```python
import torch

def _softmax(x, axis=-1):
    return torch.softmax(x, dim=axis)
def _gelu(x):
    return torch.nn.functional.gelu(x, approximate="tanh")
def _silu(x):
    return torch.nn.functional.silu(x)
def _sigmoid(x):
    return torch.sigmoid(x)
def _layernorm(x, axis=-1, eps=1e-5):
    m = x.mean(dim=axis, keepdim=True)
    v = x.var(dim=axis, keepdim=True, unbiased=False)
    return (x - m) / torch.sqrt(v + eps)
def _scatter_add(tgt, idx, src, axis=0):
    return tgt.clone().index_add_(axis, idx, src)
def _segment_sum(src, seg, n):
    out = torch.zeros((n,) + src.shape[1:], dtype=src.dtype)
    return out.index_add_(0, seg, src)
def _pad(x, pw):
    flat = tuple(v for pair in reversed(pw) for v in pair)
    return torch.nn.functional.pad(x, flat)

kernel_name = 'gated_mix__spectral_gfnet__swiglu_ffn__prompt'

def setup_inputs():

    _w = (lambda a: (lambda t: t.to(torch.bfloat16) if t.is_floating_point() else t)(torch.as_tensor(a)))
    def _A_setup():
        B, S, D = 1, 2048, 576
        Df = D // 2 + 1
        return {
            "x": _w((lambda *s: torch.randn(*s, dtype=torch.bfloat16) * 0.05)(B, S, D)),
            "w_r": _w((lambda *s: torch.randn(*s, dtype=torch.bfloat16) * 1.6)(S, Df) * 0.02),
            "w_i": _w((lambda *s: torch.randn(*s, dtype=torch.bfloat16) * 1.6)(S, Df) * 0.02),
        }
    _A_in = _A_setup()

    def _B_setup():
        B, S, D, F = 1, 2048, 576, 4608
        return {
            "x": _w((lambda *s: torch.randn(*s, dtype=torch.bfloat16) * 0.05)(B, S, D)),
            "w_gate": _w((lambda *s: torch.randn(*s, dtype=torch.bfloat16) * 0.05)(D, F)),
            "w_up": _w((lambda *s: torch.randn(*s, dtype=torch.bfloat16) * 0.05)(D, F)),
            "w_down": _w((lambda *s: torch.randn(*s, dtype=torch.bfloat16) * 0.05)(F, D)),
        }
    _B_in = _B_setup()

    return {
        "A_x": _A_in["x"],
        "A_w_r": _A_in["w_r"],
        "A_w_i": _A_in["w_i"],
        "B_x": _B_in["x"],
        "B_w_gate": _B_in["w_gate"],
        "B_w_up": _B_in["w_up"],
        "B_w_down": _B_in["w_down"],
        "gate_w": _w((lambda *s: torch.randn(*s, dtype=torch.bfloat16) * 0.05)(576) * 16.0),
    }

def reference(A_x, A_w_r, A_w_i, B_x, B_w_gate, B_w_up, B_w_down, gate_w):
    def _A_ref(x, w_r, w_i):
        B, S, D = x.shape
        X = (lambda x, axes=(-2,-1): torch.fft.rfft2(x.float(), dim=axes))(x, axes=(-2, -1))
        W = w_r + 1j * w_i
        X = X * W
        y = (lambda x, s, axes=(-2,-1): torch.fft.irfft2(x, s=s, dim=axes).to(torch.bfloat16))(X, (S, D), axes=(-2, -1))
        return y

    def _B_ref(x, w_gate, w_up, w_down):
        g = _silu(x @ w_gate)
        u = x @ w_up
        return (g * u) @ w_down

    x = A_x
    g = _sigmoid((x * gate_w).sum(-1, keepdims=True))
    a = _A_ref(x, A_w_r, A_w_i)
    b = _B_ref(x, B_w_gate, B_w_up, B_w_down)
    return g * a + (1 - g) * b
```

```asm
; @launch kernel=k1_kernel grid=(256,1,1) block=(256,1,1) lds=163840
; @launch kernel=k2_kernel grid=(256,1,1) block=(576,1,1) lds=46592
.amdgcn_target "amdgcn-amd-amdhsa--gfx950"
.text
.globl k1_kernel
.p2align 8
.type k1_kernel,@function
k1_kernel:
  s_cmp_ge_u32 s2, 256
  s_cbranch_scc1 k1_kernel_end
  s_load_dwordx16 s[16:31], s[0:1], 0
  s_load_dwordx2 s[32:33], s[0:1], 72
  s_load_dwordx2 s[34:35], s[0:1], 80
  s_getpc_b64 s[4:5]
  v_and_b32 v224, 63, v0
  v_min_u32 v224, 12, v224
  v_lshrrev_b32 v225, 6, v0
  s_bfe_u32 s3, s2, 0x30003
  v_lshl_add_u32 v225, s3, 2, v225
  v_mad_u32_u24 v224, v225, 13, v224
  v_lshlrev_b32 v224, 7, v224
  v_min_u32 v224, 51456, v224
  v_mov_b32 v227, s5
  v_add_co_u32 v226, vcc, s4, v224
  s_nop 1
  v_addc_co_u32 v227, vcc, 0, v227, vcc
  global_load_dword v224, v[226:227], off
  v_lshrrev_b32 v97, 6, v0
  v_and_b32 v96, 63, v0
  v_readfirstlane_b32 s64, v97
  v_lshrrev_b32 v97, 4, v96
  v_lshlrev_b32 v21, 4, v96
  s_and_b32 s84, s2, 7
  s_bfe_u32 s86, s2, 0x10003
  s_lshl1_add_u32 s68, s84, s86
  s_lshr_b32 s67, s2, 4
  s_mul_i32 s3, s67, 2
  s_add_u32 s3, s3, s68
  s_and_b32 s3, s3, 15
  v_lshrrev_b32 v102, 3, v96
  v_mul_u32_u24 v13, 1152, v102
  v_and_b32 v102, 0x30, v96
  v_and_b32 v103, 0x70, v21
  v_xor_b32 v102, v102, v103
  v_xor_b32 v103, 64, v102
  v_add_u32 v103, v13, v103
  v_add_u32 v13, v13, v102
  v_add_u32 v14, 8192, v103
  v_add_u32 v15, 16384, v13
  v_add_u32 v16, 24576, v103
  s_lshl_b32 s84, s67, 2
  s_add_u32 s86, s86, s84
  s_add_u32 s84, s84, s64
  s_mul_i32 s69, s84, 36864
  s_mul_i32 s86, s86, 36864
  s_lshl_b32 s74, s64, 12
  s_and_b32 s65, s64, 1
  s_lshr_b32 s66, s64, 1
  v_mul_u32_u24 v254, 147456, v96
  v_mov_b32 v102, 2147418112
  v_cmp_le_u32 vcc, 18, v96
  s_and_b32 s72, s67, 15
  s_mul_i32 s84, s66, 288
  v_cndmask_b32 v254, v254, v102, vcc
  s_add_u32 s72, s72, s84
  s_mul_i32 s72, s72, 9216
  s_mul_i32 s84, s68, 576
  s_add_u32 s72, s72, s84
  s_bitcmp1_b32 s68, 0
  s_cselect_b32 s84, 448, 0
  s_add_u32 s72, s72, s84
  s_waitcnt lgkmcnt(0)
  s_mov_b32 s36, s16
  s_and_b32 s37, s17, 0xffff
  s_mov_b32 s38, 2359296
  s_mov_b32 s39, 0x20000
  s_cmp_lg_u32 s3, 2
  s_cbranch_scc1 k1_kernel_nogate
  s_mov_b32 s60, s30
  s_and_b32 s61, s31, 0xffff
  s_mov_b32 s62, 1152
  s_mov_b32 s63, 0x20000
  v_lshlrev_b32 v102, 4, v97
  s_lshl_b32 s85, s64, 6
  buffer_load_dwordx4 v[64:67], v102, s[60:63], s85 offen offset:0
  buffer_load_dwordx4 v[68:71], v102, s[60:63], s85 offen offset:256
  buffer_load_dwordx4 v[72:75], v102, s[60:63], s85 offen offset:512
  buffer_load_dwordx4 v[76:79], v102, s[60:63], s85 offen offset:768
  buffer_load_dwordx4 v[80:83], v102, s[60:63], s85 offen offset:1024
k1_kernel_nogate:
  s_add_u32 m0, s74, 0
  s_nop 0
  buffer_load_dwordx4 v13, s[36:39], s69 offen lds
  buffer_load_dwordx4 v14, s[36:39], s69 offen offset:1024 lds
  buffer_load_dwordx4 v15, s[36:39], s69 offen offset:2048 lds
  buffer_load_dwordx4 v16, s[36:39], s69 offen offset:3072 lds
  s_add_u32 s69, s69, 128
  v_and_b32 v98, 15, v96
  s_mov_b32 s88, 0x3ae38e39
  s_lshl_b32 s84, s3, 1
  s_add_u32 s84, s84, s65
  s_lshl_b32 s84, s84, 4
  v_add_u32 v142, s84, v98
  v_lshrrev_b32 v136, 1, v142
  v_and_b32 v137, 1, v142
  v_cvt_f32_u32 v137, v137
  v_mul_f32 v137, 0x3e800000, v137
  s_lshl_b32 s84, s66, 12
  s_lshl_b32 s85, s65, 11
  s_add_u32 s84, s84, s85
  s_add_u32 s84, s84, 81920
  v_add_u32 v170, s84, v21
  v_add_u32 v171, 65536, v170
  v_cvt_f32_u32 v138, v136
  v_mul_f32 v138, s88, v138
  s_lshl_b32 s84, s66, 5
  v_lshl_add_u32 v142, v97, 3, s84
  v_mul_u32_u24 v139, v136, v142
  v_lshlrev_b32 v140, 6, v136
  v_mul_u32_u24 v142, 29128, v139
  v_lshrrev_b32 v142, 24, v142
  v_mul_u32_u24 v142, 576, v142
  v_sub_u32 v139, v139, v142
  v_mul_u32_u24 v142, 29128, v140
  v_lshrrev_b32 v142, 24, v142
  v_mul_u32_u24 v142, 576, v142
  v_sub_u32 v140, v140, v142
  v_cvt_f32_u32 v143, v140
  v_mul_f32 v143, s88, v143
  v_cos_f32 v143, v143
  v_cvt_f32_u32 v141, v139
  v_add_u32 v139, v139, v140
  v_fma_f32 v144, v141, s88, v137
  v_add_f32 v143, v143, v143
  v_add_f32 v145, v144, v138
  v_fma_f32 v146, 2.0, v138, v144
  v_fma_f32 v147, 2.0, v138, v145
  v_fma_f32 v148, 4.0, v138, v144
  v_fma_f32 v149, 4.0, v138, v145
  s_add_u32 m0, s74, 16384
  s_nop 0
  buffer_load_dwordx4 v13, s[36:39], s69 offen lds
  buffer_load_dwordx4 v14, s[36:39], s69 offen offset:1024 lds
  buffer_load_dwordx4 v15, s[36:39], s69 offen offset:2048 lds
  buffer_load_dwordx4 v16, s[36:39], s69 offen offset:3072 lds
  s_add_u32 s69, s69, 128
  v_fma_f32 v150, 4.0, v138, v146
  v_fma_f32 v151, 4.0, v138, v147
  v_cos_f32 v144, v144
  v_cos_f32 v145, v145
  v_cos_f32 v146, v146
  v_cos_f32 v147, v147
  v_cos_f32 v148, v148
  v_cos_f32 v149, v149
  v_cos_f32 v150, v150
  v_cos_f32 v151, v151
  v_cvt_pk_bf16_f32 v160, v144, v145
  v_cvt_pk_bf16_f32 v161, v146, v147
  v_cvt_pk_bf16_f32 v162, v148, v149
  v_cvt_pk_bf16_f32 v163, v150, v151
  ds_write_b128 v170, v[160:163] offset:0
  v_cvt_f32_u32 v141, v139
  v_fma_f32 v152, v141, s88, v137
  v_add_f32 v153, v152, v138
  v_fma_f32 v154, 2.0, v138, v152
  v_fma_f32 v155, 2.0, v138, v153
  v_fma_f32 v156, 4.0, v138, v152
  v_fma_f32 v157, 4.0, v138, v153
  v_fma_f32 v158, 4.0, v138, v154
  v_fma_f32 v159, 4.0, v138, v155
  v_cos_f32 v152, v152
  v_cos_f32 v153, v153
  v_cos_f32 v154, v154
  v_cos_f32 v155, v155
  v_cos_f32 v156, v156
  v_cos_f32 v157, v157
  v_cos_f32 v158, v158
  v_cos_f32 v159, v159
  v_cvt_pk_bf16_f32 v164, v152, v153
  v_cvt_pk_bf16_f32 v165, v154, v155
  v_cvt_pk_bf16_f32 v166, v156, v157
  v_cvt_pk_bf16_f32 v167, v158, v159
  ds_write_b128 v170, v[164:167] offset:8192
  v_fma_f32 v144, v143, v152, -v144
  v_fma_f32 v145, v143, v153, -v145
  v_fma_f32 v146, v143, v154, -v146
  v_fma_f32 v147, v143, v155, -v147
  v_fma_f32 v148, v143, v156, -v148
  v_fma_f32 v149, v143, v157, -v149
  v_fma_f32 v150, v143, v158, -v150
  v_fma_f32 v151, v143, v159, -v151
  v_cvt_pk_bf16_f32 v160, v144, v145
  v_cvt_pk_bf16_f32 v161, v146, v147
  v_cvt_pk_bf16_f32 v162, v148, v149
  v_cvt_pk_bf16_f32 v163, v150, v151
  ds_write_b128 v170, v[160:163] offset:16384
  v_fma_f32 v152, v143, v144, -v152
  v_fma_f32 v153, v143, v145, -v153
  v_fma_f32 v154, v143, v146, -v154
  v_fma_f32 v155, v143, v147, -v155
  v_fma_f32 v156, v143, v148, -v156
  v_fma_f32 v157, v143, v149, -v157
  v_fma_f32 v158, v143, v150, -v158
  v_fma_f32 v159, v143, v151, -v159
  v_cvt_pk_bf16_f32 v164, v152, v153
  v_cvt_pk_bf16_f32 v165, v154, v155
  v_cvt_pk_bf16_f32 v166, v156, v157
  v_cvt_pk_bf16_f32 v167, v158, v159
  ds_write_b128 v170, v[164:167] offset:24576
  v_fma_f32 v144, v143, v152, -v144
  v_fma_f32 v145, v143, v153, -v145
  v_fma_f32 v146, v143, v154, -v146
  v_fma_f32 v147, v143, v155, -v147
  v_fma_f32 v148, v143, v156, -v148
  v_fma_f32 v149, v143, v157, -v149
  v_fma_f32 v150, v143, v158, -v150
  v_fma_f32 v151, v143, v159, -v151
  v_cvt_pk_bf16_f32 v160, v144, v145
  v_cvt_pk_bf16_f32 v161, v146, v147
  v_cvt_pk_bf16_f32 v162, v148, v149
  v_cvt_pk_bf16_f32 v163, v150, v151
  ds_write_b128 v170, v[160:163] offset:32768
  v_fma_f32 v152, v143, v144, -v152
  v_fma_f32 v153, v143, v145, -v153
  v_fma_f32 v154, v143, v146, -v154
  v_fma_f32 v155, v143, v147, -v155
  v_fma_f32 v156, v143, v148, -v156
  v_fma_f32 v157, v143, v149, -v157
  v_fma_f32 v158, v143, v150, -v158
  v_fma_f32 v159, v143, v151, -v159
  v_cvt_pk_bf16_f32 v164, v152, v153
  v_cvt_pk_bf16_f32 v165, v154, v155
  s_cmp_eq_u32 s65, 1
  s_cselect_b32 s24, s26, s24
  s_cselect_b32 s25, s27, s25
  s_mov_b32 s40, s24
  s_and_b32 s41, s25, 0xffff
  s_mov_b32 s42, 5308416
  s_mov_b32 s43, 0x20000
  buffer_load_dword v225, v254, s[40:43], s72 offen
  s_add_u32 m0, s74, 32768
  s_nop 0
  buffer_load_dwordx4 v13, s[36:39], s69 offen lds
  buffer_load_dwordx4 v14, s[36:39], s69 offen offset:1024 lds
  buffer_load_dwordx4 v15, s[36:39], s69 offen offset:2048 lds
  buffer_load_dwordx4 v16, s[36:39], s69 offen offset:3072 lds
  s_add_u32 s69, s69, 128
  v_cvt_pk_bf16_f32 v166, v156, v157
  v_cvt_pk_bf16_f32 v167, v158, v159
  ds_write_b128 v170, v[164:167] offset:40960
  v_fma_f32 v144, v143, v152, -v144
  v_fma_f32 v145, v143, v153, -v145
  v_fma_f32 v146, v143, v154, -v146
  v_fma_f32 v147, v143, v155, -v147
  v_fma_f32 v148, v143, v156, -v148
  v_fma_f32 v149, v143, v157, -v149
  v_fma_f32 v150, v143, v158, -v150
  v_fma_f32 v151, v143, v159, -v151
  v_cvt_pk_bf16_f32 v160, v144, v145
  v_cvt_pk_bf16_f32 v161, v146, v147
  v_cvt_pk_bf16_f32 v162, v148, v149
  v_cvt_pk_bf16_f32 v163, v150, v151
  ds_write_b128 v170, v[160:163] offset:49152
  v_fma_f32 v152, v143, v144, -v152
  v_fma_f32 v153, v143, v145, -v153
  v_fma_f32 v154, v143, v146, -v154
  v_fma_f32 v155, v143, v147, -v155
  v_fma_f32 v156, v143, v148, -v156
  v_fma_f32 v157, v143, v149, -v157
  v_fma_f32 v158, v143, v150, -v158
  v_fma_f32 v159, v143, v151, -v159
  v_cvt_pk_bf16_f32 v164, v152, v153
  v_cvt_pk_bf16_f32 v165, v154, v155
  v_cvt_pk_bf16_f32 v166, v156, v157
  v_cvt_pk_bf16_f32 v167, v158, v159
  ds_write_b128 v170, v[164:167] offset:57344
  v_fma_f32 v144, v143, v152, -v144
  v_fma_f32 v145, v143, v153, -v145
  v_fma_f32 v146, v143, v154, -v146
  v_fma_f32 v147, v143, v155, -v147
  v_fma_f32 v148, v143, v156, -v148
  v_fma_f32 v149, v143, v157, -v149
  v_fma_f32 v150, v143, v158, -v150
  v_fma_f32 v151, v143, v159, -v151
  v_cvt_pk_bf16_f32 v160, v144, v145
  v_cvt_pk_bf16_f32 v161, v146, v147
  v_cvt_pk_bf16_f32 v162, v148, v149
  v_cvt_pk_bf16_f32 v163, v150, v151
  ds_write_b128 v171, v[160:163] offset:0
  s_lshl_b32 s84, s65, 4
  v_add_u32 v102, s84, v98
  v_lshlrev_b32 v22, 4, v102
  v_lshl_add_u32 v22, v97, 14, v22
  v_lshrrev_b32 v103, 1, v98
  v_xor_b32 v103, v103, v97
  v_lshlrev_b32 v103, 4, v103
  v_lshl_add_u32 v1, v102, 7, v103
  s_lshl_b32 s84, s66, 11
  v_add_u32 v23, s84, v21
  v_add_u32 v24, 65536, v23
  v_add_u32 v25, 131072, v23
  s_lshl1_add_u32 s101, s3, s66
  s_mul_i32 s85, s68, 576
  s_mul_i32 s84, s66, 294912
  s_mov_b32 s76, 36864
  s_mul_i32 s89, s68, 331776
  s_bitcmp1_b32 s68, 0
  s_cselect_b32 s73, 448, 0
  s_cselect_b32 s79, 0, 512
  s_cselect_b32 s75, -1, 1
  s_cselect_b32 s76, 4294930432, s76
  s_cselect_b32 s86, 294912, 0
  s_add_u32 s89, s89, s86
  s_add_u32 s85, s85, s84
  s_add_u32 s73, s73, s85
  s_add_u32 s79, s79, s85
  s_add_u32 s79, s79, s84
  s_lshl_b32 s75, s75, 7
  s_mov_b32 s90, 0
  s_mul_i32 s84, s90, s75
  s_add_u32 s73, s73, s84
  v_lshrrev_b32 v102, 3, v96
  v_mul_u32_u24 v17, 9216, v102
  v_and_b32 v102, 16, v96
  v_lshlrev_b32 v102, 1, v102
  v_and_b32 v103, 0x70, v21
  v_xor_b32 v102, v102, v103
  v_xor_b32 v103, 64, v102
  v_add_u32 v103, v17, v103
  v_add_u32 v17, v17, v102
  v_add_u32 v18, 72704, v103
  v_add_u32 v19, 145408, v17
  v_add_u32 v20, 218112, v103
  s_add_u32 m0, s74, 49152
  s_nop 0
  buffer_load_dwordx4 v13, s[36:39], s69 offen lds
  buffer_load_dwordx4 v14, s[36:39], s69 offen offset:1024 lds
  buffer_load_dwordx4 v15, s[36:39], s69 offen offset:2048 lds
  buffer_load_dwordx4 v16, s[36:39], s69 offen offset:3072 lds
  s_add_u32 s69, s69, 128
  s_cmp_lt_u32 s3, 3
  s_cbranch_scc1 k1_kernel_dft2
k1_kernel_dft2ret:
  s_waitcnt lgkmcnt(0)
  s_mov_b64 exec, 0
  s_cmp_eq_u32 s64, 1
  s_cbranch_scc1 k1_pg1
  s_cmp_eq_u32 s64, 2
  s_cbranch_scc1 k1_pg2
  s_cmp_eq_u32 s64, 3
  s_cbranch_scc1 k1_pg3
  s_branch k1_pg0
k1_wback:
  s_mov_b64 exec, -1
  s_branch k1_kernel_main
.p2align 12
k1_kernel_main:
k1_pg0:
  s_cbranch_execz k1_pg4
  s_waitcnt vmcnt(13)
  s_barrier
  v_add_u32 v29, 0, v1
  v_xor_b32 v30, 64, v29
  ds_read_b128 a[0:3], v29 offset:0
  ds_read_b128 a[4:7], v29 offset:4096
  ds_read_b128 a[8:11], v29 offset:8192
  ds_read_b128 a[12:15], v29 offset:12288
  ds_read_b128 a[16:19], v30 offset:0
  ds_read_b128 a[20:23], v30 offset:4096
  ds_read_b128 a[24:27], v30 offset:8192
  ds_read_b128 a[28:31], v30 offset:12288
  ds_read_b128 v[32:35], v24 offset:16384
  ds_read_b128 v[36:39], v24 offset:17408
  ds_read_b128 v[40:43], v24 offset:20480
  ds_read_b128 v[44:47], v24 offset:21504
  ds_read_b128 v[48:51], v24 offset:24576
  ds_read_b128 v[52:55], v24 offset:25600
  ds_read_b128 v[56:59], v24 offset:28672
  s_waitcnt lgkmcnt(3)
  v_mfma_f32_16x16x32_bf16 v[64:67], v[32:35], a[0:3], 0
  s_add_u32 m0, s74, 65536
  s_nop 0
  buffer_load_dwordx4 v13, s[36:39], s69 offen lds
  v_mfma_f32_16x16x32_bf16 v[68:71], v[32:35], a[4:7], 0
  v_and_b32 v100, 3, v96
  v_bfe_u32 v99, v96, 2, 2
  v_mfma_f32_16x16x32_bf16 v[72:75], v[32:35], a[8:11], 0
  v_lshrrev_b32 v101, 1, v99
  v_and_b32 v102, 1, v97
  v_mfma_f32_16x16x32_bf16 v[76:79], v[32:35], a[12:15], 0
  ds_read_b128 v[60:63], v24 offset:29696
  v_lshl_or_b32 v101, v102, 1, v101
  s_cmp_ge_u32 s101, 5
  s_cbranch_scc1 k1_kernel_z4
  v_mfma_f32_16x16x32_bf16 v[80:83], v[36:39], a[0:3], 0
  v_mfma_f32_16x16x32_bf16 v[84:87], v[36:39], a[4:7], 0
  v_mfma_f32_16x16x32_bf16 v[88:91], v[36:39], a[8:11], 0
  v_mfma_f32_16x16x32_bf16 v[92:95], v[36:39], a[12:15], 0
k1_kernel_z4:
  v_xor_b32 v102, s66, v102
  v_lshlrev_b32 v102, 5, v102
  buffer_load_dwordx4 v14, s[36:39], s69 offen offset:1024 lds
  v_lshl_add_u32 v102, v100, 3, v102
  v_lshl_add_u32 v103, v97, 3, v99
  v_lshl_add_u32 v3, v103, 6, v102
  s_lshl_b32 s84, s66, 1
  v_mfma_f32_16x16x32_bf16 v[64:67], v[40:43], a[16:19], v[64:67]
  v_xor_b32 v102, s84, v101
  v_lshlrev_b32 v102, 5, v102
  v_mfma_f32_16x16x32_bf16 v[68:71], v[40:43], a[20:23], v[68:71]
  v_lshl_add_u32 v102, v100, 3, v102
  v_lshl_add_u32 v7, v103, 7, v102
  v_mfma_f32_16x16x32_bf16 v[72:75], v[40:43], a[24:27], v[72:75]
  v_add_u32 v29, 16384, v1
  v_xor_b32 v30, 64, v29
  buffer_load_dwordx4 v15, s[36:39], s69 offen offset:2048 lds
  v_xor_b32 v8, 32, v7
  v_add_u32 v9, 65536, v7
  v_mfma_f32_16x16x32_bf16 v[76:79], v[40:43], a[28:31], v[76:79]
  v_add_u32 v10, 65536, v8
  v_add_u32 v11, 131072, v7
  s_cmp_ge_u32 s101, 5
  s_cbranch_scc1 k1_kernel_z12
  v_mfma_f32_16x16x32_bf16 v[80:83], v[44:47], a[16:19], v[80:83]
  v_mfma_f32_16x16x32_bf16 v[84:87], v[44:47], a[20:23], v[84:87]
  v_mfma_f32_16x16x32_bf16 v[88:91], v[44:47], a[24:27], v[88:91]
  v_mfma_f32_16x16x32_bf16 v[92:95], v[44:47], a[28:31], v[92:95]
k1_kernel_z12:
  s_waitcnt vmcnt(12)
  s_barrier
  ds_read_b128 a[32:35], v29 offset:0
  ds_read_b128 a[36:39], v29 offset:4096
  ds_read_b128 a[40:43], v29 offset:8192
  ds_read_b128 a[44:47], v29 offset:12288
  v_add_u32 v12, 131072, v8
  ds_read_b128 a[48:51], v30 offset:0
  ds_read_b128 v[32:35], v24 offset:32768
  ds_read_b128 a[52:55], v30 offset:4096
  ds_read_b128 v[36:39], v24 offset:33792
  buffer_load_dwordx4 v16, s[36:39], s69 offen offset:3072 lds
  s_waitcnt lgkmcnt(4)
  v_mfma_f32_16x16x32_bf16 v[64:67], v[48:51], a[32:35], v[64:67]
  ds_read_b128 a[56:59], v30 offset:8192
  ds_read_b128 a[60:63], v30 offset:12288
  v_mfma_f32_16x16x32_bf16 v[68:71], v[48:51], a[36:39], v[68:71]
  ds_read_b128 v[40:43], v24 offset:36864
  s_mov_b32 s44, s28
  v_mfma_f32_16x16x32_bf16 v[72:75], v[48:51], a[40:43], v[72:75]
  s_and_b32 s45, s29, 0xffff
  s_mov_b32 s46, 5308416
  v_mfma_f32_16x16x32_bf16 v[76:79], v[48:51], a[44:47], v[76:79]
  ds_read_b128 v[44:47], v24 offset:37888
  s_mov_b32 s47, 0x20000
  s_cmp_ge_u32 s101, 5
  s_cbranch_scc1 k1_kernel_z20
  v_mfma_f32_16x16x32_bf16 v[80:83], v[52:55], a[32:35], v[80:83]
  v_mfma_f32_16x16x32_bf16 v[84:87], v[52:55], a[36:39], v[84:87]
  v_mfma_f32_16x16x32_bf16 v[88:91], v[52:55], a[40:43], v[88:91]
  v_mfma_f32_16x16x32_bf16 v[92:95], v[52:55], a[44:47], v[92:95]
k1_kernel_z20:
  s_add_u32 s69, s69, 128
  s_add_u32 m0, s74, 0
  s_nop 0
  buffer_load_dwordx4 v13, s[36:39], s69 offen lds
  s_mov_b32 s48, s34
  s_and_b32 s49, s35, 0xffff
  buffer_load_dwordx4 v14, s[36:39], s69 offen offset:1024 lds
  v_add_u32 v29, 32768, v1
  ds_read_b128 v[48:51], v24 offset:40960
  s_waitcnt lgkmcnt(3)
  v_mfma_f32_16x16x32_bf16 v[64:67], v[56:59], a[48:51], v[64:67]
  v_xor_b32 v30, 64, v29
  s_mov_b32 s50, 268435456
  v_mfma_f32_16x16x32_bf16 v[68:71], v[56:59], a[52:55], v[68:71]
  s_mov_b32 s51, 0x20000
  s_mov_b32 s52, s18
  v_mfma_f32_16x16x32_bf16 v[72:75], v[56:59], a[56:59], v[72:75]
  s_waitcnt vmcnt(10)
  s_barrier
  v_mfma_f32_16x16x32_bf16 v[76:79], v[56:59], a[60:63], v[76:79]
  buffer_load_dwordx4 v15, s[36:39], s69 offen offset:2048 lds
  s_cmp_ge_u32 s101, 5
  s_cbranch_scc1 k1_kernel_z28
  v_mfma_f32_16x16x32_bf16 v[80:83], v[60:63], a[48:51], v[80:83]
  v_mfma_f32_16x16x32_bf16 v[84:87], v[60:63], a[52:55], v[84:87]
  v_mfma_f32_16x16x32_bf16 v[88:91], v[60:63], a[56:59], v[88:91]
  v_mfma_f32_16x16x32_bf16 v[92:95], v[60:63], a[60:63], v[92:95]
k1_kernel_z28:
  ds_read_b128 a[64:67], v29 offset:0
  ds_read_b128 a[68:71], v29 offset:4096
  ds_read_b128 a[72:75], v29 offset:8192
  ds_read_b128 a[76:79], v29 offset:12288
  ds_read_b128 a[80:83], v30 offset:0
  ds_read_b128 v[52:55], v24 offset:41984
  ds_read_b128 a[84:87], v30 offset:4096
  s_and_b32 s53, s19, 0xffff
  ds_read_b128 a[88:91], v30 offset:8192
  ds_read_b128 v[56:59], v24 offset:45056
  s_waitcnt lgkmcnt(5)
  v_mfma_f32_16x16x32_bf16 v[64:67], v[32:35], a[64:67], v[64:67]
  ds_read_b128 a[92:95], v30 offset:12288
  buffer_load_dwordx4 v16, s[36:39], s69 offen offset:3072 lds
  v_mfma_f32_16x16x32_bf16 v[68:71], v[32:35], a[68:71], v[68:71]
  s_mov_b32 s54, 1183744
  s_mov_b32 s55, 0x20000
  v_mfma_f32_16x16x32_bf16 v[72:75], v[32:35], a[72:75], v[72:75]
  s_mov_b32 s56, s20
  s_and_b32 s57, s21, 0xffff
  v_mfma_f32_16x16x32_bf16 v[76:79], v[32:35], a[76:79], v[76:79]
  ds_read_b128 v[60:63], v24 offset:46080
  s_mov_b32 s58, 1183744
  s_cmp_ge_u32 s101, 5
  s_cbranch_scc1 k1_kernel_z36
  v_mfma_f32_16x16x32_bf16 v[80:83], v[36:39], a[64:67], v[80:83]
  v_mfma_f32_16x16x32_bf16 v[84:87], v[36:39], a[68:71], v[84:87]
  v_mfma_f32_16x16x32_bf16 v[88:91], v[36:39], a[72:75], v[88:91]
  v_mfma_f32_16x16x32_bf16 v[92:95], v[36:39], a[76:79], v[92:95]
k1_kernel_z36:
  s_mov_b32 s59, 0x20000
  s_add_u32 s69, s69, 128
  s_add_u32 m0, s74, 16384
  s_nop 0
  buffer_load_dwordx4 v17, s[40:43], s73 offen lds
  v_add_u32 v29, 49152, v1
  buffer_load_dwordx4 v18, s[40:43], s73 offen offset:1024 lds
  s_waitcnt lgkmcnt(1)
  v_mfma_f32_16x16x32_bf16 v[64:67], v[40:43], a[80:83], v[64:67]
  v_xor_b32 v30, 64, v29
  ds_read_b128 v[32:35], v24 offset:49152
  v_mfma_f32_16x16x32_bf16 v[68:71], v[40:43], a[84:87], v[68:71]
  s_cmp_eq_u32 s90, 3
  s_cselect_b32 s84, -3, 1
  v_mfma_f32_16x16x32_bf16 v[72:75], v[40:43], a[88:91], v[72:75]
  s_waitcnt vmcnt(10)
  s_barrier
  v_mfma_f32_16x16x32_bf16 v[76:79], v[40:43], a[92:95], v[76:79]
  ds_read_b128 a[96:99], v29 offset:0
  ds_read_b128 v[36:39], v24 offset:50176
  s_cmp_ge_u32 s101, 5
  s_cbranch_scc1 k1_kernel_z44
  v_mfma_f32_16x16x32_bf16 v[80:83], v[44:47], a[80:83], v[80:83]
  v_mfma_f32_16x16x32_bf16 v[84:87], v[44:47], a[84:87], v[84:87]
  v_mfma_f32_16x16x32_bf16 v[88:91], v[44:47], a[88:91], v[88:91]
  v_mfma_f32_16x16x32_bf16 v[92:95], v[44:47], a[92:95], v[92:95]
k1_kernel_z44:
  ds_read_b128 a[100:103], v29 offset:4096
  ds_read_b128 a[104:107], v29 offset:8192
  ds_read_b128 a[108:111], v29 offset:12288
  buffer_load_dwordx4 v19, s[40:43], s73 offen offset:2048 lds
  s_mul_i32 s84, s84, s75
  s_sub_u32 s95, s84, 4718592
  ds_read_b128 a[112:115], v30 offset:0
  ds_read_b128 a[116:119], v30 offset:4096
  s_cmp_eq_u32 s90, 2
  s_cselect_b32 s84, -3, 1
  s_waitcnt lgkmcnt(2)
  v_mfma_f32_16x16x32_bf16 v[64:67], v[48:51], a[96:99], v[64:67]
  ds_read_b128 a[120:123], v30 offset:8192
  ds_read_b128 a[124:127], v30 offset:12288
  s_mul_i32 s84, s84, s75
  v_mfma_f32_16x16x32_bf16 v[68:71], v[48:51], a[100:103], v[68:71]
  buffer_load_dwordx4 v20, s[40:43], s73 offen offset:3072 lds
  s_sub_u32 s96, s84, 4718592
  v_mfma_f32_16x16x32_bf16 v[72:75], v[48:51], a[104:107], v[72:75]
  ds_read_b128 v[40:43], v24 offset:53248
  v_mfma_f32_16x16x32_bf16 v[76:79], v[48:51], a[108:111], v[76:79]
  s_cmp_eq_u32 s90, 1
  s_cselect_b32 s84, -3, 1
  s_cmp_ge_u32 s101, 5
  s_cbranch_scc1 k1_kernel_z52
  v_mfma_f32_16x16x32_bf16 v[80:83], v[52:55], a[96:99], v[80:83]
  v_mfma_f32_16x16x32_bf16 v[84:87], v[52:55], a[100:103], v[84:87]
  v_mfma_f32_16x16x32_bf16 v[88:91], v[52:55], a[104:107], v[88:91]
  v_mfma_f32_16x16x32_bf16 v[92:95], v[52:55], a[108:111], v[92:95]
k1_kernel_z52:
  s_mul_i32 s84, s84, s75
  ds_read_b128 v[44:47], v24 offset:54272
  s_sub_u32 s97, s84, 4718592
  s_lshl_b32 s90, s90, 1
  s_add_u32 s73, s73, 589824
  s_add_u32 m0, s74, 81920
  s_nop 0
  buffer_load_dwordx4 v13, s[36:39], s69 offen lds
  v_add_u32 v29, 65536, v1
  ds_read_b128 v[48:51], v24 offset:57344
  s_waitcnt lgkmcnt(3)
  v_mfma_f32_16x16x32_bf16 v[64:67], v[56:59], a[112:115], v[64:67]
  buffer_load_dwordx4 v14, s[36:39], s69 offen offset:1024 lds
  s_mul_i32 s84, s64, 578
  v_mfma_f32_16x16x32_bf16 v[68:71], v[56:59], a[116:119], v[68:71]
  v_lshl_add_u32 v251, v96, 3, s84
  v_xor_b32 v30, 64, v29
  v_mfma_f32_16x16x32_bf16 v[72:75], v[56:59], a[120:123], v[72:75]
  v_mov_b32 v103, 2147418112
  v_mfma_f32_16x16x32_bf16 v[76:79], v[56:59], a[124:127], v[76:79]
  s_waitcnt vmcnt(10)
  s_barrier
  s_cmp_ge_u32 s101, 5
  s_cbranch_scc1 k1_kernel_z60
  v_mfma_f32_16x16x32_bf16 v[80:83], v[60:63], a[112:115], v[80:83]
  v_mfma_f32_16x16x32_bf16 v[84:87], v[60:63], a[116:119], v[84:87]
  v_mfma_f32_16x16x32_bf16 v[88:91], v[60:63], a[120:123], v[88:91]
  v_mfma_f32_16x16x32_bf16 v[92:95], v[60:63], a[124:127], v[92:95]
k1_kernel_z60:
  ds_read_b128 a[128:131], v29 offset:0
  ds_read_b128 a[132:135], v29 offset:4096
  ds_read_b128 a[136:139], v29 offset:8192
  ds_read_b128 a[140:143], v29 offset:12288
  v_cmp_gt_u32 vcc, 37, v96
  s_nop 1
  v_cndmask_b32 v251, v103, v251, vcc
  buffer_load_dwordx4 v15, s[36:39], s69 offen offset:2048 lds
  s_lshr_b32 s85, s2, 5
  s_bfe_u32 s84, s2, 0x40001
  ds_read_b128 a[144:147], v30 offset:0
  s_lshl_b32 s86, s85, 6
  ds_read_b128 a[148:151], v30 offset:4096
  s_waitcnt lgkmcnt(2)
  v_mfma_f32_16x16x32_bf16 v[64:67], v[32:35], a[128:131], v[64:67]
  ds_read_b128 a[152:155], v30 offset:8192
  ds_read_b128 a[156:159], v30 offset:12288
  s_add_u32 s86, s86, s84
  v_mfma_f32_16x16x32_bf16 v[68:71], v[32:35], a[132:135], v[68:71]
  s_mul_i32 s91, s86, 2312
  ds_read_b128 v[52:55], v24 offset:58368
  v_mfma_f32_16x16x32_bf16 v[72:75], v[32:35], a[136:139], v[72:75]
  buffer_load_dwordx4 v16, s[36:39], s69 offen offset:3072 lds
  s_lshl_b32 s85, s85, 10
  v_mfma_f32_16x16x32_bf16 v[76:79], v[32:35], a[140:143], v[76:79]
  s_lshl_b32 s84, s84, 6
  ds_read_b128 v[56:59], v24 offset:61440
  s_cmp_ge_u32 s101, 5
  s_cbranch_scc1 k1_kernel_z68
  v_mfma_f32_16x16x32_bf16 v[80:83], v[36:39], a[128:131], v[80:83]
  v_mfma_f32_16x16x32_bf16 v[84:87], v[36:39], a[132:135], v[84:87]
  v_mfma_f32_16x16x32_bf16 v[88:91], v[36:39], a[136:139], v[88:91]
  v_mfma_f32_16x16x32_bf16 v[92:95], v[36:39], a[140:143], v[92:95]
k1_kernel_z68:
  ds_read_b128 v[60:63], v24 offset:62464
  s_add_u32 s98, s84, s85
  s_and_b32 s86, s2, 1
  s_mul_i32 s84, s86, 282
  v_add_u32 v29, 0, v1
  s_add_u32 s91, s91, s84
  s_add_u32 s69, s69, 128
  s_add_u32 m0, s74, 32768
  s_nop 0
  buffer_load_dwordx4 v17, s[40:43], s73 offen lds
  s_waitcnt lgkmcnt(3)
  v_mfma_f32_16x16x32_bf16 v[64:67], v[40:43], a[144:147], v[64:67]
  v_xor_b32 v30, 64, v29
  s_mul_i32 s84, s86, 1155072
  v_mfma_f32_16x16x32_bf16 v[68:71], v[40:43], a[148:151], v[68:71]
  buffer_load_dwordx4 v18, s[40:43], s73 offen offset:1024 lds
  v_mfma_f32_16x16x32_bf16 v[72:75], v[40:43], a[152:155], v[72:75]
  s_add_u32 s98, s98, s84
  s_add_u32 s98, s98, 62914560
  v_mfma_f32_16x16x32_bf16 v[76:79], v[40:43], a[156:159], v[76:79]
  s_waitcnt vmcnt(10)
  s_barrier
  s_cmp_ge_u32 s101, 5
  s_cbranch_scc1 k1_kernel_z76
  v_mfma_f32_16x16x32_bf16 v[80:83], v[44:47], a[144:147], v[80:83]
  v_mfma_f32_16x16x32_bf16 v[84:87], v[44:47], a[148:151], v[84:87]
  v_mfma_f32_16x16x32_bf16 v[88:91], v[44:47], a[152:155], v[88:91]
  v_mfma_f32_16x16x32_bf16 v[92:95], v[44:47], a[156:159], v[92:95]
k1_kernel_z76:
  ds_read_b128 a[160:163], v29 offset:0
  ds_read_b128 a[164:167], v29 offset:4096
  ds_read_b128 a[168:171], v29 offset:8192
  ds_read_b128 a[172:175], v29 offset:12288
  s_add_u32 s92, s91, 36992
  s_add_u32 s93, s91, 73984
  ds_read_b128 a[176:179], v30 offset:0
  buffer_load_dwordx4 v19, s[40:43], s73 offen offset:2048 lds
  s_add_u32 s94, s91, 110976
  v_lshrrev_b32 v102, 2, v0
  ds_read_b128 a[180:183], v30 offset:4096
  s_waitcnt lgkmcnt(2)
  v_mfma_f32_16x16x32_bf16 v[64:67], v[48:51], a[160:163], v[64:67]
  ds_read_b128 a[184:187], v30 offset:8192
  ds_read_b128 a[188:191], v30 offset:12288
  v_and_b32 v103, 1, v97
  v_mfma_f32_16x16x32_bf16 v[68:71], v[48:51], a[164:167], v[68:71]
  v_xor_b32 v102, v102, v103
  v_lshrrev_b32 v103, 1, v0
  v_mfma_f32_16x16x32_bf16 v[72:75], v[48:51], a[168:171], v[72:75]
  s_waitcnt vmcnt(7)
  s_barrier
  v_mfma_f32_16x16x32_bf16 v[76:79], v[48:51], a[172:175], v[76:79]
  ds_read_b64_tr_b16 v[32:33], v7 offset:16384
  ds_read_b64_tr_b16 v[34:35], v7 offset:16896
  buffer_load_dwordx4 v20, s[40:43], s73 offen offset:3072 lds
  s_cmp_ge_u32 s101, 5
  s_cbranch_scc1 k1_kernel_z84
  v_mfma_f32_16x16x32_bf16 v[80:83], v[52:55], a[160:163], v[80:83]
  v_mfma_f32_16x16x32_bf16 v[84:87], v[52:55], a[164:167], v[84:87]
  v_mfma_f32_16x16x32_bf16 v[88:91], v[52:55], a[168:171], v[88:91]
  v_mfma_f32_16x16x32_bf16 v[92:95], v[52:55], a[172:175], v[92:95]
k1_kernel_z84:
  ds_read_b64_tr_b16 v[36:37], v7 offset:24576
  ds_read_b64_tr_b16 v[38:39], v7 offset:25088
  v_xor_b32 v103, v103, v21
  v_and_b32 v103, 0x30, v103
  ds_read_b64_tr_b16 v[40:41], v7 offset:20480
  v_lshl_add_u32 v248, v102, 13, v103
  ds_read_b64_tr_b16 v[42:43], v7 offset:20992
  s_mul_i32 s86, s86, 7
  ds_read_b64_tr_b16 v[44:45], v7 offset:28672
  s_waitcnt lgkmcnt(7)
  v_mfma_f32_16x16x32_bf16 v[64:67], v[56:59], a[176:179], v[64:67]
  s_add_u32 s73, s73, 589824
  s_add_u32 m0, s74, 49152
  s_nop 0
  buffer_load_dwordx4 v13, s[36:39], s69 offen lds
  s_add_u32 s86, s86, 13
  v_mfma_f32_16x16x32_bf16 v[68:71], v[56:59], a[180:183], v[68:71]
  v_mov_b32 v103, 2147418112
  ds_read_b64_tr_b16 v[46:47], v7 offset:29184
  v_mfma_f32_16x16x32_bf16 v[72:75], v[56:59], a[184:187], v[72:75]
  buffer_load_dwordx4 v14, s[36:39], s69 offen offset:1024 lds
  v_mfma_f32_16x16x32_bf16 v[76:79], v[56:59], a[188:191], v[76:79]
  v_cmp_gt_u32 vcc, s86, v102
  s_nop 1
  v_cndmask_b32 v249, v103, v248, vcc
  s_cmp_ge_u32 s101, 5
  s_cbranch_scc1 k1_kernel_z92
  v_mfma_f32_16x16x32_bf16 v[80:83], v[60:63], a[176:179], v[80:83]
  v_mfma_f32_16x16x32_bf16 v[84:87], v[60:63], a[180:183], v[84:87]
  v_mfma_f32_16x16x32_bf16 v[88:91], v[60:63], a[184:187], v[88:91]
  v_mfma_f32_16x16x32_bf16 v[92:95], v[60:63], a[188:191], v[92:95]
k1_kernel_z92:
  v_bfe_u32 v250, v96, 1, 2
  ds_read_b64_tr_b16 v[48:49], v8 offset:16384
  v_xor_b32 v250, s64, v250
  ds_read_b64_tr_b16 v[50:51], v8 offset:16896
  v_and_b32 v103, 1, v96
  ds_read_b64_tr_b16 v[52:53], v8 offset:24576
  buffer_load_dwordx4 v15, s[36:39], s69 offen offset:2048 lds
  s_waitcnt lgkmcnt(3)
  v_mfma_f32_16x16x32_bf16 v[128:131], v[32:35], a[0:3], 0
  v_lshl_add_u32 v250, v103, 2, v250
  ds_read_b64_tr_b16 v[54:55], v8 offset:25088
  v_mfma_f32_16x16x32_bf16 v[128:131], v[36:39], a[16:19], v[128:131]
  v_lshlrev_b32 v250, 4, v250
  ds_read_b64_tr_b16 v[56:57], v8 offset:20480
  v_mfma_f32_16x16x32_bf16 v[132:135], v[32:35], a[4:7], 0
  v_lshl_add_u32 v250, v96, 8, v250
  ds_read_b64_tr_b16 v[58:59], v8 offset:20992
  v_mfma_f32_16x16x32_bf16 v[132:135], v[36:39], a[20:23], v[132:135]
  s_mov_b32 s99, 0x05040100
  ds_read_b64_tr_b16 v[60:61], v8 offset:28672
  v_mfma_f32_16x16x32_bf16 v[136:139], v[32:35], a[8:11], 0
  buffer_load_dwordx4 v16, s[36:39], s69 offen offset:3072 lds
  s_mov_b32 s100, 0x07060302
  v_mfma_f32_16x16x32_bf16 v[136:139], v[36:39], a[24:27], v[136:139]
  s_mov_b32 s77, 0xbfb8aa3b
  ds_read_b64_tr_b16 v[62:63], v8 offset:29184
  v_mfma_f32_16x16x32_bf16 v[140:143], v[32:35], a[12:15], 0
  s_and_b32 s84, s68, 1
  s_xor_b32 s87, s84, s66
  v_mfma_f32_16x16x32_bf16 v[140:143], v[36:39], a[28:31], v[140:143]
  ds_read_b128 v[32:35], v25 offset:0
  s_lshl_b32 s87, s87, 12
  v_mfma_f32_16x16x32_bf16 v[144:147], v[40:43], a[0:3], 0
  s_lshl_b32 s84, s65, 13
  v_add_u32 v27, s84, v21
  v_mfma_f32_16x16x32_bf16 v[144:147], v[44:47], a[16:19], v[144:147]
  s_add_u32 s69, s69, 128
  s_add_u32 m0, s74, 98304
  s_nop 0
  buffer_load_dwordx4 v17, s[40:43], s73 offen lds
  v_mfma_f32_16x16x32_bf16 v[148:151], v[40:43], a[4:7], 0
  v_add_u32 v29, 81920, v1
  v_add_u32 v26, s87, v27
  v_mfma_f32_16x16x32_bf16 v[148:151], v[44:47], a[20:23], v[148:151]
  buffer_load_dwordx4 v18, s[40:43], s73 offen offset:1024 lds
  v_mfma_f32_16x16x32_bf16 v[152:155], v[40:43], a[8:11], 0
  s_lshl_b32 s87, s66, 3
  v_xor_b32 v30, 64, v29
  v_mfma_f32_16x16x32_bf16 v[152:155], v[44:47], a[24:27], v[152:155]
  ds_read_b128 v[36:39], v25 offset:1024
  s_lshl_b32 s84, s67, 1
  v_mfma_f32_16x16x32_bf16 v[156:159], v[40:43], a[12:15], 0
  s_waitcnt vmcnt(10)
  s_barrier
  v_mfma_f32_16x16x32_bf16 v[156:159], v[44:47], a[28:31], v[156:159]
  s_add_u32 s84, s84, s65
  s_waitcnt lgkmcnt(2)
  v_mfma_f32_16x16x32_bf16 v[160:163], v[48:51], a[0:3], 0
  buffer_load_dwordx4 v19, s[40:43], s73 offen offset:2048 lds
  s_mul_i32 s81, s84, 1179648
  v_mfma_f32_16x16x32_bf16 v[160:163], v[52:55], a[16:19], v[160:163]
  s_lshl_b32 s84, s66, 16
  ds_read_b128 a[192:195], v29 offset:0
  v_mfma_f32_16x16x32_bf16 v[164:167], v[48:51], a[4:7], 0
  s_add_u32 s81, s81, s84
  ds_read_b128 a[196:199], v29 offset:4096
  v_mfma_f32_16x16x32_bf16 v[164:167], v[52:55], a[20:23], v[164:167]
  s_lshl_b32 s84, s68, 11
  ds_read_b128 a[200:203], v29 offset:8192
  v_mfma_f32_16x16x32_bf16 v[168:171], v[48:51], a[8:11], 0
  s_add_u32 s81, s81, s84
  ds_read_b128 a[204:207], v29 offset:12288
  v_mfma_f32_16x16x32_bf16 v[168:171], v[52:55], a[24:27], v[168:171]
  buffer_load_dwordx4 v20, s[40:43], s73 offen offset:3072 lds
  s_lshl_b32 s84, s3, 1
  v_mfma_f32_16x16x32_bf16 v[172:175], v[48:51], a[12:15], 0
  s_add_u32 s84, s84, s66
  ds_read_b128 a[208:211], v30 offset:0
  v_mfma_f32_16x16x32_bf16 v[172:175], v[52:55], a[28:31], v[172:175]
  s_lshl_b32 s82, s84, 16
  ds_read_b128 a[212:215], v30 offset:4096
  v_mfma_f32_16x16x32_bf16 v[176:179], v[56:59], a[0:3], 0
  s_waitcnt vmcnt(8)
  s_barrier
  ds_read_b128 v[40:43], v25 offset:4096
  s_lshl_b32 s85, s67, 9
  v_mfma_f32_16x16x32_bf16 v[176:179], v[60:63], a[16:19], v[176:179]
  s_add_u32 s82, s82, s85
  ds_read_b128 a[216:219], v30 offset:8192
  v_mfma_f32_16x16x32_bf16 v[180:183], v[56:59], a[4:7], 0
  s_add_u32 s73, s73, 589824
  s_add_u32 m0, s74, 65536
  s_nop 0
  buffer_load_dwordx4 v13, s[36:39], s69 offen lds
  v_mfma_f32_16x16x32_bf16 v[180:183], v[60:63], a[20:23], v[180:183]
  s_add_u32 s82, s82, 56623104
  ds_read_b128 a[220:223], v30 offset:12288
  v_mfma_f32_16x16x32_bf16 v[184:187], v[56:59], a[8:11], 0
  ds_read_b128 v[44:47], v25 offset:5120
  s_add_u32 s83, s82, 2097152
  v_mfma_f32_16x16x32_bf16 v[184:187], v[60:63], a[24:27], v[184:187]
  ds_read_b64_tr_b16 v[48:49], v7 offset:32768
  v_mfma_f32_16x16x32_bf16 v[188:191], v[56:59], a[12:15], 0
  buffer_load_dwordx4 v14, s[36:39], s69 offen offset:1024 lds
  s_cmp_lt_u32 s84, 5
  s_cselect_b32 s83, s83, 2147418112
  v_mfma_f32_16x16x32_bf16 v[188:191], v[60:63], a[28:31], v[188:191]
  v_lshlrev_b32 v102, 3, v21
  s_waitcnt lgkmcnt(4)
  v_mfma_f32_16x16x32_bf16 v[64:67], v[32:35], a[192:195], v[64:67]
  ds_read_b64_tr_b16 v[50:51], v7 offset:33280
  v_mov_b32 v0, 2147418112
  v_mfma_f32_16x16x32_bf16 v[68:71], v[32:35], a[196:199], v[68:71]
  ds_read_b64_tr_b16 v[52:53], v7 offset:40960
  v_mfma_f32_16x16x32_bf16 v[72:75], v[32:35], a[200:203], v[72:75]
  v_cmp_gt_u32 vcc, 2688, v102
  s_nop 1
  v_cndmask_b32 v0, v0, v102, vcc
  v_mfma_f32_16x16x32_bf16 v[76:79], v[32:35], a[204:207], v[76:79]
  buffer_load_dwordx4 v15, s[36:39], s69 offen offset:2048 lds
  s_lshl_b32 s78, s68, 4
  s_cmp_ge_u32 s101, 5
  s_cbranch_scc1 k1_kernel_z132
  v_mfma_f32_16x16x32_bf16 v[80:83], v[36:39], a[192:195], v[80:83]
  v_mfma_f32_16x16x32_bf16 v[84:87], v[36:39], a[196:199], v[84:87]
  v_mfma_f32_16x16x32_bf16 v[88:91], v[36:39], a[200:203], v[88:91]
  v_mfma_f32_16x16x32_bf16 v[92:95], v[36:39], a[204:207], v[92:95]
k1_kernel_z132:
  ds_read_b64_tr_b16 v[54:55], v7 offset:41472
  s_and_b32 s86, s67, 15
  s_add_u32 s78, s78, s86
  ds_read_b64_tr_b16 v[56:57], v7 offset:36864
  s_lshl2_add_u32 s78, s78, s64
  ds_read_b64_tr_b16 v[58:59], v7 offset:37376
  ds_read_b64_tr_b16 v[60:61], v7 offset:45056
  s_mul_i32 s78, s78, 5184
  s_waitcnt lgkmcnt(8)
  v_mfma_f32_16x16x32_bf16 v[64:67], v[40:43], a[208:211], v[64:67]
  buffer_load_dwordx4 v16, s[36:39], s69 offen offset:3072 lds
  v_mfma_f32_16x16x32_bf16 v[68:71], v[40:43], a[212:215], v[68:71]
  ds_read_b64_tr_b16 v[62:63], v7 offset:45568
  v_mfma_f32_16x16x32_bf16 v[72:75], v[40:43], a[216:219], v[72:75]
  ds_read_b64_tr_b16 v[32:33], v8 offset:32768
  v_mfma_f32_16x16x32_bf16 v[76:79], v[40:43], a[220:223], v[76:79]
  ds_read_b64_tr_b16 v[34:35], v8 offset:33280
  s_waitcnt lgkmcnt(4)
  s_cmp_ge_u32 s101, 5
  s_cbranch_scc1 k1_kernel_z140
  v_mfma_f32_16x16x32_bf16 v[80:83], v[44:47], a[208:211], v[80:83]
  v_mfma_f32_16x16x32_bf16 v[84:87], v[44:47], a[212:215], v[84:87]
  v_mfma_f32_16x16x32_bf16 v[88:91], v[44:47], a[216:219], v[88:91]
  v_mfma_f32_16x16x32_bf16 v[92:95], v[44:47], a[220:223], v[92:95]
k1_kernel_z140:
  s_add_u32 m0, s74, 114688
  s_nop 0
  buffer_load_dwordx4 v17, s[40:43], s73 offen lds
  ds_read_b64_tr_b16 v[36:37], v8 offset:40960
  ds_read_b64_tr_b16 v[38:39], v8 offset:41472
  ds_read_b64_tr_b16 v[40:41], v8 offset:36864
  v_mfma_f32_16x16x32_bf16 v[128:131], v[48:51], a[32:35], v[128:131]
  v_mfma_f32_16x16x32_bf16 v[128:131], v[52:55], a[48:51], v[128:131]
  buffer_load_dwordx4 v18, s[40:43], s73 offen offset:1024 lds
  v_mfma_f32_16x16x32_bf16 v[132:135], v[48:51], a[36:39], v[132:135]
  ds_read_b64_tr_b16 v[42:43], v8 offset:37376
  v_mfma_f32_16x16x32_bf16 v[132:135], v[52:55], a[52:55], v[132:135]
  ds_read_b64_tr_b16 v[44:45], v8 offset:45056
  v_mfma_f32_16x16x32_bf16 v[136:139], v[48:51], a[40:43], v[136:139]
  v_mfma_f32_16x16x32_bf16 v[136:139], v[52:55], a[56:59], v[136:139]
  ds_read_b64_tr_b16 v[46:47], v8 offset:45568
  v_mfma_f32_16x16x32_bf16 v[140:143], v[48:51], a[44:47], v[140:143]
  buffer_load_dwordx4 v19, s[40:43], s73 offen offset:2048 lds
  v_mfma_f32_16x16x32_bf16 v[140:143], v[52:55], a[60:63], v[140:143]
  ds_read_b128 v[48:51], v25 offset:8192
  v_mfma_f32_16x16x32_bf16 v[144:147], v[56:59], a[32:35], v[144:147]
  s_waitcnt lgkmcnt(3)
  v_mfma_f32_16x16x32_bf16 v[144:147], v[60:63], a[48:51], v[144:147]
  v_mfma_f32_16x16x32_bf16 v[148:151], v[56:59], a[36:39], v[148:151]
  v_add_u32 v29, 49152, v1
  v_mfma_f32_16x16x32_bf16 v[148:151], v[60:63], a[52:55], v[148:151]
  buffer_load_dwordx4 v20, s[40:43], s73 offen offset:3072 lds
  v_mfma_f32_16x16x32_bf16 v[152:155], v[56:59], a[40:43], v[152:155]
  v_xor_b32 v30, 64, v29
  ds_read_b128 v[52:55], v25 offset:9216
  v_mfma_f32_16x16x32_bf16 v[152:155], v[60:63], a[56:59], v[152:155]
  v_mfma_f32_16x16x32_bf16 v[156:159], v[56:59], a[44:47], v[156:159]
  s_waitcnt vmcnt(12)
  s_barrier
  v_mfma_f32_16x16x32_bf16 v[156:159], v[60:63], a[60:63], v[156:159]
  ds_read_b128 a[224:227], v29 offset:0
  ds_read_b128 v[56:59], v25 offset:12288
  v_mfma_f32_16x16x32_bf16 v[160:163], v[32:35], a[32:35], v[160:163]
  s_add_u32 s73, s73, 589824
  s_add_u32 m0, s74, 0
  s_nop 0
  buffer_load_dwordx4 v17, s[40:43], s73 offen lds
  v_mfma_f32_16x16x32_bf16 v[160:163], v[36:39], a[48:51], v[160:163]
  ds_read_b128 a[228:231], v29 offset:4096
  v_mfma_f32_16x16x32_bf16 v[164:167], v[32:35], a[36:39], v[164:167]
  ds_read_b128 a[232:235], v29 offset:8192
  v_mfma_f32_16x16x32_bf16 v[164:167], v[36:39], a[52:55], v[164:167]
  ds_read_b128 a[236:239], v29 offset:12288
  ds_read_b128 v[60:63], v25 offset:13312
  v_mfma_f32_16x16x32_bf16 v[168:171], v[32:35], a[40:43], v[168:171]
  buffer_load_dwordx4 v18, s[40:43], s73 offen offset:1024 lds
  v_mfma_f32_16x16x32_bf16 v[168:171], v[36:39], a[56:59], v[168:171]
  ds_read_b128 a[240:243], v30 offset:0
  v_mfma_f32_16x16x32_bf16 v[172:175], v[32:35], a[44:47], v[172:175]
  s_waitcnt vmcnt(10)
  s_barrier
  v_mfma_f32_16x16x32_bf16 v[172:175], v[36:39], a[60:63], v[172:175]
  ds_read_b128 a[244:247], v30 offset:4096
  ds_read_b64_tr_b16 v[32:33], v9 offset:32768
  v_mfma_f32_16x16x32_bf16 v[176:179], v[40:43], a[32:35], v[176:179]
  ds_read_b128 a[248:251], v30 offset:8192
  s_waitcnt lgkmcnt(8)
  v_mfma_f32_16x16x32_bf16 v[176:179], v[44:47], a[48:51], v[176:179]
  buffer_load_dwordx4 v19, s[40:43], s73 offen offset:2048 lds
  v_mfma_f32_16x16x32_bf16 v[180:183], v[40:43], a[36:39], v[180:183]
  ds_read_b128 a[252:255], v30 offset:12288
  ds_read_b64_tr_b16 v[34:35], v9 offset:33280
  v_mfma_f32_16x16x32_bf16 v[180:183], v[44:47], a[52:55], v[180:183]
  ds_read_b64_tr_b16 v[36:37], v9 offset:40960
  v_mfma_f32_16x16x32_bf16 v[184:187], v[40:43], a[40:43], v[184:187]
  v_mfma_f32_16x16x32_bf16 v[184:187], v[44:47], a[56:59], v[184:187]
  ds_read_b64_tr_b16 v[38:39], v9 offset:41472
  v_mfma_f32_16x16x32_bf16 v[188:191], v[40:43], a[44:47], v[188:191]
  buffer_load_dwordx4 v20, s[40:43], s73 offen offset:3072 lds
  v_mfma_f32_16x16x32_bf16 v[188:191], v[44:47], a[60:63], v[188:191]
  ds_read_b64_tr_b16 v[40:41], v9 offset:36864
  s_waitcnt lgkmcnt(10)
  v_mfma_f32_16x16x32_bf16 v[64:67], v[48:51], a[224:227], v[64:67]
  s_mov_b32 s86, 0x3020100
  v_writelane_b32 v31, s86, 0
  v_mfma_f32_16x16x32_bf16 v[68:71], v[48:51], a[228:231], v[68:71]
  ds_read_b64_tr_b16 v[42:43], v9 offset:37376
  v_mfma_f32_16x16x32_bf16 v[72:75], v[48:51], a[232:235], v[72:75]
k1_pg1:
  s_cbranch_execz k1_pg5
  s_mov_b32 s86, 0x21200504
  v_writelane_b32 v31, s86, 1
  v_mfma_f32_16x16x32_bf16 v[76:79], v[48:51], a[236:239], v[76:79]
  s_add_u32 s73, s73, 589824
  s_add_u32 m0, s74, 16384
  s_nop 0
  buffer_load_dwordx4 v17, s[40:43], s73 offen lds
  s_cmp_ge_u32 s101, 5
  s_cbranch_scc1 k1_kernel_z180
  v_mfma_f32_16x16x32_bf16 v[80:83], v[52:55], a[224:227], v[80:83]
  v_mfma_f32_16x16x32_bf16 v[84:87], v[52:55], a[228:231], v[84:87]
  v_mfma_f32_16x16x32_bf16 v[88:91], v[52:55], a[232:235], v[88:91]
  v_mfma_f32_16x16x32_bf16 v[92:95], v[52:55], a[236:239], v[92:95]
k1_kernel_z180:
  ds_read_b64_tr_b16 v[44:45], v9 offset:45056
  ds_read_b64_tr_b16 v[46:47], v9 offset:45568
  s_mov_b32 s86, 0x25242322
  v_writelane_b32 v31, s86, 2
  buffer_load_dwordx4 v18, s[40:43], s73 offen offset:1024 lds
  s_waitcnt lgkmcnt(7)
  v_mfma_f32_16x16x32_bf16 v[64:67], v[56:59], a[240:243], v[64:67]
  ds_read_b64_tr_b16 v[48:49], v10 offset:32768
  v_mfma_f32_16x16x32_bf16 v[68:71], v[56:59], a[244:247], v[68:71]
  ds_read_b64_tr_b16 v[50:51], v10 offset:33280
  v_mfma_f32_16x16x32_bf16 v[72:75], v[56:59], a[248:251], v[72:75]
  s_mov_b32 s86, 0xe0f1011
  v_writelane_b32 v31, s86, 3
  v_mfma_f32_16x16x32_bf16 v[76:79], v[56:59], a[252:255], v[76:79]
  ds_read_b64_tr_b16 v[52:53], v10 offset:40960
  s_cmp_ge_u32 s101, 5
  s_cbranch_scc1 k1_kernel_z188
  v_mfma_f32_16x16x32_bf16 v[80:83], v[60:63], a[240:243], v[80:83]
  v_mfma_f32_16x16x32_bf16 v[84:87], v[60:63], a[244:247], v[84:87]
  v_mfma_f32_16x16x32_bf16 v[88:91], v[60:63], a[248:251], v[88:91]
  v_mfma_f32_16x16x32_bf16 v[92:95], v[60:63], a[252:255], v[92:95]
k1_kernel_z188:
  buffer_load_dwordx4 v19, s[40:43], s73 offen offset:2048 lds
  ds_read_b64_tr_b16 v[54:55], v10 offset:41472
  s_mov_b32 s86, 0x2e2f3031
  v_writelane_b32 v31, s86, 4
  ds_read_b64_tr_b16 v[56:57], v10 offset:36864
  s_waitcnt lgkmcnt(5)
  v_mfma_f32_16x16x32_bf16 v[128:131], v[32:35], a[64:67], v[128:131]
  s_mov_b32 s86, 0x43424140
  v_writelane_b32 v31, s86, 5
  v_mfma_f32_16x16x32_bf16 v[128:131], v[36:39], a[80:83], v[128:131]
  buffer_load_dwordx4 v20, s[40:43], s73 offen offset:3072 lds
  v_mfma_f32_16x16x32_bf16 v[132:135], v[32:35], a[68:71], v[132:135]
  ds_read_b64_tr_b16 v[58:59], v10 offset:37376
  v_mfma_f32_16x16x32_bf16 v[132:135], v[36:39], a[84:87], v[132:135]
  ds_read_b64_tr_b16 v[60:61], v10 offset:45056
  v_mfma_f32_16x16x32_bf16 v[136:139], v[32:35], a[72:75], v[136:139]
  s_mov_b32 s86, 0x50514544
  v_writelane_b32 v31, s86, 6
  v_mfma_f32_16x16x32_bf16 v[136:139], v[36:39], a[88:91], v[136:139]
  ds_read_b64_tr_b16 v[62:63], v10 offset:45568
  v_mfma_f32_16x16x32_bf16 v[140:143], v[32:35], a[76:79], v[140:143]
  s_add_u32 s73, s73, 589824
  s_add_u32 m0, s74, 81920
  s_nop 0
  buffer_load_dwordx4 v17, s[40:43], s73 offen lds
  v_mfma_f32_16x16x32_bf16 v[140:143], v[36:39], a[92:95], v[140:143]
  ds_read_b128 v[32:35], v25 offset:16384
  v_mfma_f32_16x16x32_bf16 v[144:147], v[40:43], a[64:67], v[144:147]
  s_mov_b32 s86, 0x61604e4f
  v_writelane_b32 v31, s86, 7
  v_mfma_f32_16x16x32_bf16 v[144:147], v[44:47], a[80:83], v[144:147]
  s_mov_b32 s86, 0x63628180
  v_writelane_b32 v31, s86, 8
  v_mfma_f32_16x16x32_bf16 v[148:151], v[40:43], a[68:71], v[148:151]
  buffer_load_dwordx4 v18, s[40:43], s73 offen offset:1024 lds
  v_mfma_f32_16x16x32_bf16 v[148:151], v[44:47], a[84:87], v[148:151]
  v_add_u32 v29, 65536, v1
  ds_read_b128 v[36:39], v25 offset:17408
  v_mfma_f32_16x16x32_bf16 v[152:155], v[40:43], a[72:75], v[152:155]
  v_xor_b32 v30, 64, v29
  v_mfma_f32_16x16x32_bf16 v[152:155], v[44:47], a[88:91], v[152:155]
  s_mov_b32 s86, 0x65648382
  v_writelane_b32 v31, s86, 9
  v_mfma_f32_16x16x32_bf16 v[156:159], v[40:43], a[76:79], v[156:159]
  s_waitcnt vmcnt(14)
  s_barrier
  v_mfma_f32_16x16x32_bf16 v[156:159], v[44:47], a[92:95], v[156:159]
  buffer_load_dwordx4 v19, s[40:43], s73 offen offset:2048 lds
  s_waitcnt lgkmcnt(2)
  v_mfma_f32_16x16x32_bf16 v[160:163], v[48:51], a[64:67], v[160:163]
  ds_read_b128 v[192:195], v29 offset:0
  ds_read_b128 v[40:43], v25 offset:20480
  v_mfma_f32_16x16x32_bf16 v[160:163], v[52:55], a[80:83], v[160:163]
  ds_read_b128 v[196:199], v29 offset:4096
  v_mfma_f32_16x16x32_bf16 v[164:167], v[48:51], a[68:71], v[164:167]
  ds_read_b128 v[200:203], v29 offset:8192
  v_mfma_f32_16x16x32_bf16 v[164:167], v[52:55], a[84:87], v[164:167]
  ds_read_b128 v[204:207], v29 offset:12288
  ds_read_b128 v[44:47], v25 offset:21504
  v_mfma_f32_16x16x32_bf16 v[168:171], v[48:51], a[72:75], v[168:171]
  buffer_load_dwordx4 v20, s[40:43], s73 offen offset:3072 lds
  v_mfma_f32_16x16x32_bf16 v[168:171], v[52:55], a[88:91], v[168:171]
  ds_read_b128 v[208:211], v30 offset:0
  v_mfma_f32_16x16x32_bf16 v[172:175], v[48:51], a[76:79], v[172:175]
  s_waitcnt vmcnt(12)
  s_barrier
  v_mfma_f32_16x16x32_bf16 v[172:175], v[52:55], a[92:95], v[172:175]
  ds_read_b128 v[212:215], v30 offset:4096
  ds_read_b64_tr_b16 v[48:49], v9 offset:49152
  v_mfma_f32_16x16x32_bf16 v[176:179], v[56:59], a[64:67], v[176:179]
  ds_read_b128 v[216:219], v30 offset:8192
  v_mfma_f32_16x16x32_bf16 v[176:179], v[60:63], a[80:83], v[176:179]
  s_add_u32 s73, s73, 589824
  s_add_u32 m0, s74, 131072
  s_nop 0
  buffer_load_dwordx4 v17, s[40:43], s73 offen lds
  v_mfma_f32_16x16x32_bf16 v[180:183], v[56:59], a[68:71], v[180:183]
  ds_read_b128 v[220:223], v30 offset:12288
  ds_read_b64_tr_b16 v[50:51], v9 offset:49664
  v_mfma_f32_16x16x32_bf16 v[180:183], v[60:63], a[84:87], v[180:183]
  ds_read_b64_tr_b16 v[52:53], v9 offset:57344
  v_mfma_f32_16x16x32_bf16 v[184:187], v[56:59], a[72:75], v[184:187]
  s_mov_b32 s86, 0x70718584
  v_writelane_b32 v31, s86, 10
  v_mfma_f32_16x16x32_bf16 v[184:187], v[60:63], a[88:91], v[184:187]
  buffer_load_dwordx4 v18, s[40:43], s73 offen offset:1024 lds
  v_mfma_f32_16x16x32_bf16 v[188:191], v[56:59], a[76:79], v[188:191]
  ds_read_b64_tr_b16 v[54:55], v9 offset:57856
  v_mfma_f32_16x16x32_bf16 v[188:191], v[60:63], a[92:95], v[188:191]
  ds_read_b64_tr_b16 v[56:57], v9 offset:53248
  s_waitcnt lgkmcnt(9)
  v_mfma_f32_16x16x32_bf16 v[64:67], v[32:35], v[192:195], v[64:67]
  s_mov_b32 s86, 0x6e6f9091
  v_writelane_b32 v31, s86, 11
  v_mfma_f32_16x16x32_bf16 v[68:71], v[32:35], v[196:199], v[68:71]
  ds_read_b64_tr_b16 v[58:59], v9 offset:53760
  v_mfma_f32_16x16x32_bf16 v[72:75], v[32:35], v[200:203], v[72:75]
  buffer_load_dwordx4 v19, s[40:43], s73 offen offset:2048 lds
  v_mfma_f32_16x16x32_bf16 v[76:79], v[32:35], v[204:207], v[76:79]
  ds_read_b64_tr_b16 v[60:61], v9 offset:61440
  s_cmp_ge_u32 s101, 5
  s_cbranch_scc1 k1_kernel_z228
  v_mfma_f32_16x16x32_bf16 v[80:83], v[36:39], v[192:195], v[80:83]
  v_mfma_f32_16x16x32_bf16 v[84:87], v[36:39], v[196:199], v[84:87]
  v_mfma_f32_16x16x32_bf16 v[88:91], v[36:39], v[200:203], v[88:91]
  v_mfma_f32_16x16x32_bf16 v[92:95], v[36:39], v[204:207], v[92:95]
k1_kernel_z228:
  s_mov_b32 s86, 0x7068e8f
  v_writelane_b32 v31, s86, 12
  ds_read_b64_tr_b16 v[62:63], v9 offset:61952
  s_mov_b32 s86, 0x47462726
  v_writelane_b32 v31, s86, 13
  buffer_load_dwordx4 v20, s[40:43], s73 offen offset:3072 lds
  s_waitcnt lgkmcnt(7)
  v_mfma_f32_16x16x32_bf16 v[64:67], v[40:43], v[208:211], v[64:67]
  ds_read_b64_tr_b16 v[32:33], v10 offset:49152
  v_mfma_f32_16x16x32_bf16 v[68:71], v[40:43], v[212:215], v[68:71]
  ds_read_b64_tr_b16 v[34:35], v10 offset:49664
  v_mfma_f32_16x16x32_bf16 v[72:75], v[40:43], v[216:219], v[72:75]
  s_mov_b32 s86, 0x87866766
  v_writelane_b32 v31, s86, 14
  v_mfma_f32_16x16x32_bf16 v[76:79], v[40:43], v[220:223], v[76:79]
  ds_read_b64_tr_b16 v[36:37], v10 offset:57344
  s_cmp_ge_u32 s101, 5
  s_cbranch_scc1 k1_kernel_z236
  v_mfma_f32_16x16x32_bf16 v[80:83], v[44:47], v[208:211], v[80:83]
  v_mfma_f32_16x16x32_bf16 v[84:87], v[44:47], v[212:215], v[84:87]
  v_mfma_f32_16x16x32_bf16 v[88:91], v[44:47], v[216:219], v[88:91]
  v_mfma_f32_16x16x32_bf16 v[92:95], v[44:47], v[220:223], v[92:95]
k1_kernel_z236:
  s_add_u32 s73, s73, 589824
  s_add_u32 s72, s72, s95
  s_add_u32 s72, s72, 4718592
  buffer_load_dword v253, v254, s[40:43], s72 offen
  ds_read_b64_tr_b16 v[38:39], v10 offset:57856
  s_mov_b32 s86, 0x2d280d08
  v_writelane_b32 v31, s86, 15
  ds_read_b64_tr_b16 v[40:41], v10 offset:53248
  s_waitcnt lgkmcnt(5)
  v_mfma_f32_16x16x32_bf16 v[128:131], v[48:51], a[96:99], v[128:131]
  buffer_load_dwordx2 v[224:225], v251, s[52:55], s91 offen
  v_mfma_f32_16x16x32_bf16 v[128:131], v[52:55], a[112:115], v[128:131]
  ds_read_b64_tr_b16 v[42:43], v10 offset:53760
  v_mfma_f32_16x16x32_bf16 v[132:135], v[48:51], a[100:103], v[132:135]
  buffer_load_dwordx2 v[226:227], v251, s[56:59], s91 offen
  v_mfma_f32_16x16x32_bf16 v[132:135], v[52:55], a[116:119], v[132:135]
  ds_read_b64_tr_b16 v[44:45], v10 offset:61440
  v_cvt_pk_bf16_f32 v64, v64, v65
  v_mfma_f32_16x16x32_bf16 v[136:139], v[48:51], a[104:107], v[136:139]
  s_mov_b32 s86, 0x2b2c0b0c
  v_writelane_b32 v31, s86, 16
  v_mfma_f32_16x16x32_bf16 v[136:139], v[52:55], a[120:123], v[136:139]
  ds_read_b64_tr_b16 v[46:47], v10 offset:61952
  s_mov_b32 s60, s32
  v_mfma_f32_16x16x32_bf16 v[140:143], v[48:51], a[108:111], v[140:143]
  s_waitcnt vmcnt(15)
  s_barrier
  v_mfma_f32_16x16x32_bf16 v[140:143], v[52:55], a[124:127], v[140:143]
  ds_read_b64_tr_b16 v[48:49], v7 offset:0
  s_and_b32 s61, s33, 0xffff
  v_mfma_f32_16x16x32_bf16 v[144:147], v[56:59], a[96:99], v[144:147]
  buffer_load_dwordx2 v[228:229], v251, s[52:55], s92 offen
  v_mfma_f32_16x16x32_bf16 v[144:147], v[60:63], a[112:115], v[144:147]
  ds_read_b64_tr_b16 v[50:51], v7 offset:512
  s_mov_b32 s62, 256
  v_mfma_f32_16x16x32_bf16 v[148:151], v[56:59], a[100:103], v[148:151]
  buffer_load_dwordx2 v[230:231], v251, s[56:59], s92 offen
  v_mfma_f32_16x16x32_bf16 v[148:151], v[60:63], a[116:119], v[148:151]
  ds_read_b64_tr_b16 v[52:53], v7 offset:8192
  s_mov_b32 s63, 0x20000
  v_mfma_f32_16x16x32_bf16 v[152:155], v[56:59], a[104:107], v[152:155]
  buffer_load_dwordx2 v[232:233], v251, s[52:55], s93 offen
  v_mfma_f32_16x16x32_bf16 v[152:155], v[60:63], a[120:123], v[152:155]
  ds_read_b64_tr_b16 v[54:55], v7 offset:8704
  s_lshl_b32 s16, s2, 13
  v_mfma_f32_16x16x32_bf16 v[156:159], v[56:59], a[108:111], v[156:159]
  buffer_load_dwordx2 v[234:235], v251, s[56:59], s93 offen
  v_mfma_f32_16x16x32_bf16 v[156:159], v[60:63], a[124:127], v[156:159]
  ds_read_b64_tr_b16 v[56:57], v7 offset:4096
  s_waitcnt lgkmcnt(5)
  v_mfma_f32_16x16x32_bf16 v[160:163], v[32:35], a[96:99], v[160:163]
  s_mov_b32 s86, 0x292a090a
  v_writelane_b32 v31, s86, 17
  v_mfma_f32_16x16x32_bf16 v[160:163], v[36:39], a[112:115], v[160:163]
  ds_read_b64_tr_b16 v[58:59], v7 offset:4608
  s_add_u32 s18, s16, 62914560
  v_mfma_f32_16x16x32_bf16 v[164:167], v[32:35], a[100:103], v[164:167]
  buffer_load_dwordx2 v[236:237], v251, s[52:55], s94 offen
  v_mfma_f32_16x16x32_bf16 v[164:167], v[36:39], a[116:119], v[164:167]
  ds_read_b64_tr_b16 v[60:61], v7 offset:12288
  s_add_u32 s16, s16, 56623104
  v_mfma_f32_16x16x32_bf16 v[168:171], v[32:35], a[104:107], v[168:171]
  buffer_load_dwordx2 v[238:239], v251, s[56:59], s94 offen
  v_mfma_f32_16x16x32_bf16 v[168:171], v[36:39], a[120:123], v[168:171]
  ds_read_b64_tr_b16 v[62:63], v7 offset:12800
  s_mul_i32 s20, s64, 589824
  v_mfma_f32_16x16x32_bf16 v[172:175], v[32:35], a[108:111], v[172:175]
  s_mov_b32 s86, 0x4b4c4d48
  v_writelane_b32 v31, s86, 18
  v_mfma_f32_16x16x32_bf16 v[172:175], v[36:39], a[124:127], v[172:175]
  ds_read_b64_tr_b16 v[32:33], v8 offset:0
  s_lshl_b32 s88, s2, 7
  v_mfma_f32_16x16x32_bf16 v[176:179], v[40:43], a[96:99], v[176:179]
  s_mov_b32 s86, 0x8d88494a
  v_writelane_b32 v31, s86, 19
  v_mfma_f32_16x16x32_bf16 v[176:179], v[44:47], a[112:115], v[176:179]
  ds_read_b64_tr_b16 v[34:35], v8 offset:512
  s_add_u32 s20, s20, s88
  v_mfma_f32_16x16x32_bf16 v[180:183], v[40:43], a[100:103], v[180:183]
  s_mov_b32 s86, 0x8b8c6d68
  v_writelane_b32 v31, s86, 20
  v_mfma_f32_16x16x32_bf16 v[180:183], v[44:47], a[116:119], v[180:183]
  ds_read_b64_tr_b16 v[36:37], v8 offset:8192
  s_add_u32 s20, s20, 59768832
  v_mfma_f32_16x16x32_bf16 v[184:187], v[40:43], a[104:107], v[184:187]
  s_mov_b32 s86, 0x898a6b6c
  v_writelane_b32 v31, s86, 21
  v_mfma_f32_16x16x32_bf16 v[184:187], v[44:47], a[120:123], v[184:187]
  ds_read_b64_tr_b16 v[38:39], v8 offset:8704
  s_add_u32 s17, s16, 2088960
  v_mfma_f32_16x16x32_bf16 v[188:191], v[40:43], a[108:111], v[188:191]
  s_mov_b32 s86, 0x6969696a
  v_writelane_b32 v31, s86, 22
  v_mfma_f32_16x16x32_bf16 v[188:191], v[44:47], a[124:127], v[188:191]
  ds_read_b64_tr_b16 v[40:41], v8 offset:4096
  s_waitcnt lgkmcnt(5)
  v_mfma_f32_16x16x32_bf16 v[128:131], v[48:51], a[128:131], v[128:131]
  s_add_u32 s19, s18, 2088960
  s_add_u32 s21, s20, 32640
  v_mfma_f32_16x16x32_bf16 v[128:131], v[52:55], a[144:147], v[128:131]
  ds_read_b64_tr_b16 v[42:43], v8 offset:4608
  s_lshl_b32 s26, s2, 7
  v_mfma_f32_16x16x32_bf16 v[132:135], v[48:51], a[132:135], v[132:135]
  s_cmp_le_u32 s2, 32
  s_cselect_b32 s17, s17, 2147418112
  s_cselect_b32 s19, s19, 2147418112
  s_cselect_b32 s21, s21, 2147418112
  v_mfma_f32_16x16x32_bf16 v[132:135], v[52:55], a[148:151], v[132:135]
  ds_read_b64_tr_b16 v[44:45], v8 offset:12288
  s_add_u32 s26, s26, 66584576
  v_mfma_f32_16x16x32_bf16 v[136:139], v[48:51], a[136:139], v[136:139]
  s_cmp_eq_u32 s2, 0
  s_cselect_b32 s17, 58990592, s17
  s_cselect_b32 s19, 65273856, s19
  s_cselect_b32 s21, 2147418112, s21
  v_mfma_f32_16x16x32_bf16 v[136:139], v[52:55], a[152:155], v[136:139]
  ds_read_b64_tr_b16 v[46:47], v8 offset:12800
  v_mov_b32 v104, 0
  v_mfma_f32_16x16x32_bf16 v[140:143], v[48:51], a[140:143], v[140:143]
  s_waitcnt vmcnt(17)
  s_barrier
  v_mfma_f32_16x16x32_bf16 v[140:143], v[52:55], a[156:159], v[140:143]
  ds_read_b64_tr_b16 v[48:49], v7 offset:16384
  s_lshl_b32 s86, s64, 3
  v_mfma_f32_16x16x32_bf16 v[144:147], v[56:59], a[128:131], v[144:147]
  s_cmp_eq_u32 s66, 0
  s_cselect_b32 s16, s16, s17
  v_mfma_f32_16x16x32_bf16 v[144:147], v[60:63], a[144:147], v[144:147]
  ds_read_b64_tr_b16 v[50:51], v7 offset:16896
  s_lshl_b32 s88, s65, 12
  v_mfma_f32_16x16x32_bf16 v[148:151], v[56:59], a[132:135], v[148:151]
  s_add_u32 s16, s16, s88
  v_lshrrev_b32 v31, s86, v31
  v_mfma_f32_16x16x32_bf16 v[148:151], v[60:63], a[148:151], v[148:151]
  ds_read_b64_tr_b16 v[52:53], v7 offset:24576
  v_and_b32 v109, 31, v31
  v_mfma_f32_16x16x32_bf16 v[152:155], v[56:59], a[136:139], v[152:155]
  v_and_b32 v110, 0xe0, v31
  s_and_b32 s86, s68, 1
  v_mfma_f32_16x16x32_bf16 v[152:155], v[60:63], a[152:155], v[152:155]
  ds_read_b64_tr_b16 v[54:55], v7 offset:25088
  s_mul_i32 s29, s86, 640
  v_mfma_f32_16x16x32_bf16 v[156:159], v[56:59], a[140:143], v[156:159]
  v_mov_b32 v108, s29
  v_cvt_pk_bf16_f32 v65, v68, v69
  v_mfma_f32_16x16x32_bf16 v[156:159], v[60:63], a[156:159], v[156:159]
  ds_read_b64_tr_b16 v[56:57], v7 offset:20480
  s_waitcnt lgkmcnt(5)
  v_mfma_f32_16x16x32_bf16 v[160:163], v[32:35], a[128:131], v[160:163]
  v_cmp_gt_u32 vcc, 0x80, v110
  s_nop 1
  v_cndmask_b32 v108, 0, v108, vcc
  v_mfma_f32_16x16x32_bf16 v[160:163], v[36:39], a[144:147], v[160:163]
  ds_read_b64_tr_b16 v[58:59], v7 offset:20992
  v_lshl_add_u32 v110, v110, 2, v108
  v_mfma_f32_16x16x32_bf16 v[164:167], v[32:35], a[132:135], v[164:167]
  v_mul_lo_u32 v109, v109, s76
  v_add3_u32 v31, v109, v110, s89
  v_mfma_f32_16x16x32_bf16 v[164:167], v[36:39], a[148:151], v[164:167]
  ds_read_b64_tr_b16 v[60:61], v7 offset:28672
  s_mul_i32 s24, s2, 81920
  v_mfma_f32_16x16x32_bf16 v[168:171], v[32:35], a[136:139], v[168:171]
  s_add_u32 s24, s24, 20955136
  s_xor_b32 s27, s2, 8
  v_mfma_f32_16x16x32_bf16 v[168:171], v[36:39], a[152:155], v[168:171]
  ds_read_b64_tr_b16 v[62:63], v7 offset:29184
  s_mul_i32 s25, s27, 81920
  v_mfma_f32_16x16x32_bf16 v[172:175], v[32:35], a[140:143], v[172:175]
  s_add_u32 s25, s25, 20971520
  s_add_u32 s25, s25, s74
  v_mfma_f32_16x16x32_bf16 v[172:175], v[36:39], a[156:159], v[172:175]
  ds_read_b64_tr_b16 v[32:33], v8 offset:16384
  s_add_u32 m0, s74, 32768
  v_mfma_f32_16x16x32_bf16 v[176:179], v[40:43], a[128:131], v[176:179]
  buffer_load_dwordx4 v17, s[40:43], s73 offen lds
  v_mfma_f32_16x16x32_bf16 v[176:179], v[44:47], a[144:147], v[176:179]
  ds_read_b64_tr_b16 v[34:35], v8 offset:16896
  s_lshl_b32 s27, s27, 7
  v_mfma_f32_16x16x32_bf16 v[180:183], v[40:43], a[132:135], v[180:183]
  s_add_u32 s27, s27, 66584576
  s_lshl1_add_u32 s81, s67, s65
  v_mfma_f32_16x16x32_bf16 v[180:183], v[44:47], a[148:151], v[180:183]
  ds_read_b64_tr_b16 v[36:37], v8 offset:24576
  s_mul_i32 s81, s81, 589824
  v_mfma_f32_16x16x32_bf16 v[184:187], v[40:43], a[136:139], v[184:187]
  buffer_load_dwordx4 v18, s[40:43], s73 offen offset:1024 lds
  v_mfma_f32_16x16x32_bf16 v[184:187], v[44:47], a[152:155], v[184:187]
  ds_read_b64_tr_b16 v[38:39], v8 offset:25088
  s_lshr_b32 s28, s68, 1
  v_mfma_f32_16x16x32_bf16 v[188:191], v[40:43], a[140:143], v[188:191]
  s_lshl_b32 s28, s28, 11
  s_add_u32 s81, s81, s28
  v_mfma_f32_16x16x32_bf16 v[188:191], v[44:47], a[156:159], v[188:191]
  ds_read_b64_tr_b16 v[40:41], v8 offset:20480
  s_waitcnt lgkmcnt(5)
  v_mfma_f32_16x16x32_bf16 v[128:131], v[48:51], a[160:163], v[128:131]
  s_lshl1_add_u32 s29, s86, s66
  s_add_u32 s28, s29, 16
  v_mfma_f32_16x16x32_bf16 v[128:131], v[52:55], a[176:179], v[128:131]
  ds_read_b64_tr_b16 v[42:43], v8 offset:20992
  s_lshl_b32 s28, s28, 14
  v_mfma_f32_16x16x32_bf16 v[132:135], v[48:51], a[164:167], v[132:135]
  buffer_load_dwordx4 v19, s[40:43], s73 offen offset:2048 lds
  v_mfma_f32_16x16x32_bf16 v[132:135], v[52:55], a[180:183], v[132:135]
  ds_read_b64_tr_b16 v[44:45], v8 offset:28672
  s_add_u32 s28, s28, s81
  v_mfma_f32_16x16x32_bf16 v[136:139], v[48:51], a[168:171], v[136:139]
  s_mul_i32 s86, s86, 10
  s_add_u32 s86, s86, s66
  v_mfma_f32_16x16x32_bf16 v[136:139], v[52:55], a[184:187], v[136:139]
  ds_read_b64_tr_b16 v[46:47], v8 offset:29184
  s_lshl_b32 s86, s86, 15
  v_mfma_f32_16x16x32_bf16 v[140:143], v[48:51], a[172:175], v[140:143]
  s_waitcnt vmcnt(16)
  s_barrier
  v_mfma_f32_16x16x32_bf16 v[140:143], v[52:55], a[188:191], v[140:143]
  ds_read_b64_tr_b16 v[48:49], v9 offset:16384
  s_add_u32 s81, s81, s86
  v_mfma_f32_16x16x32_bf16 v[144:147], v[56:59], a[160:163], v[144:147]
  buffer_load_dwordx4 v20, s[40:43], s73 offen offset:3072 lds
  v_mfma_f32_16x16x32_bf16 v[144:147], v[60:63], a[176:179], v[144:147]
  ds_read_b64_tr_b16 v[50:51], v9 offset:16896
  s_lshl_b32 s86, s66, 1
  v_mfma_f32_16x16x32_bf16 v[148:151], v[56:59], a[164:167], v[148:151]
  s_xor_b32 s29, s29, s86
  s_lshl_b32 s29, s29, 5
  v_mfma_f32_16x16x32_bf16 v[148:151], v[60:63], a[180:183], v[148:151]
  ds_read_b64_tr_b16 v[52:53], v9 offset:24576
  s_add_u32 s73, s73, s95
  v_mfma_f32_16x16x32_bf16 v[152:155], v[56:59], a[168:171], v[152:155]
  s_add_u32 m0, s74, 49152
  v_mov_b32 v23, v3
  v_mfma_f32_16x16x32_bf16 v[152:155], v[60:63], a[184:187], v[152:155]
  ds_read_b64_tr_b16 v[54:55], v9 offset:25088
  v_add_u32 v24, 65536, v23
  v_mfma_f32_16x16x32_bf16 v[156:159], v[56:59], a[172:175], v[156:159]
  buffer_load_dwordx4 v17, s[40:43], s73 offen lds
  v_mfma_f32_16x16x32_bf16 v[156:159], v[60:63], a[188:191], v[156:159]
  ds_read_b64_tr_b16 v[56:57], v9 offset:20480
  s_waitcnt lgkmcnt(5)
  v_mfma_f32_16x16x32_bf16 v[160:163], v[32:35], a[160:163], v[160:163]
  buffer_load_dwordx4 v18, s[40:43], s73 offen offset:1024 lds
  v_mfma_f32_16x16x32_bf16 v[160:163], v[36:39], a[176:179], v[160:163]
  ds_read_b64_tr_b16 v[58:59], v9 offset:20992
  v_add_u32 v25, 131072, v23
  v_mfma_f32_16x16x32_bf16 v[164:167], v[32:35], a[164:167], v[164:167]
  v_lshrrev_b32 v29, 8, v21
  v_lshlrev_b32 v29, 9, v29
  v_mfma_f32_16x16x32_bf16 v[164:167], v[36:39], a[180:183], v[164:167]
  ds_read_b64_tr_b16 v[60:61], v9 offset:28672
  v_sub_u32 v1, v7, v29
  v_mfma_f32_16x16x32_bf16 v[168:171], v[32:35], a[168:171], v[168:171]
  buffer_load_dwordx4 v19, s[40:43], s73 offen offset:2048 lds
  v_mfma_f32_16x16x32_bf16 v[168:171], v[36:39], a[184:187], v[168:171]
  ds_read_b64_tr_b16 v[62:63], v9 offset:29184
  v_sub_u32 v2, v8, v29
  v_mfma_f32_16x16x32_bf16 v[172:175], v[32:35], a[172:175], v[172:175]
  v_sub_u32 v3, v9, v29
  v_sub_u32 v4, v10, v29
  v_mfma_f32_16x16x32_bf16 v[172:175], v[36:39], a[188:191], v[172:175]
  ds_read_b64_tr_b16 v[32:33], v10 offset:16384
  v_sub_u32 v5, v11, v29
  v_mfma_f32_16x16x32_bf16 v[176:179], v[40:43], a[160:163], v[176:179]
  v_sub_u32 v6, v12, v29
  v_lshrrev_b32 v29, 6, v21
  v_mfma_f32_16x16x32_bf16 v[176:179], v[44:47], a[176:179], v[176:179]
  ds_read_b64_tr_b16 v[34:35], v10 offset:16896
  v_mul_u32_u24 v13, 9216, v29
  v_mfma_f32_16x16x32_bf16 v[180:183], v[40:43], a[164:167], v[180:183]
  buffer_load_dwordx4 v20, s[40:43], s73 offen offset:3072 lds
  v_mfma_f32_16x16x32_bf16 v[180:183], v[44:47], a[180:183], v[180:183]
  ds_read_b64_tr_b16 v[36:37], v10 offset:24576
  v_lshrrev_b32 v29, 4, v21
  v_mfma_f32_16x16x32_bf16 v[184:187], v[40:43], a[168:171], v[184:187]
  v_and_b32 v29, 32, v29
  v_and_b32 v30, 0x30, v21
  v_mfma_f32_16x16x32_bf16 v[184:187], v[44:47], a[184:187], v[184:187]
  ds_read_b64_tr_b16 v[38:39], v10 offset:25088
  v_xor_b32 v29, v29, v30
  v_mfma_f32_16x16x32_bf16 v[188:191], v[40:43], a[172:175], v[188:191]
  s_add_u32 s73, s73, 589824
  s_add_u32 m0, s74, 147456
  v_mfma_f32_16x16x32_bf16 v[188:191], v[44:47], a[188:191], v[188:191]
  ds_read_b64_tr_b16 v[40:41], v10 offset:20480
  s_waitcnt lgkmcnt(5)
  v_mfma_f32_16x16x32_bf16 v[128:131], v[48:51], a[192:195], v[128:131]
  buffer_load_dwordx4 v17, s[40:43], s73 offen lds
  v_mfma_f32_16x16x32_bf16 v[128:131], v[52:55], a[208:211], v[128:131]
  ds_read_b64_tr_b16 v[42:43], v10 offset:20992
  v_add_u32 v250, 81920, v250
  v_mfma_f32_16x16x32_bf16 v[132:135], v[48:51], a[196:199], v[132:135]
  buffer_load_dwordx4 v18, s[40:43], s73 offen offset:1024 lds
  v_mfma_f32_16x16x32_bf16 v[132:135], v[52:55], a[212:215], v[132:135]
  ds_read_b64_tr_b16 v[44:45], v10 offset:28672
  v_add_u32 v13, v13, v29
  v_mfma_f32_16x16x32_bf16 v[136:139], v[48:51], a[200:203], v[136:139]
  v_add_u32 v14, 146432, v13
  v_add_u32 v15, 292864, v13
  v_mfma_f32_16x16x32_bf16 v[136:139], v[52:55], a[216:219], v[136:139]
  ds_read_b64_tr_b16 v[46:47], v10 offset:29184
  v_add_u32 v16, 439296, v13
  v_mfma_f32_16x16x32_bf16 v[140:143], v[48:51], a[204:207], v[140:143]
  s_waitcnt vmcnt(19)
  s_barrier
  v_mfma_f32_16x16x32_bf16 v[140:143], v[52:55], a[220:223], v[140:143]
  ds_read_b64_tr_b16 v[48:49], v11 offset:0
  v_cvt_pk_bf16_f32 v68, v66, v67
  v_mfma_f32_16x16x32_bf16 v[144:147], v[56:59], a[192:195], v[144:147]
  buffer_load_dwordx4 v19, s[40:43], s73 offen offset:2048 lds
  v_mfma_f32_16x16x32_bf16 v[144:147], v[60:63], a[208:211], v[144:147]
  ds_read_b64_tr_b16 v[50:51], v11 offset:512
  v_xor_b32 v251, 64, v250
  v_mfma_f32_16x16x32_bf16 v[148:151], v[56:59], a[196:199], v[148:151]
  s_waitcnt vmcnt(11)
  v_perm_b32 v112, v226, v224, s99
  v_perm_b32 v113, v230, v228, s99
  v_mfma_f32_16x16x32_bf16 v[148:151], v[60:63], a[212:215], v[148:151]
  ds_read_b64_tr_b16 v[52:53], v11 offset:8192
  v_perm_b32 v114, v234, v232, s99
  v_mfma_f32_16x16x32_bf16 v[152:155], v[56:59], a[200:203], v[152:155]
  buffer_load_dwordx4 v20, s[40:43], s73 offen offset:3072 lds
  v_mfma_f32_16x16x32_bf16 v[152:155], v[60:63], a[216:219], v[152:155]
  ds_read_b64_tr_b16 v[54:55], v11 offset:8704
  v_perm_b32 v115, v238, v236, s99
  v_mfma_f32_16x16x32_bf16 v[156:159], v[56:59], a[204:207], v[156:159]
  v_perm_b32 v116, v226, v224, s100
  v_perm_b32 v117, v230, v228, s100
  v_mfma_f32_16x16x32_bf16 v[156:159], v[60:63], a[220:223], v[156:159]
  ds_read_b64_tr_b16 v[56:57], v11 offset:4096
  s_waitcnt lgkmcnt(5)
  v_mfma_f32_16x16x32_bf16 v[160:163], v[32:35], a[192:195], v[160:163]
  v_perm_b32 v118, v234, v232, s100
  v_perm_b32 v119, v238, v236, s100
  v_mfma_f32_16x16x32_bf16 v[160:163], v[36:39], a[208:211], v[160:163]
  ds_read_b64_tr_b16 v[58:59], v11 offset:4608
  s_add_u32 s73, s73, 589824
  v_mfma_f32_16x16x32_bf16 v[164:167], v[32:35], a[196:199], v[164:167]
  s_add_u32 m0, s74, 98304
  v_perm_b32 v120, v227, v225, s99
  v_mfma_f32_16x16x32_bf16 v[164:167], v[36:39], a[212:215], v[164:167]
  ds_read_b64_tr_b16 v[60:61], v11 offset:12288
  v_perm_b32 v121, v231, v229, s99
  v_mfma_f32_16x16x32_bf16 v[168:171], v[32:35], a[200:203], v[168:171]
  buffer_load_dwordx4 v17, s[40:43], s73 offen lds
  v_mfma_f32_16x16x32_bf16 v[168:171], v[36:39], a[216:219], v[168:171]
  ds_read_b64_tr_b16 v[62:63], v11 offset:12800
  v_perm_b32 v122, v235, v233, s99
  v_mfma_f32_16x16x32_bf16 v[172:175], v[32:35], a[204:207], v[172:175]
  buffer_load_dwordx4 v18, s[40:43], s73 offen offset:1024 lds
  v_mfma_f32_16x16x32_bf16 v[172:175], v[36:39], a[220:223], v[172:175]
  ds_read_b64_tr_b16 v[32:33], v12 offset:0
  v_perm_b32 v123, v239, v237, s99
  v_mfma_f32_16x16x32_bf16 v[176:179], v[40:43], a[192:195], v[176:179]
  v_perm_b32 v124, v227, v225, s100
  v_perm_b32 v125, v231, v229, s100
  v_mfma_f32_16x16x32_bf16 v[176:179], v[44:47], a[208:211], v[176:179]
  ds_read_b64_tr_b16 v[34:35], v12 offset:512
  v_perm_b32 v126, v235, v233, s100
  v_mfma_f32_16x16x32_bf16 v[180:183], v[40:43], a[196:199], v[180:183]
  buffer_load_dwordx4 v19, s[40:43], s73 offen offset:2048 lds
  v_mfma_f32_16x16x32_bf16 v[180:183], v[44:47], a[212:215], v[180:183]
  ds_read_b64_tr_b16 v[36:37], v12 offset:8192
  v_perm_b32 v127, v239, v237, s100
  v_mfma_f32_16x16x32_bf16 v[184:187], v[40:43], a[200:203], v[184:187]
  v_cvt_pk_bf16_f32 v69, v70, v71
  v_cvt_pk_bf16_f32 v80, v80, v81
  v_mfma_f32_16x16x32_bf16 v[184:187], v[44:47], a[216:219], v[184:187]
  ds_read_b64_tr_b16 v[38:39], v12 offset:8704
  v_cvt_pk_bf16_f32 v66, v72, v73
  v_mfma_f32_16x16x32_bf16 v[188:191], v[40:43], a[204:207], v[188:191]
  v_cvt_pk_bf16_f32 v67, v76, v77
  v_cvt_pk_bf16_f32 v81, v84, v85
  v_mfma_f32_16x16x32_bf16 v[188:191], v[44:47], a[220:223], v[188:191]
  ds_read_b64_tr_b16 v[40:41], v12 offset:4096
  s_waitcnt lgkmcnt(5)
  v_mfma_f32_16x16x32_bf16 v[128:131], v[48:51], a[224:227], v[128:131]
  buffer_load_dwordx4 v20, s[40:43], s73 offen offset:3072 lds
  v_mfma_f32_16x16x32_bf16 v[128:131], v[52:55], a[240:243], v[128:131]
  ds_read_b64_tr_b16 v[42:43], v12 offset:4608
  v_cvt_pk_bf16_f32 v70, v74, v75
  v_mfma_f32_16x16x32_bf16 v[132:135], v[48:51], a[228:231], v[132:135]
  v_cvt_pk_bf16_f32 v71, v78, v79
  v_cvt_pk_bf16_f32 v84, v82, v83
  v_mfma_f32_16x16x32_bf16 v[132:135], v[52:55], a[244:247], v[132:135]
  ds_read_b64_tr_b16 v[44:45], v12 offset:12288
  v_cvt_pk_bf16_f32 v85, v86, v87
  v_mfma_f32_16x16x32_bf16 v[136:139], v[48:51], a[232:235], v[136:139]
  buffer_store_dwordx4 v[64:67], v22, s[48:51], s82 offen sc1
  v_mfma_f32_16x16x32_bf16 v[136:139], v[52:55], a[248:251], v[136:139]
  ds_read_b64_tr_b16 v[46:47], v12 offset:12800
  s_add_u32 s73, s73, 589824
  v_mfma_f32_16x16x32_bf16 v[140:143], v[48:51], a[236:239], v[140:143]
  s_waitcnt vmcnt(13)
  s_barrier
  v_mfma_f32_16x16x32_bf16 v[140:143], v[52:55], a[252:255], v[140:143]
  ds_read_b64_tr_b16 v[48:49], v7 offset:32768
  s_add_u32 m0, s74, 65536
k1_pg2:
  s_cbranch_execz k1_pg6
  v_mfma_f32_16x16x32_bf16 v[144:147], v[56:59], a[224:227], v[144:147]
  buffer_load_dwordx4 v17, s[40:43], s73 offen lds
  v_mfma_f32_16x16x32_bf16 v[144:147], v[60:63], a[240:243], v[144:147]
  ds_read_b64_tr_b16 v[50:51], v7 offset:33280
  s_add_u32 s82, s82, 8192
  v_mfma_f32_16x16x32_bf16 v[148:151], v[56:59], a[228:231], v[148:151]
  buffer_load_dwordx4 v18, s[40:43], s73 offen offset:1024 lds
  v_mfma_f32_16x16x32_bf16 v[148:151], v[60:63], a[244:247], v[148:151]
  ds_read_b64_tr_b16 v[52:53], v7 offset:40960
  v_cvt_pk_bf16_f32 v82, v88, v89
  v_mfma_f32_16x16x32_bf16 v[152:155], v[56:59], a[232:235], v[152:155]
  ds_write_b128 v250, v[112:115] offset:0
  v_mfma_f32_16x16x32_bf16 v[152:155], v[60:63], a[248:251], v[152:155]
  ds_read_b64_tr_b16 v[54:55], v7 offset:41472
  v_cvt_pk_bf16_f32 v83, v92, v93
  v_mfma_f32_16x16x32_bf16 v[156:159], v[56:59], a[236:239], v[156:159]
  buffer_load_dwordx4 v19, s[40:43], s73 offen offset:2048 lds
  v_mfma_f32_16x16x32_bf16 v[156:159], v[60:63], a[252:255], v[156:159]
  ds_read_b64_tr_b16 v[56:57], v7 offset:36864
  s_waitcnt lgkmcnt(6)
  v_mfma_f32_16x16x32_bf16 v[160:163], v[32:35], a[224:227], v[160:163]
  ds_write_b128 v251, v[116:119] offset:0
  v_mfma_f32_16x16x32_bf16 v[160:163], v[36:39], a[240:243], v[160:163]
  ds_read_b64_tr_b16 v[58:59], v7 offset:37376
  v_cvt_pk_bf16_f32 v86, v90, v91
  v_mfma_f32_16x16x32_bf16 v[164:167], v[32:35], a[228:231], v[164:167]
  buffer_load_dwordx4 v20, s[40:43], s73 offen offset:3072 lds
  v_mfma_f32_16x16x32_bf16 v[164:167], v[36:39], a[244:247], v[164:167]
  ds_read_b64_tr_b16 v[60:61], v7 offset:45056
  v_cvt_pk_bf16_f32 v87, v94, v95
  v_mfma_f32_16x16x32_bf16 v[168:171], v[32:35], a[232:235], v[168:171]
  ds_write_b128 v250, v[120:123] offset:128
  v_mfma_f32_16x16x32_bf16 v[168:171], v[36:39], a[248:251], v[168:171]
  ds_read_b64_tr_b16 v[62:63], v7 offset:45568
  v_mfma_f32_16x16x32_bf16 v[172:175], v[32:35], a[236:239], v[172:175]
  buffer_store_dword v104, off, s[48:51], s26 sc1
  v_mfma_f32_16x16x32_bf16 v[172:175], v[36:39], a[252:255], v[172:175]
  ds_read_b64_tr_b16 v[32:33], v8 offset:32768
  s_add_u32 s73, s73, 589824
  v_mfma_f32_16x16x32_bf16 v[176:179], v[40:43], a[224:227], v[176:179]
  buffer_store_dwordx4 v[68:71], v22, s[48:51], s82 offen sc1
  v_mfma_f32_16x16x32_bf16 v[176:179], v[44:47], a[240:243], v[176:179]
  ds_read_b64_tr_b16 v[34:35], v8 offset:33280
  s_add_u32 m0, s74, 114688
  v_mfma_f32_16x16x32_bf16 v[180:183], v[40:43], a[228:231], v[180:183]
  buffer_load_dwordx4 v17, s[40:43], s73 offen lds
  v_mfma_f32_16x16x32_bf16 v[180:183], v[44:47], a[244:247], v[180:183]
  ds_read_b64_tr_b16 v[36:37], v8 offset:40960
  v_mfma_f32_16x16x32_bf16 v[184:187], v[40:43], a[232:235], v[184:187]
  buffer_load_dwordx4 v18, s[40:43], s73 offen offset:1024 lds
  v_mfma_f32_16x16x32_bf16 v[184:187], v[44:47], a[248:251], v[184:187]
  ds_read_b64_tr_b16 v[38:39], v8 offset:41472
  v_mfma_f32_16x16x32_bf16 v[188:191], v[40:43], a[236:239], v[188:191]
  ds_write_b128 v251, v[124:127] offset:128
  v_mfma_f32_16x16x32_bf16 v[188:191], v[44:47], a[252:255], v[188:191]
  ds_read_b64_tr_b16 v[40:41], v8 offset:36864
  s_waitcnt lgkmcnt(6)
  v_mfma_f32_16x16x32_bf16 v[128:131], v[48:51], v[192:195], v[128:131]
  buffer_load_dwordx4 v19, s[40:43], s73 offen offset:2048 lds
  v_mfma_f32_16x16x32_bf16 v[128:131], v[52:55], v[208:211], v[128:131]
  ds_read_b64_tr_b16 v[42:43], v8 offset:37376
  v_lshl_add_u32 v251, s64, 10, v21
  v_mfma_f32_16x16x32_bf16 v[132:135], v[48:51], v[196:199], v[132:135]
  buffer_store_dwordx4 v[80:83], v22, s[48:51], s83 offen sc1
  v_mfma_f32_16x16x32_bf16 v[132:135], v[52:55], v[212:215], v[132:135]
  v_add_u32 v251, 81920, v251
  ds_read_b64_tr_b16 v[44:45], v8 offset:45056
  v_mfma_f32_16x16x32_bf16 v[136:139], v[48:51], v[200:203], v[136:139]
  s_add_u32 s83, s83, 8192
  v_mfma_f32_16x16x32_bf16 v[136:139], v[52:55], v[216:219], v[136:139]
  ds_read_b64_tr_b16 v[46:47], v8 offset:45568
  v_mfma_f32_16x16x32_bf16 v[140:143], v[48:51], v[204:207], v[140:143]
  s_waitcnt vmcnt(19) lgkmcnt(4)
  s_barrier
  v_mfma_f32_16x16x32_bf16 v[140:143], v[52:55], v[220:223], v[140:143]
  ds_read_b64_tr_b16 v[48:49], v7 offset:49152
  v_mfma_f32_16x16x32_bf16 v[144:147], v[56:59], v[192:195], v[144:147]
  buffer_load_dwordx4 v20, s[40:43], s73 offen offset:3072 lds
  v_mfma_f32_16x16x32_bf16 v[144:147], v[60:63], v[208:211], v[144:147]
  ds_read_b64_tr_b16 v[50:51], v7 offset:49664
  v_mfma_f32_16x16x32_bf16 v[148:151], v[56:59], v[196:199], v[148:151]
  ds_read_b128 v[224:227], v251 offset:0
  v_mfma_f32_16x16x32_bf16 v[148:151], v[60:63], v[212:215], v[148:151]
  ds_read_b64_tr_b16 v[52:53], v7 offset:57344
  s_add_u32 s73, s73, 589824
  v_mfma_f32_16x16x32_bf16 v[152:155], v[56:59], v[200:203], v[152:155]
  ds_read_b128 v[228:231], v251 offset:4096
  v_mfma_f32_16x16x32_bf16 v[152:155], v[60:63], v[216:219], v[152:155]
  ds_read_b64_tr_b16 v[54:55], v7 offset:57856
  s_add_u32 m0, s74, 0
  v_mfma_f32_16x16x32_bf16 v[156:159], v[56:59], v[204:207], v[156:159]
  buffer_store_dwordx4 v[84:87], v22, s[48:51], s83 offen sc1
  v_mfma_f32_16x16x32_bf16 v[156:159], v[60:63], v[220:223], v[156:159]
  buffer_load_dwordx4 v17, s[40:43], s73 offen lds
  v_mfma_f32_16x16x32_bf16 v[160:163], v[32:35], v[192:195], v[160:163]
  ds_read_b64_tr_b16 v[56:57], v7 offset:53248
  v_lshrrev_b32 v29, 4, v21
  v_mfma_f32_16x16x32_bf16 v[160:163], v[36:39], v[208:211], v[160:163]
  ds_read_b64_tr_b16 v[58:59], v7 offset:53760
  v_mul_u32_u24 v29, 294912, v29
  v_mfma_f32_16x16x32_bf16 v[164:167], v[32:35], v[196:199], v[164:167]
  buffer_load_dwordx4 v18, s[40:43], s73 offen offset:1024 lds
  v_mfma_f32_16x16x32_bf16 v[164:167], v[36:39], v[212:215], v[164:167]
  ds_read_b64_tr_b16 v[60:61], v7 offset:61440
  v_mov_b32 v22, 2147418112
  v_mfma_f32_16x16x32_bf16 v[168:171], v[32:35], v[200:203], v[168:171]
  buffer_load_dwordx4 v19, s[40:43], s73 offen offset:2048 lds
  v_mfma_f32_16x16x32_bf16 v[168:171], v[36:39], v[216:219], v[168:171]
  ds_read_b64_tr_b16 v[62:63], v7 offset:61952
  v_mfma_f32_16x16x32_bf16 v[172:175], v[32:35], v[204:207], v[172:175]
  ds_read_b128 v[232:235], v251 offset:8192
  v_mfma_f32_16x16x32_bf16 v[172:175], v[36:39], v[220:223], v[172:175]
  ds_read_b64_tr_b16 v[32:33], v8 offset:49152
  s_waitcnt lgkmcnt(6)
  v_mfma_f32_16x16x32_bf16 v[176:179], v[40:43], v[192:195], v[176:179]
  buffer_load_dwordx4 v20, s[40:43], s73 offen offset:3072 lds
  v_mfma_f32_16x16x32_bf16 v[176:179], v[44:47], v[208:211], v[176:179]
  ds_read_b64_tr_b16 v[34:35], v8 offset:49664
  v_mfma_f32_16x16x32_bf16 v[180:183], v[40:43], v[196:199], v[180:183]
  v_cmp_gt_u32 vcc, 144, v21
  s_nop 1
  v_cndmask_b32 v22, v22, v29, vcc
  v_mfma_f32_16x16x32_bf16 v[180:183], v[44:47], v[212:215], v[180:183]
  ds_read_b64_tr_b16 v[36:37], v8 offset:57344
  s_and_b32 s80, s67, 15
  v_mfma_f32_16x16x32_bf16 v[184:187], v[40:43], v[200:203], v[184:187]
  s_lshl_b32 s80, s80, 1
  s_and_b32 s86, s68, 1
  v_mfma_f32_16x16x32_bf16 v[184:187], v[44:47], v[216:219], v[184:187]
  ds_read_b64_tr_b16 v[38:39], v8 offset:57856
  s_add_u32 s73, s73, 589824
  v_mfma_f32_16x16x32_bf16 v[188:191], v[40:43], v[204:207], v[188:191]
  s_add_u32 m0, s74, 16384
  s_add_u32 s80, s80, s86
  v_mfma_f32_16x16x32_bf16 v[188:191], v[44:47], v[220:223], v[188:191]
  ds_read_b64_tr_b16 v[40:41], v8 offset:53248
  s_mul_i32 s86, s66, 224
  v_mfma_f32_16x16x32_bf16 v[64:67], v[48:51], a[0:3], 0
  buffer_load_dwordx4 v17, s[40:43], s73 offen lds
  v_mfma_f32_16x16x32_bf16 v[64:67], v[52:55], a[16:19], v[64:67]
  ds_read_b64_tr_b16 v[42:43], v8 offset:53760
  s_add_u32 s80, s80, s86
  v_mfma_f32_16x16x32_bf16 v[68:71], v[48:51], a[4:7], 0
  buffer_load_dwordx4 v18, s[40:43], s73 offen offset:1024 lds
  v_mfma_f32_16x16x32_bf16 v[68:71], v[52:55], a[20:23], v[68:71]
  ds_read_b64_tr_b16 v[44:45], v8 offset:61440
  s_mul_i32 s80, s80, 9216
  v_mfma_f32_16x16x32_bf16 v[72:75], v[48:51], a[8:11], 0
  buffer_store_dwordx4 v[224:227], v248, s[48:51], s98 offen sc1
  v_mfma_f32_16x16x32_bf16 v[72:75], v[52:55], a[24:27], v[72:75]
  ds_read_b64_tr_b16 v[46:47], v8 offset:61952
  s_add_u32 s98, s98, 524288
  v_mfma_f32_16x16x32_bf16 v[76:79], v[48:51], a[12:15], 0
  s_waitcnt vmcnt(24) lgkmcnt(8)
  s_barrier
  v_mfma_f32_16x16x32_bf16 v[76:79], v[52:55], a[28:31], v[76:79]
  ds_read_b64_tr_b16 v[48:49], v11 offset:16384
  s_add_u32 s80, s80, s79
  v_mfma_f32_16x16x32_bf16 v[80:83], v[56:59], a[0:3], 0
  buffer_load_dwordx4 v19, s[40:43], s73 offen offset:2048 lds
  v_mfma_f32_16x16x32_bf16 v[80:83], v[60:63], a[16:19], v[80:83]
  ds_read_b64_tr_b16 v[50:51], v11 offset:16896
  v_mul_f32 v144, v128, v144
  v_mfma_f32_16x16x32_bf16 v[84:87], v[56:59], a[4:7], 0
  v_mul_f32 v128, s77, v128
  v_mul_f32 v145, v129, v145
  v_mfma_f32_16x16x32_bf16 v[84:87], v[60:63], a[20:23], v[84:87]
  ds_read_b64_tr_b16 v[52:53], v11 offset:24576
  v_mul_f32 v129, s77, v129
  v_mfma_f32_16x16x32_bf16 v[88:91], v[56:59], a[8:11], 0
  buffer_load_dwordx4 v20, s[40:43], s73 offen offset:3072 lds
  v_mfma_f32_16x16x32_bf16 v[88:91], v[60:63], a[24:27], v[88:91]
  ds_read_b64_tr_b16 v[54:55], v11 offset:25088
  v_mul_f32 v146, v130, v146
  v_mfma_f32_16x16x32_bf16 v[92:95], v[56:59], a[12:15], 0
  buffer_store_dwordx4 v[228:231], v248, s[48:51], s98 offen sc1
  v_mfma_f32_16x16x32_bf16 v[92:95], v[60:63], a[28:31], v[92:95]
  ds_read_b64_tr_b16 v[56:57], v11 offset:20480
  s_waitcnt lgkmcnt(5)
  v_mfma_f32_16x16x32_bf16 v[96:99], v[32:35], a[0:3], 0
  v_exp_f32 v128, v128
  v_mfma_f32_16x16x32_bf16 v[96:99], v[36:39], a[16:19], v[96:99]
  ds_read_b64_tr_b16 v[58:59], v11 offset:20992
  s_add_u32 s73, s73, 589824
  v_mfma_f32_16x16x32_bf16 v[100:103], v[32:35], a[4:7], 0
  v_exp_f32 v129, v129
  v_mfma_f32_16x16x32_bf16 v[100:103], v[36:39], a[20:23], v[100:103]
  v_add_f32 v128, 1.0, v128
  ds_read_b64_tr_b16 v[60:61], v11 offset:28672
  v_mfma_f32_16x16x32_bf16 v[104:107], v[32:35], a[8:11], 0
  v_rcp_f32 v128, v128
  v_mfma_f32_16x16x32_bf16 v[104:107], v[36:39], a[24:27], v[104:107]
  s_add_u32 m0, s74, 131072
  s_nop 0
  buffer_load_dwordx4 v17, s[40:43], s73 offen lds
  v_mfma_f32_16x16x32_bf16 v[108:111], v[32:35], a[12:15], 0
  s_add_u32 s98, s98, 524288
  ds_read_b64_tr_b16 v[62:63], v11 offset:29184
  v_mfma_f32_16x16x32_bf16 v[108:111], v[36:39], a[28:31], v[108:111]
  v_mul_f32 v144, v128, v144
  ds_read_b64_tr_b16 v[32:33], v12 offset:16384
  v_mfma_f32_16x16x32_bf16 v[112:115], v[40:43], a[0:3], 0
  buffer_load_dwordx4 v18, s[40:43], s73 offen offset:1024 lds
  v_mfma_f32_16x16x32_bf16 v[112:115], v[44:47], a[16:19], v[112:115]
  ds_read_b64_tr_b16 v[34:35], v12 offset:16896
  v_add_f32 v129, 1.0, v129
  v_mfma_f32_16x16x32_bf16 v[116:119], v[40:43], a[4:7], 0
  buffer_load_dwordx4 v19, s[40:43], s73 offen offset:2048 lds
  v_mfma_f32_16x16x32_bf16 v[116:119], v[44:47], a[20:23], v[116:119]
  ds_read_b64_tr_b16 v[36:37], v12 offset:24576
  v_mul_f32 v130, s77, v130
  v_mfma_f32_16x16x32_bf16 v[120:123], v[40:43], a[8:11], 0
  buffer_store_dwordx4 v[232:235], v249, s[48:51], s98 offen sc1
  v_mfma_f32_16x16x32_bf16 v[120:123], v[44:47], a[24:27], v[120:123]
  v_rcp_f32 v129, v129
  v_mfma_f32_16x16x32_bf16 v[124:127], v[40:43], a[12:15], 0
  ds_read_b64_tr_b16 v[38:39], v12 offset:25088
  v_add_u32 v240, s74, v21
  v_mfma_f32_16x16x32_bf16 v[124:127], v[44:47], a[28:31], v[124:127]
  v_mul_f32 v145, v129, v145
  s_waitcnt lgkmcnt(4)
  v_mfma_f32_16x16x32_bf16 v[64:67], v[48:51], a[32:35], v[64:67]
  ds_read_b64_tr_b16 v[40:41], v12 offset:20480
  v_lshlrev_b32 v240, 8, v240
  v_mfma_f32_16x16x32_bf16 v[64:67], v[52:55], a[48:51], v[64:67]
  v_exp_f32 v130, v130
  v_mfma_f32_16x16x32_bf16 v[68:71], v[48:51], a[36:39], v[68:71]
  ds_read_b64_tr_b16 v[42:43], v12 offset:20992
  v_mov_b32 v241, 1
  v_mfma_f32_16x16x32_bf16 v[68:71], v[52:55], a[52:55], v[68:71]
  v_add_f32 v130, 1.0, v130
  ds_read_b64_tr_b16 v[44:45], v12 offset:28672
  v_mfma_f32_16x16x32_bf16 v[72:75], v[48:51], a[40:43], v[72:75]
  buffer_load_dwordx4 v20, s[40:43], s73 offen offset:3072 lds
  v_mfma_f32_16x16x32_bf16 v[72:75], v[52:55], a[56:59], v[72:75]
  v_rcp_f32 v130, v130
  v_mul_f32 v147, v131, v147
  v_mfma_f32_16x16x32_bf16 v[76:79], v[48:51], a[44:47], v[76:79]
  s_waitcnt vmcnt(28)
  s_barrier
  v_mfma_f32_16x16x32_bf16 v[76:79], v[52:55], a[60:63], v[76:79]
  v_mul_f32 v146, v130, v146
  v_mul_f32 v131, s77, v131
  v_mfma_f32_16x16x32_bf16 v[80:83], v[56:59], a[32:35], v[80:83]
  ds_read_b64_tr_b16 v[46:47], v12 offset:29184
  s_add_u32 s73, s73, 589824
  v_mfma_f32_16x16x32_bf16 v[80:83], v[60:63], a[48:51], v[80:83]
  buffer_load_dword v253, v0, s[44:47], s78 offen
  s_add_u32 s78, s78, 2688
  s_add_u32 s72, s72, s96
  s_add_u32 s72, s72, 4718592
  buffer_load_dword v253, v254, s[40:43], s72 offen
  v_exp_f32 v131, v131
  v_mfma_f32_16x16x32_bf16 v[84:87], v[56:59], a[36:39], v[84:87]
  ds_read_b64_tr_b16 v[48:49], v9 offset:32768
  s_bfe_u32 s70, s2, 131075
  v_mfma_f32_16x16x32_bf16 v[84:87], v[60:63], a[52:55], v[84:87]
  v_add_f32 v131, 1.0, v131
  ds_read_b64_tr_b16 v[50:51], v9 offset:33280
  v_mfma_f32_16x16x32_bf16 v[88:91], v[56:59], a[40:43], v[88:91]
  ds_read_b64_tr_b16 v[52:53], v9 offset:40960
  v_mul_f32 v176, v160, v176
  v_mfma_f32_16x16x32_bf16 v[88:91], v[60:63], a[56:59], v[88:91]
  v_rcp_f32 v131, v131
  v_mfma_f32_16x16x32_bf16 v[92:95], v[56:59], a[44:47], v[92:95]
  ds_read_b64_tr_b16 v[54:55], v9 offset:41472
  v_mul_f32 v147, v131, v147
  v_mfma_f32_16x16x32_bf16 v[92:95], v[60:63], a[60:63], v[92:95]
  v_mul_f32 v160, s77, v160
  s_waitcnt lgkmcnt(4)
  v_mfma_f32_16x16x32_bf16 v[96:99], v[32:35], a[32:35], v[96:99]
  ds_read_b64_tr_b16 v[56:57], v9 offset:36864
  v_mul_f32 v177, v161, v177
  v_mfma_f32_16x16x32_bf16 v[96:99], v[36:39], a[48:51], v[96:99]
  v_exp_f32 v160, v160
  v_mfma_f32_16x16x32_bf16 v[100:103], v[32:35], a[36:39], v[100:103]
  ds_read_b64_tr_b16 v[58:59], v9 offset:37376
  v_add_f32 v160, 1.0, v160
  v_mfma_f32_16x16x32_bf16 v[100:103], v[36:39], a[52:55], v[100:103]
  ds_read_b64_tr_b16 v[60:61], v9 offset:45056
  v_mul_f32 v161, s77, v161
  v_mfma_f32_16x16x32_bf16 v[104:107], v[32:35], a[40:43], v[104:107]
  v_rcp_f32 v160, v160
  v_mfma_f32_16x16x32_bf16 v[104:107], v[36:39], a[56:59], v[104:107]
  ds_read_b64_tr_b16 v[62:63], v9 offset:45568
  v_mul_f32 v176, v160, v176
  v_mfma_f32_16x16x32_bf16 v[108:111], v[32:35], a[44:47], v[108:111]
  v_exp_f32 v161, v161
  v_mfma_f32_16x16x32_bf16 v[108:111], v[36:39], a[60:63], v[108:111]
  ds_read_b64_tr_b16 v[32:33], v10 offset:32768
  v_add_f32 v161, 1.0, v161
  v_mfma_f32_16x16x32_bf16 v[112:115], v[40:43], a[32:35], v[112:115]
  v_rcp_f32 v161, v161
  v_mfma_f32_16x16x32_bf16 v[112:115], v[44:47], a[48:51], v[112:115]
  ds_read_b64_tr_b16 v[34:35], v10 offset:33280
  v_mul_f32 v177, v161, v177
  v_mfma_f32_16x16x32_bf16 v[116:119], v[40:43], a[36:39], v[116:119]
  v_mul_f32 v178, v162, v178
  v_mul_f32 v179, v163, v179
  v_mfma_f32_16x16x32_bf16 v[116:119], v[44:47], a[52:55], v[116:119]
  ds_read_b64_tr_b16 v[36:37], v10 offset:40960
  v_mul_f32 v162, s77, v162
  v_mfma_f32_16x16x32_bf16 v[120:123], v[40:43], a[40:43], v[120:123]
  v_exp_f32 v162, v162
  v_mfma_f32_16x16x32_bf16 v[120:123], v[44:47], a[56:59], v[120:123]
  ds_read_b64_tr_b16 v[38:39], v10 offset:41472
  v_add_f32 v162, 1.0, v162
  v_mfma_f32_16x16x32_bf16 v[124:127], v[40:43], a[44:47], v[124:127]
  v_rcp_f32 v162, v162
  v_mfma_f32_16x16x32_bf16 v[124:127], v[44:47], a[60:63], v[124:127]
  ds_read_b64_tr_b16 v[40:41], v10 offset:36864
  s_waitcnt lgkmcnt(5)
  v_mfma_f32_16x16x32_bf16 v[64:67], v[48:51], a[64:67], v[64:67]
  v_mul_f32 v178, v162, v178
  v_mul_f32 v163, s77, v163
  v_mfma_f32_16x16x32_bf16 v[64:67], v[52:55], a[80:83], v[64:67]
  ds_read_b64_tr_b16 v[42:43], v10 offset:37376
  v_cvt_pk_bf16_f32 v128, v144, v145
  v_mfma_f32_16x16x32_bf16 v[68:71], v[48:51], a[68:71], v[68:71]
  v_exp_f32 v163, v163
  v_mfma_f32_16x16x32_bf16 v[68:71], v[52:55], a[84:87], v[68:71]
  ds_read_b64_tr_b16 v[44:45], v10 offset:45056
  v_add_f32 v163, 1.0, v163
  v_mfma_f32_16x16x32_bf16 v[72:75], v[48:51], a[72:75], v[72:75]
  v_rcp_f32 v163, v163
  v_mfma_f32_16x16x32_bf16 v[72:75], v[52:55], a[88:91], v[72:75]
  ds_read_b64_tr_b16 v[46:47], v10 offset:45568
  v_mul_f32 v179, v163, v179
  v_mfma_f32_16x16x32_bf16 v[76:79], v[48:51], a[76:79], v[76:79]
  s_waitcnt vmcnt(25)
  s_barrier
  v_mfma_f32_16x16x32_bf16 v[76:79], v[52:55], a[92:95], v[76:79]
  ds_read_b64_tr_b16 v[48:49], v9 offset:0
  v_cvt_pk_bf16_f32 v129, v146, v147
  v_mfma_f32_16x16x32_bf16 v[80:83], v[56:59], a[64:67], v[80:83]
  v_cvt_pk_bf16_f32 v130, v176, v177
  v_mul_f32 v148, v132, v148
  v_mfma_f32_16x16x32_bf16 v[80:83], v[60:63], a[80:83], v[80:83]
  ds_read_b64_tr_b16 v[50:51], v9 offset:512
  v_cvt_pk_bf16_f32 v131, v178, v179
  v_mfma_f32_16x16x32_bf16 v[84:87], v[56:59], a[68:71], v[84:87]
  v_add_u32 v28, 32768, v26
  v_mul_f32 v132, s77, v132
  v_mfma_f32_16x16x32_bf16 v[84:87], v[60:63], a[84:87], v[84:87]
  ds_read_b64_tr_b16 v[52:53], v9 offset:8192
  v_mul_f32 v149, v133, v149
  v_mfma_f32_16x16x32_bf16 v[88:91], v[56:59], a[72:75], v[88:91]
  ds_write_b128 v28, v[128:131] offset:0
  v_mfma_f32_16x16x32_bf16 v[88:91], v[60:63], a[88:91], v[88:91]
  ds_read_b64_tr_b16 v[54:55], v9 offset:8704
  v_mul_f32 v133, s77, v133
  v_mfma_f32_16x16x32_bf16 v[92:95], v[56:59], a[76:79], v[92:95]
  s_add_u32 s24, s24, 16384
  buffer_store_dwordx4 v[128:131], v26, s[48:51], s24 offen offset:0 sc1
  v_mfma_f32_16x16x32_bf16 v[92:95], v[60:63], a[92:95], v[92:95]
  ds_read_b64_tr_b16 v[56:57], v9 offset:4096
  s_waitcnt lgkmcnt(6)
  v_mfma_f32_16x16x32_bf16 v[96:99], v[32:35], a[64:67], v[96:99]
  v_exp_f32 v132, v132
  v_mfma_f32_16x16x32_bf16 v[96:99], v[36:39], a[80:83], v[96:99]
  ds_read_b64_tr_b16 v[58:59], v9 offset:4608
  v_add_f32 v132, 1.0, v132
  v_mfma_f32_16x16x32_bf16 v[100:103], v[32:35], a[68:71], v[100:103]
  v_rcp_f32 v132, v132
  v_mfma_f32_16x16x32_bf16 v[100:103], v[36:39], a[84:87], v[100:103]
  ds_read_b64_tr_b16 v[60:61], v9 offset:12288
  v_mul_f32 v148, v132, v148
  v_mfma_f32_16x16x32_bf16 v[104:107], v[32:35], a[72:75], v[104:107]
  v_exp_f32 v133, v133
  v_mfma_f32_16x16x32_bf16 v[104:107], v[36:39], a[88:91], v[104:107]
  ds_read_b64_tr_b16 v[62:63], v9 offset:12800
  v_add_f32 v133, 1.0, v133
  v_mfma_f32_16x16x32_bf16 v[108:111], v[32:35], a[76:79], v[108:111]
  v_rcp_f32 v133, v133
  v_mfma_f32_16x16x32_bf16 v[108:111], v[36:39], a[92:95], v[108:111]
  ds_read_b64_tr_b16 v[32:33], v10 offset:0
  v_mul_f32 v149, v133, v149
  v_mfma_f32_16x16x32_bf16 v[112:115], v[40:43], a[64:67], v[112:115]
  v_mul_f32 v150, v134, v150
  v_mul_f32 v151, v135, v151
  v_mfma_f32_16x16x32_bf16 v[112:115], v[44:47], a[80:83], v[112:115]
  ds_read_b64_tr_b16 v[34:35], v10 offset:512
  v_mul_f32 v134, s77, v134
  v_mfma_f32_16x16x32_bf16 v[116:119], v[40:43], a[68:71], v[116:119]
  v_exp_f32 v134, v134
  v_mfma_f32_16x16x32_bf16 v[116:119], v[44:47], a[84:87], v[116:119]
  ds_read_b64_tr_b16 v[36:37], v10 offset:8192
  v_add_f32 v134, 1.0, v134
  v_mfma_f32_16x16x32_bf16 v[120:123], v[40:43], a[72:75], v[120:123]
  v_rcp_f32 v134, v134
  v_mfma_f32_16x16x32_bf16 v[120:123], v[44:47], a[88:91], v[120:123]
  ds_read_b64_tr_b16 v[38:39], v10 offset:8704
  v_mul_f32 v150, v134, v150
  v_mfma_f32_16x16x32_bf16 v[124:127], v[40:43], a[76:79], v[124:127]
  v_mul_f32 v135, s77, v135
  v_mul_f32 v180, v164, v180
  v_mfma_f32_16x16x32_bf16 v[124:127], v[44:47], a[92:95], v[124:127]
  ds_read_b64_tr_b16 v[40:41], v10 offset:4096
  s_waitcnt lgkmcnt(5)
  v_mfma_f32_16x16x32_bf16 v[64:67], v[48:51], a[96:99], v[64:67]
  v_exp_f32 v135, v135
  v_mfma_f32_16x16x32_bf16 v[64:67], v[52:55], a[112:115], v[64:67]
  ds_read_b64_tr_b16 v[42:43], v10 offset:4608
  v_add_f32 v135, 1.0, v135
  v_mfma_f32_16x16x32_bf16 v[68:71], v[48:51], a[100:103], v[68:71]
  v_rcp_f32 v135, v135
  v_mfma_f32_16x16x32_bf16 v[68:71], v[52:55], a[116:119], v[68:71]
  ds_read_b64_tr_b16 v[44:45], v10 offset:12288
  v_mul_f32 v151, v135, v151
  v_mfma_f32_16x16x32_bf16 v[72:75], v[48:51], a[104:107], v[72:75]
  v_mul_f32 v164, s77, v164
  v_mul_f32 v181, v165, v181
  v_mfma_f32_16x16x32_bf16 v[72:75], v[52:55], a[120:123], v[72:75]
  ds_read_b64_tr_b16 v[46:47], v10 offset:12800
  v_mul_f32 v165, s77, v165
  v_mfma_f32_16x16x32_bf16 v[76:79], v[48:51], a[108:111], v[76:79]
  s_waitcnt vmcnt(4)
  s_barrier
  v_mfma_f32_16x16x32_bf16 v[76:79], v[52:55], a[124:127], v[76:79]
  ds_read_b64_tr_b16 v[48:49], v9 offset:49152
  v_mul_f32 v182, v166, v182
  v_mfma_f32_16x16x32_bf16 v[80:83], v[56:59], a[96:99], v[80:83]
  s_cmp_eq_u32 s70, 0
  s_cselect_b32 s71, s2, 2147418112
  v_mfma_f32_16x16x32_bf16 v[80:83], v[60:63], a[112:115], v[80:83]
  ds_read_b64_tr_b16 v[50:51], v9 offset:49664
  v_mul_f32 v166, s77, v166
  v_mfma_f32_16x16x32_bf16 v[84:87], v[56:59], a[100:103], v[84:87]
  v_exp_f32 v164, v164
  v_mfma_f32_16x16x32_bf16 v[84:87], v[60:63], a[116:119], v[84:87]
  ds_read_b64_tr_b16 v[52:53], v9 offset:57344
  v_add_f32 v164, 1.0, v164
  v_mfma_f32_16x16x32_bf16 v[88:91], v[56:59], a[104:107], v[88:91]
  v_rcp_f32 v164, v164
  v_mfma_f32_16x16x32_bf16 v[88:91], v[60:63], a[120:123], v[88:91]
  ds_read_b64_tr_b16 v[54:55], v9 offset:57856
  v_mul_f32 v180, v164, v180
  v_mfma_f32_16x16x32_bf16 v[92:95], v[56:59], a[108:111], v[92:95]
  v_exp_f32 v165, v165
  v_mfma_f32_16x16x32_bf16 v[92:95], v[60:63], a[124:127], v[92:95]
  ds_read_b64_tr_b16 v[56:57], v9 offset:53248
  s_waitcnt lgkmcnt(5)
  v_mfma_f32_16x16x32_bf16 v[96:99], v[32:35], a[96:99], v[96:99]
  buffer_store_byte v241, v240, s[60:63], s71 offen sc1
  v_mfma_f32_16x16x32_bf16 v[96:99], v[36:39], a[112:115], v[96:99]
  ds_read_b64_tr_b16 v[58:59], v9 offset:53760
  v_add_f32 v165, 1.0, v165
  v_mfma_f32_16x16x32_bf16 v[100:103], v[32:35], a[100:103], v[100:103]
  v_rcp_f32 v165, v165
  v_mfma_f32_16x16x32_bf16 v[100:103], v[36:39], a[116:119], v[100:103]
  ds_read_b64_tr_b16 v[60:61], v9 offset:61440
  v_mul_f32 v181, v165, v181
  v_mfma_f32_16x16x32_bf16 v[104:107], v[32:35], a[104:107], v[104:107]
  v_exp_f32 v166, v166
  v_mfma_f32_16x16x32_bf16 v[104:107], v[36:39], a[120:123], v[104:107]
  ds_read_b64_tr_b16 v[62:63], v9 offset:61952
  v_add_f32 v166, 1.0, v166
  v_mfma_f32_16x16x32_bf16 v[108:111], v[32:35], a[108:111], v[108:111]
  v_rcp_f32 v166, v166
  v_mfma_f32_16x16x32_bf16 v[108:111], v[36:39], a[124:127], v[108:111]
  ds_read_b64_tr_b16 v[32:33], v10 offset:49152
  v_mul_f32 v182, v166, v182
  v_mfma_f32_16x16x32_bf16 v[112:115], v[40:43], a[96:99], v[112:115]
  v_mul_f32 v183, v167, v183
  v_cvt_pk_bf16_f32 v132, v148, v149
  v_mfma_f32_16x16x32_bf16 v[112:115], v[44:47], a[112:115], v[112:115]
  ds_read_b64_tr_b16 v[34:35], v10 offset:49664
  v_mul_f32 v167, s77, v167
  v_mfma_f32_16x16x32_bf16 v[116:119], v[40:43], a[100:103], v[116:119]
  v_exp_f32 v167, v167
  v_mfma_f32_16x16x32_bf16 v[116:119], v[44:47], a[116:119], v[116:119]
  ds_read_b64_tr_b16 v[36:37], v10 offset:57344
  v_add_f32 v167, 1.0, v167
  v_mfma_f32_16x16x32_bf16 v[120:123], v[40:43], a[104:107], v[120:123]
  v_rcp_f32 v167, v167
  v_mfma_f32_16x16x32_bf16 v[120:123], v[44:47], a[120:123], v[120:123]
  ds_read_b64_tr_b16 v[38:39], v10 offset:57856
  v_mul_f32 v183, v167, v183
  v_mfma_f32_16x16x32_bf16 v[124:127], v[40:43], a[108:111], v[124:127]
  v_cvt_pk_bf16_f32 v133, v150, v151
  v_mul_f32 v152, v136, v152
  v_mfma_f32_16x16x32_bf16 v[124:127], v[44:47], a[124:127], v[124:127]
  ds_read_b64_tr_b16 v[40:41], v10 offset:53248
  s_waitcnt lgkmcnt(5)
  v_mfma_f32_16x16x32_bf16 v[64:67], v[48:51], a[128:131], v[64:67]
  v_cvt_pk_bf16_f32 v134, v180, v181
  v_mul_f32 v136, s77, v136
  v_mfma_f32_16x16x32_bf16 v[64:67], v[52:55], a[144:147], v[64:67]
  ds_read_b64_tr_b16 v[42:43], v10 offset:53760
  v_cvt_pk_bf16_f32 v135, v182, v183
  v_mfma_f32_16x16x32_bf16 v[68:71], v[48:51], a[132:135], v[68:71]
  ds_write_b128 v28, v[132:135] offset:1024
  v_mfma_f32_16x16x32_bf16 v[68:71], v[52:55], a[148:151], v[68:71]
  ds_read_b64_tr_b16 v[44:45], v10 offset:61440
  v_mul_f32 v153, v137, v153
  v_mfma_f32_16x16x32_bf16 v[72:75], v[48:51], a[136:139], v[72:75]
  buffer_store_dwordx4 v[132:135], v26, s[48:51], s24 offen offset:1024 sc1
  v_mfma_f32_16x16x32_bf16 v[72:75], v[52:55], a[152:155], v[72:75]
  ds_read_b64_tr_b16 v[46:47], v10 offset:61952
  v_mul_f32 v137, s77, v137
  v_mfma_f32_16x16x32_bf16 v[76:79], v[48:51], a[140:143], v[76:79]
  s_barrier
  v_mfma_f32_16x16x32_bf16 v[76:79], v[52:55], a[156:159], v[76:79]
  ds_read_b64_tr_b16 v[48:49], v7 offset:0
  v_mul_f32 v154, v138, v154
  v_mfma_f32_16x16x32_bf16 v[80:83], v[56:59], a[128:131], v[80:83]
  v_exp_f32 v136, v136
  v_mfma_f32_16x16x32_bf16 v[80:83], v[60:63], a[144:147], v[80:83]
  ds_read_b64_tr_b16 v[50:51], v7 offset:512
  v_add_f32 v136, 1.0, v136
  v_mfma_f32_16x16x32_bf16 v[84:87], v[56:59], a[132:135], v[84:87]
  v_rcp_f32 v136, v136
  v_mfma_f32_16x16x32_bf16 v[84:87], v[60:63], a[148:151], v[84:87]
  ds_read_b64_tr_b16 v[52:53], v7 offset:8192
  v_mul_f32 v152, v136, v152
  v_mfma_f32_16x16x32_bf16 v[88:91], v[56:59], a[136:139], v[88:91]
  v_exp_f32 v137, v137
  v_mfma_f32_16x16x32_bf16 v[88:91], v[60:63], a[152:155], v[88:91]
  ds_read_b64_tr_b16 v[54:55], v7 offset:8704
  v_add_f32 v137, 1.0, v137
  v_mfma_f32_16x16x32_bf16 v[92:95], v[56:59], a[140:143], v[92:95]
  v_rcp_f32 v137, v137
  v_mfma_f32_16x16x32_bf16 v[92:95], v[60:63], a[156:159], v[92:95]
  ds_read_b64_tr_b16 v[56:57], v7 offset:4096
  s_waitcnt lgkmcnt(5)
  v_mfma_f32_16x16x32_bf16 v[96:99], v[32:35], a[128:131], v[96:99]
  v_mul_f32 v153, v137, v153
  v_mul_f32 v138, s77, v138
  v_mfma_f32_16x16x32_bf16 v[96:99], v[36:39], a[144:147], v[96:99]
  ds_read_b64_tr_b16 v[58:59], v7 offset:4608
  v_mul_f32 v155, v139, v155
  v_mfma_f32_16x16x32_bf16 v[100:103], v[32:35], a[132:135], v[100:103]
  v_exp_f32 v138, v138
  v_mfma_f32_16x16x32_bf16 v[100:103], v[36:39], a[148:151], v[100:103]
  ds_read_b64_tr_b16 v[60:61], v7 offset:12288
  v_add_f32 v138, 1.0, v138
  v_mfma_f32_16x16x32_bf16 v[104:107], v[32:35], a[136:139], v[104:107]
  v_rcp_f32 v138, v138
  v_mfma_f32_16x16x32_bf16 v[104:107], v[36:39], a[152:155], v[104:107]
  ds_read_b64_tr_b16 v[62:63], v7 offset:12800
  s_add_u32 m0, s74, 81920
  v_mfma_f32_16x16x32_bf16 v[108:111], v[32:35], a[140:143], v[108:111]
  buffer_load_dwordx4 v17, s[40:43], s73 offen lds
  v_mfma_f32_16x16x32_bf16 v[108:111], v[36:39], a[156:159], v[108:111]
  ds_read_b64_tr_b16 v[32:33], v8 offset:0
  v_mul_f32 v154, v138, v154
  v_mfma_f32_16x16x32_bf16 v[112:115], v[40:43], a[128:131], v[112:115]
  v_mul_f32 v139, s77, v139
  v_mul_f32 v184, v168, v184
  v_mfma_f32_16x16x32_bf16 v[112:115], v[44:47], a[144:147], v[112:115]
  ds_read_b64_tr_b16 v[34:35], v8 offset:512
  v_mul_f32 v168, s77, v168
  v_mfma_f32_16x16x32_bf16 v[116:119], v[40:43], a[132:135], v[116:119]
  buffer_load_dwordx4 v18, s[40:43], s73 offen offset:1024 lds
  v_mfma_f32_16x16x32_bf16 v[116:119], v[44:47], a[148:151], v[116:119]
  ds_read_b64_tr_b16 v[36:37], v8 offset:8192
  v_mul_f32 v185, v169, v185
  v_mfma_f32_16x16x32_bf16 v[120:123], v[40:43], a[136:139], v[120:123]
  v_exp_f32 v139, v139
  v_mfma_f32_16x16x32_bf16 v[120:123], v[44:47], a[152:155], v[120:123]
  ds_read_b64_tr_b16 v[38:39], v8 offset:8704
  v_add_f32 v139, 1.0, v139
  v_mfma_f32_16x16x32_bf16 v[124:127], v[40:43], a[140:143], v[124:127]
  v_rcp_f32 v139, v139
  v_mfma_f32_16x16x32_bf16 v[124:127], v[44:47], a[156:159], v[124:127]
  ds_read_b64_tr_b16 v[40:41], v8 offset:4096
  s_waitcnt lgkmcnt(5)
  v_mfma_f32_16x16x32_bf16 v[64:67], v[48:51], a[160:163], v[64:67]
  buffer_load_dwordx4 v19, s[40:43], s73 offen offset:2048 lds
  v_mfma_f32_16x16x32_bf16 v[64:67], v[52:55], a[176:179], v[64:67]
  ds_read_b64_tr_b16 v[42:43], v8 offset:4608
  v_mul_f32 v155, v139, v155
  v_mfma_f32_16x16x32_bf16 v[68:71], v[48:51], a[164:167], v[68:71]
  v_exp_f32 v168, v168
  v_mfma_f32_16x16x32_bf16 v[68:71], v[52:55], a[180:183], v[68:71]
  ds_read_b64_tr_b16 v[44:45], v8 offset:12288
  v_add_f32 v168, 1.0, v168
  v_mfma_f32_16x16x32_bf16 v[72:75], v[48:51], a[168:171], v[72:75]
  buffer_load_dwordx4 v20, s[40:43], s73 offen offset:3072 lds
  v_mfma_f32_16x16x32_bf16 v[72:75], v[52:55], a[184:187], v[72:75]
  ds_read_b64_tr_b16 v[46:47], v8 offset:12800
  v_mul_f32 v169, s77, v169
  v_mfma_f32_16x16x32_bf16 v[76:79], v[48:51], a[172:175], v[76:79]
  s_barrier
  v_mfma_f32_16x16x32_bf16 v[76:79], v[52:55], a[188:191], v[76:79]
  ds_read_b64_tr_b16 v[48:49], v7 offset:16384
  v_mul_f32 v186, v170, v186
  v_mfma_f32_16x16x32_bf16 v[80:83], v[56:59], a[160:163], v[80:83]
  v_rcp_f32 v168, v168
  v_mfma_f32_16x16x32_bf16 v[80:83], v[60:63], a[176:179], v[80:83]
  ds_read_b64_tr_b16 v[50:51], v7 offset:16896
  s_add_u32 s73, s73, s96
  v_mfma_f32_16x16x32_bf16 v[84:87], v[56:59], a[164:167], v[84:87]
  v_exp_f32 v169, v169
  v_mfma_f32_16x16x32_bf16 v[84:87], v[60:63], a[180:183], v[84:87]
  ds_read_b64_tr_b16 v[52:53], v7 offset:24576
  s_add_u32 m0, s74, 49152
k1_pg3:
  s_cbranch_execz k1_pg7
  v_mfma_f32_16x16x32_bf16 v[88:91], v[56:59], a[168:171], v[88:91]
  buffer_load_dwordx4 v17, s[40:43], s73 offen lds
  v_mfma_f32_16x16x32_bf16 v[88:91], v[60:63], a[184:187], v[88:91]
  ds_read_b64_tr_b16 v[54:55], v7 offset:25088
  v_mul_f32 v184, v168, v184
  v_mfma_f32_16x16x32_bf16 v[92:95], v[56:59], a[172:175], v[92:95]
  buffer_load_dwordx4 v18, s[40:43], s73 offen offset:1024 lds
  v_mfma_f32_16x16x32_bf16 v[92:95], v[60:63], a[188:191], v[92:95]
  ds_read_b64_tr_b16 v[56:57], v7 offset:20480
  s_waitcnt lgkmcnt(5)
  v_mfma_f32_16x16x32_bf16 v[96:99], v[32:35], a[160:163], v[96:99]
  v_add_f32 v169, 1.0, v169
  v_mul_f32 v170, s77, v170
  v_mfma_f32_16x16x32_bf16 v[96:99], v[36:39], a[176:179], v[96:99]
  ds_read_b64_tr_b16 v[58:59], v7 offset:20992
  v_mul_f32 v187, v171, v187
  v_mfma_f32_16x16x32_bf16 v[100:103], v[32:35], a[164:167], v[100:103]
  buffer_load_dwordx4 v19, s[40:43], s73 offen offset:2048 lds
  v_mfma_f32_16x16x32_bf16 v[100:103], v[36:39], a[180:183], v[100:103]
  ds_read_b64_tr_b16 v[60:61], v7 offset:28672
  v_mul_f32 v171, s77, v171
  v_mfma_f32_16x16x32_bf16 v[104:107], v[32:35], a[168:171], v[104:107]
  v_rcp_f32 v169, v169
  v_mfma_f32_16x16x32_bf16 v[104:107], v[36:39], a[184:187], v[104:107]
  ds_read_b64_tr_b16 v[62:63], v7 offset:29184
  v_mul_f32 v185, v169, v185
  v_mfma_f32_16x16x32_bf16 v[108:111], v[32:35], a[172:175], v[108:111]
  v_exp_f32 v170, v170
  v_mfma_f32_16x16x32_bf16 v[108:111], v[36:39], a[188:191], v[108:111]
  ds_read_b64_tr_b16 v[32:33], v8 offset:16384
  v_add_f32 v170, 1.0, v170
  v_mfma_f32_16x16x32_bf16 v[112:115], v[40:43], a[160:163], v[112:115]
  buffer_load_dwordx4 v20, s[40:43], s73 offen offset:3072 lds
  v_mfma_f32_16x16x32_bf16 v[112:115], v[44:47], a[176:179], v[112:115]
  ds_read_b64_tr_b16 v[34:35], v8 offset:16896
  v_cvt_pk_bf16_f32 v136, v152, v153
  v_mfma_f32_16x16x32_bf16 v[116:119], v[40:43], a[164:167], v[116:119]
  v_rcp_f32 v170, v170
  v_mfma_f32_16x16x32_bf16 v[116:119], v[44:47], a[180:183], v[116:119]
  ds_read_b64_tr_b16 v[36:37], v8 offset:24576
  v_mul_f32 v186, v170, v186
  v_mfma_f32_16x16x32_bf16 v[120:123], v[40:43], a[168:171], v[120:123]
  v_exp_f32 v171, v171
  v_mfma_f32_16x16x32_bf16 v[120:123], v[44:47], a[184:187], v[120:123]
  ds_read_b64_tr_b16 v[38:39], v8 offset:25088
  s_add_u32 s73, s73, 589824
  v_mfma_f32_16x16x32_bf16 v[124:127], v[40:43], a[172:175], v[124:127]
  s_add_u32 m0, s74, 147456
  v_add_f32 v171, 1.0, v171
  v_mfma_f32_16x16x32_bf16 v[124:127], v[44:47], a[188:191], v[124:127]
  ds_read_b64_tr_b16 v[40:41], v8 offset:20480
  s_waitcnt lgkmcnt(5)
  v_mfma_f32_16x16x32_bf16 v[64:67], v[48:51], a[192:195], v[64:67]
  buffer_load_dwordx4 v17, s[40:43], s73 offen lds
  v_mfma_f32_16x16x32_bf16 v[64:67], v[52:55], a[208:211], v[64:67]
  ds_read_b64_tr_b16 v[42:43], v8 offset:20992
  v_cvt_pk_bf16_f32 v137, v154, v155
  v_mfma_f32_16x16x32_bf16 v[68:71], v[48:51], a[196:199], v[68:71]
  buffer_load_dwordx4 v18, s[40:43], s73 offen offset:1024 lds
  v_mfma_f32_16x16x32_bf16 v[68:71], v[52:55], a[212:215], v[68:71]
  ds_read_b64_tr_b16 v[44:45], v8 offset:28672
  v_cvt_pk_bf16_f32 v138, v184, v185
  v_mfma_f32_16x16x32_bf16 v[72:75], v[48:51], a[200:203], v[72:75]
  v_rcp_f32 v171, v171
  v_mfma_f32_16x16x32_bf16 v[72:75], v[52:55], a[216:219], v[72:75]
  ds_read_b64_tr_b16 v[46:47], v8 offset:29184
  v_mul_f32 v187, v171, v187
  v_mfma_f32_16x16x32_bf16 v[76:79], v[48:51], a[204:207], v[76:79]
  s_waitcnt vmcnt(15)
  s_barrier
  v_mfma_f32_16x16x32_bf16 v[76:79], v[52:55], a[220:223], v[76:79]
  ds_read_b64_tr_b16 v[48:49], v11 offset:0
  v_cvt_pk_bf16_f32 v139, v186, v187
  v_mfma_f32_16x16x32_bf16 v[80:83], v[56:59], a[192:195], v[80:83]
  buffer_load_dwordx4 v19, s[40:43], s73 offen offset:2048 lds
  v_mfma_f32_16x16x32_bf16 v[80:83], v[60:63], a[208:211], v[80:83]
  ds_read_b64_tr_b16 v[50:51], v11 offset:512
  v_mul_f32 v156, v140, v156
  v_mfma_f32_16x16x32_bf16 v[84:87], v[56:59], a[196:199], v[84:87]
  buffer_load_dwordx4 v20, s[40:43], s73 offen offset:3072 lds
  v_mfma_f32_16x16x32_bf16 v[84:87], v[60:63], a[212:215], v[84:87]
  ds_read_b64_tr_b16 v[52:53], v11 offset:8192
  v_mul_f32 v140, s77, v140
  v_mfma_f32_16x16x32_bf16 v[88:91], v[56:59], a[200:203], v[88:91]
  s_cmp_eq_u32 s70, 1
  s_cselect_b32 s71, s2, 2147418112
  v_mfma_f32_16x16x32_bf16 v[88:91], v[60:63], a[216:219], v[88:91]
  ds_read_b64_tr_b16 v[54:55], v11 offset:8704
  v_mul_f32 v157, v141, v157
  v_mfma_f32_16x16x32_bf16 v[92:95], v[56:59], a[204:207], v[92:95]
  ds_write_b128 v28, v[136:139] offset:2048
  v_mfma_f32_16x16x32_bf16 v[92:95], v[60:63], a[220:223], v[92:95]
  ds_read_b64_tr_b16 v[56:57], v11 offset:4096
  s_waitcnt lgkmcnt(6)
  v_mfma_f32_16x16x32_bf16 v[96:99], v[32:35], a[192:195], v[96:99]
  buffer_store_dwordx4 v[136:139], v26, s[48:51], s24 offen offset:2048 sc1
  v_mfma_f32_16x16x32_bf16 v[96:99], v[36:39], a[208:211], v[96:99]
  v_exp_f32 v140, v140
  v_mfma_f32_16x16x32_bf16 v[100:103], v[32:35], a[196:199], v[100:103]
  ds_read_b64_tr_b16 v[58:59], v11 offset:4608
  s_add_u32 s73, s73, 589824
  v_mfma_f32_16x16x32_bf16 v[100:103], v[36:39], a[212:215], v[100:103]
  v_add_f32 v140, 1.0, v140
  ds_read_b64_tr_b16 v[60:61], v11 offset:12288
  v_mfma_f32_16x16x32_bf16 v[104:107], v[32:35], a[200:203], v[104:107]
  s_add_u32 m0, s74, 98304
  s_nop 0
  buffer_load_dwordx4 v17, s[40:43], s73 offen lds
  v_mfma_f32_16x16x32_bf16 v[104:107], v[36:39], a[216:219], v[104:107]
  v_rcp_f32 v140, v140
  v_mfma_f32_16x16x32_bf16 v[108:111], v[32:35], a[204:207], v[108:111]
  ds_read_b64_tr_b16 v[62:63], v11 offset:12800
  v_mul_f32 v156, v140, v156
  v_mfma_f32_16x16x32_bf16 v[108:111], v[36:39], a[220:223], v[108:111]
  v_mul_f32 v141, s77, v141
  ds_read_b64_tr_b16 v[32:33], v12 offset:0
  v_mfma_f32_16x16x32_bf16 v[112:115], v[40:43], a[192:195], v[112:115]
  buffer_load_dwordx4 v18, s[40:43], s73 offen offset:1024 lds
  v_mfma_f32_16x16x32_bf16 v[112:115], v[44:47], a[208:211], v[112:115]
  v_exp_f32 v141, v141
  v_mfma_f32_16x16x32_bf16 v[116:119], v[40:43], a[196:199], v[116:119]
  ds_read_b64_tr_b16 v[34:35], v12 offset:512
  v_add_f32 v141, 1.0, v141
  v_mfma_f32_16x16x32_bf16 v[116:119], v[44:47], a[212:215], v[116:119]
  ds_read_b64_tr_b16 v[36:37], v12 offset:8192
  v_mul_f32 v158, v142, v158
  v_mfma_f32_16x16x32_bf16 v[120:123], v[40:43], a[200:203], v[120:123]
  buffer_load_dwordx4 v19, s[40:43], s73 offen offset:2048 lds
  v_mfma_f32_16x16x32_bf16 v[120:123], v[44:47], a[216:219], v[120:123]
  v_rcp_f32 v141, v141
  v_mfma_f32_16x16x32_bf16 v[124:127], v[40:43], a[204:207], v[124:127]
  ds_read_b64_tr_b16 v[38:39], v12 offset:8704
  v_mul_f32 v157, v141, v157
  v_mfma_f32_16x16x32_bf16 v[124:127], v[44:47], a[220:223], v[124:127]
  v_mul_f32 v142, s77, v142
  s_waitcnt lgkmcnt(4)
  v_mfma_f32_16x16x32_bf16 v[64:67], v[48:51], a[224:227], v[64:67]
  buffer_store_byte v241, v240, s[60:63], s71 offen sc1
  v_mfma_f32_16x16x32_bf16 v[64:67], v[52:55], a[240:243], v[64:67]
  v_exp_f32 v142, v142
  v_mfma_f32_16x16x32_bf16 v[68:71], v[48:51], a[228:231], v[68:71]
  ds_read_b64_tr_b16 v[40:41], v12 offset:4096
  v_add_f32 v142, 1.0, v142
  v_mfma_f32_16x16x32_bf16 v[68:71], v[52:55], a[244:247], v[68:71]
  buffer_load_dwordx4 v20, s[40:43], s73 offen offset:3072 lds
  v_mfma_f32_16x16x32_bf16 v[72:75], v[48:51], a[232:235], v[72:75]
  ds_read_b64_tr_b16 v[42:43], v12 offset:4608
  s_add_u32 s73, s73, 589824
  v_mfma_f32_16x16x32_bf16 v[72:75], v[52:55], a[248:251], v[72:75]
  v_rcp_f32 v142, v142
  v_mul_f32 v159, v143, v159
  v_mfma_f32_16x16x32_bf16 v[76:79], v[48:51], a[236:239], v[76:79]
  s_waitcnt vmcnt(14)
  s_barrier
  v_mfma_f32_16x16x32_bf16 v[76:79], v[52:55], a[252:255], v[76:79]
  s_add_u32 m0, s74, 65536
  s_nop 0
  buffer_load_dwordx4 v17, s[40:43], s73 offen lds
  v_mul_f32 v158, v142, v158
  v_mul_f32 v143, s77, v143
  v_mfma_f32_16x16x32_bf16 v[80:83], v[56:59], a[224:227], v[80:83]
  ds_read_b64_tr_b16 v[44:45], v12 offset:12288
  v_mul_f32 v188, v172, v188
  v_mfma_f32_16x16x32_bf16 v[80:83], v[60:63], a[240:243], v[80:83]
  v_exp_f32 v143, v143
  v_mfma_f32_16x16x32_bf16 v[84:87], v[56:59], a[228:231], v[84:87]
  ds_read_b64_tr_b16 v[46:47], v12 offset:12800
  v_add_f32 v143, 1.0, v143
  v_mfma_f32_16x16x32_bf16 v[84:87], v[60:63], a[244:247], v[84:87]
  ds_read_b64_tr_b16 v[48:49], v9 offset:16384
  v_mul_f32 v172, s77, v172
  v_mfma_f32_16x16x32_bf16 v[88:91], v[56:59], a[232:235], v[88:91]
  buffer_load_dwordx4 v18, s[40:43], s73 offen offset:1024 lds
  v_mfma_f32_16x16x32_bf16 v[88:91], v[60:63], a[248:251], v[88:91]
  v_rcp_f32 v143, v143
  v_mfma_f32_16x16x32_bf16 v[92:95], v[56:59], a[236:239], v[92:95]
  ds_read_b64_tr_b16 v[50:51], v9 offset:16896
  v_mul_f32 v159, v143, v159
  v_mfma_f32_16x16x32_bf16 v[92:95], v[60:63], a[252:255], v[92:95]
  ds_read_b64_tr_b16 v[52:53], v9 offset:24576
  s_waitcnt lgkmcnt(3)
  v_mfma_f32_16x16x32_bf16 v[96:99], v[32:35], a[224:227], v[96:99]
  ds_read_b64_tr_b16 v[54:55], v9 offset:25088
  v_mul_f32 v189, v173, v189
  v_mfma_f32_16x16x32_bf16 v[96:99], v[36:39], a[240:243], v[96:99]
  buffer_load_dwordx4 v19, s[40:43], s73 offen offset:2048 lds
  v_exp_f32 v172, v172
  v_mfma_f32_16x16x32_bf16 v[100:103], v[32:35], a[228:231], v[100:103]
  ds_read_b64_tr_b16 v[56:57], v9 offset:20480
  v_add_f32 v172, 1.0, v172
  v_mfma_f32_16x16x32_bf16 v[100:103], v[36:39], a[244:247], v[100:103]
  ds_read_b64_tr_b16 v[58:59], v9 offset:20992
  v_mul_f32 v173, s77, v173
  v_mfma_f32_16x16x32_bf16 v[104:107], v[32:35], a[232:235], v[104:107]
  ds_read_b64_tr_b16 v[60:61], v9 offset:28672
  v_mul_f32 v190, v174, v190
  v_mfma_f32_16x16x32_bf16 v[104:107], v[36:39], a[248:251], v[104:107]
  v_rcp_f32 v172, v172
  v_mfma_f32_16x16x32_bf16 v[108:111], v[32:35], a[236:239], v[108:111]
  buffer_load_dwordx4 v20, s[40:43], s73 offen offset:3072 lds
  v_mfma_f32_16x16x32_bf16 v[108:111], v[36:39], a[252:255], v[108:111]
  v_mul_f32 v188, v172, v188
  ds_read_b64_tr_b16 v[62:63], v9 offset:29184
  v_mfma_f32_16x16x32_bf16 v[112:115], v[40:43], a[224:227], v[112:115]
  ds_read_b64_tr_b16 v[32:33], v10 offset:16384
  s_add_u32 s73, s73, 589824
  v_mfma_f32_16x16x32_bf16 v[112:115], v[44:47], a[240:243], v[112:115]
  v_exp_f32 v173, v173
  v_mfma_f32_16x16x32_bf16 v[116:119], v[40:43], a[228:231], v[116:119]
  s_add_u32 m0, s74, 114688
  s_nop 0
  buffer_load_dwordx4 v17, s[40:43], s73 offen lds
  v_mfma_f32_16x16x32_bf16 v[116:119], v[44:47], a[244:247], v[116:119]
  v_add_f32 v173, 1.0, v173
  ds_read_b64_tr_b16 v[34:35], v10 offset:16896
  v_mfma_f32_16x16x32_bf16 v[120:123], v[40:43], a[232:235], v[120:123]
  ds_read_b64_tr_b16 v[36:37], v10 offset:24576
  v_mul_f32 v174, s77, v174
  v_mfma_f32_16x16x32_bf16 v[120:123], v[44:47], a[248:251], v[120:123]
  v_rcp_f32 v173, v173
  v_mfma_f32_16x16x32_bf16 v[124:127], v[40:43], a[236:239], v[124:127]
  ds_read_b64_tr_b16 v[38:39], v10 offset:25088
  v_mul_f32 v189, v173, v189
  v_mfma_f32_16x16x32_bf16 v[124:127], v[44:47], a[252:255], v[124:127]
  buffer_load_dwordx4 v18, s[40:43], s73 offen offset:1024 lds
  s_waitcnt lgkmcnt(4)
  v_mfma_f32_16x16x32_bf16 v[64:67], v[48:51], v[192:195], v[64:67]
  ds_read_b64_tr_b16 v[40:41], v10 offset:20480
  v_mul_f32 v191, v175, v191
  v_mfma_f32_16x16x32_bf16 v[64:67], v[52:55], v[208:211], v[64:67]
  v_exp_f32 v174, v174
  v_mfma_f32_16x16x32_bf16 v[68:71], v[48:51], v[196:199], v[68:71]
  ds_read_b64_tr_b16 v[42:43], v10 offset:20992
  v_add_f32 v174, 1.0, v174
  v_mfma_f32_16x16x32_bf16 v[68:71], v[52:55], v[212:215], v[68:71]
  ds_read_b64_tr_b16 v[44:45], v10 offset:28672
  v_mul_f32 v175, s77, v175
  v_mfma_f32_16x16x32_bf16 v[72:75], v[48:51], v[200:203], v[72:75]
  buffer_load_dwordx4 v19, s[40:43], s73 offen offset:2048 lds
  v_mfma_f32_16x16x32_bf16 v[72:75], v[52:55], v[216:219], v[72:75]
  v_rcp_f32 v174, v174
  v_mfma_f32_16x16x32_bf16 v[76:79], v[48:51], v[204:207], v[76:79]
  s_waitcnt vmcnt(17)
  s_barrier
  v_mfma_f32_16x16x32_bf16 v[76:79], v[52:55], v[220:223], v[76:79]
  v_mul_f32 v190, v174, v190
  ds_read_b64_tr_b16 v[46:47], v10 offset:29184
  v_mfma_f32_16x16x32_bf16 v[80:83], v[56:59], v[192:195], v[80:83]
  ds_read_b64_tr_b16 v[48:49], v7 offset:49152
  v_cvt_pk_bf16_f32 v140, v156, v157
  v_mfma_f32_16x16x32_bf16 v[80:83], v[60:63], v[208:211], v[80:83]
  buffer_load_dwordx4 v20, s[40:43], s73 offen offset:3072 lds
  v_exp_f32 v175, v175
  v_mfma_f32_16x16x32_bf16 v[84:87], v[56:59], v[196:199], v[84:87]
  ds_read_b64_tr_b16 v[50:51], v7 offset:49664
  s_add_u32 s73, s73, 589824
  v_mfma_f32_16x16x32_bf16 v[84:87], v[60:63], v[212:215], v[84:87]
  v_add_f32 v175, 1.0, v175
  ds_read_b64_tr_b16 v[52:53], v7 offset:57344
  v_mfma_f32_16x16x32_bf16 v[88:91], v[56:59], v[200:203], v[88:91]
  v_rcp_f32 v175, v175
  v_mfma_f32_16x16x32_bf16 v[88:91], v[60:63], v[216:219], v[88:91]
  s_add_u32 m0, s74, 0
  s_nop 0
  buffer_load_dwordx4 v17, s[40:43], s73 offen lds
  v_mfma_f32_16x16x32_bf16 v[92:95], v[56:59], v[204:207], v[92:95]
  ds_read_b64_tr_b16 v[54:55], v7 offset:57856
  v_mul_f32 v191, v175, v191
  v_mfma_f32_16x16x32_bf16 v[92:95], v[60:63], v[220:223], v[92:95]
  ds_read_b64_tr_b16 v[56:57], v7 offset:53248
  s_waitcnt lgkmcnt(5)
  v_mfma_f32_16x16x32_bf16 v[96:99], v[32:35], v[192:195], v[96:99]
  buffer_load_dwordx4 v18, s[40:43], s73 offen offset:1024 lds
  v_mfma_f32_16x16x32_bf16 v[96:99], v[36:39], v[208:211], v[96:99]
  ds_read_b64_tr_b16 v[58:59], v7 offset:53760
  v_cvt_pk_bf16_f32 v141, v158, v159
  v_mfma_f32_16x16x32_bf16 v[100:103], v[32:35], v[196:199], v[100:103]
  buffer_load_dwordx4 v19, s[40:43], s73 offen offset:2048 lds
  v_mfma_f32_16x16x32_bf16 v[100:103], v[36:39], v[212:215], v[100:103]
  v_cvt_pk_bf16_f32 v142, v188, v189
  ds_read_b64_tr_b16 v[60:61], v7 offset:61440
  v_mfma_f32_16x16x32_bf16 v[104:107], v[32:35], v[200:203], v[104:107]
  v_cvt_pk_bf16_f32 v143, v190, v191
  v_mfma_f32_16x16x32_bf16 v[104:107], v[36:39], v[216:219], v[104:107]
  ds_read_b64_tr_b16 v[62:63], v7 offset:61952
  v_mfma_f32_16x16x32_bf16 v[108:111], v[32:35], v[204:207], v[108:111]
  buffer_load_dwordx4 v20, s[40:43], s73 offen offset:3072 lds
  v_mfma_f32_16x16x32_bf16 v[108:111], v[36:39], v[220:223], v[108:111]
  ds_write_b128 v28, v[140:143] offset:3072
  v_mfma_f32_16x16x32_bf16 v[112:115], v[40:43], v[192:195], v[112:115]
  ds_read_b64_tr_b16 v[32:33], v8 offset:49152
  v_mfma_f32_16x16x32_bf16 v[112:115], v[44:47], v[208:211], v[112:115]
  buffer_store_dwordx4 v[140:143], v26, s[48:51], s24 offen offset:3072 sc1
  v_mfma_f32_16x16x32_bf16 v[116:119], v[40:43], v[196:199], v[116:119]
  ds_read_b64_tr_b16 v[34:35], v8 offset:49664
  v_mfma_f32_16x16x32_bf16 v[116:119], v[44:47], v[212:215], v[116:119]
  ds_read_b64_tr_b16 v[36:37], v8 offset:57344
  s_add_u32 s73, s73, 589824
  v_mfma_f32_16x16x32_bf16 v[120:123], v[40:43], v[200:203], v[120:123]
  s_add_u32 m0, s74, 16384
  v_mfma_f32_16x16x32_bf16 v[120:123], v[44:47], v[216:219], v[120:123]
  ds_read_b64_tr_b16 v[38:39], v8 offset:57856
  v_mfma_f32_16x16x32_bf16 v[124:127], v[40:43], v[204:207], v[124:127]
  buffer_load_dwordx4 v17, s[40:43], s73 offen lds
  v_mfma_f32_16x16x32_bf16 v[124:127], v[44:47], v[220:223], v[124:127]
  ds_read_b64_tr_b16 v[40:41], v8 offset:53248
  s_waitcnt lgkmcnt(6)
  v_mfma_f32_16x16x32_bf16 v[128:131], v[48:51], a[0:3], 0
  buffer_load_dwordx4 v18, s[40:43], s73 offen offset:1024 lds
  v_mfma_f32_16x16x32_bf16 v[128:131], v[52:55], a[16:19], v[128:131]
  ds_read_b64_tr_b16 v[42:43], v8 offset:53760
  v_mfma_f32_16x16x32_bf16 v[132:135], v[48:51], a[4:7], 0
  v_mul_f32 v80, v64, v80
  v_mul_f32 v81, v65, v81
  v_mfma_f32_16x16x32_bf16 v[132:135], v[52:55], a[20:23], v[132:135]
  ds_read_b64_tr_b16 v[44:45], v8 offset:61440
  v_mul_f32 v64, s77, v64
  v_mfma_f32_16x16x32_bf16 v[136:139], v[48:51], a[8:11], 0
  buffer_load_dwordx4 v19, s[40:43], s73 offen offset:2048 lds
  v_mfma_f32_16x16x32_bf16 v[136:139], v[52:55], a[24:27], v[136:139]
  ds_read_b64_tr_b16 v[46:47], v8 offset:61952
  v_mul_f32 v65, s77, v65
  v_mfma_f32_16x16x32_bf16 v[140:143], v[48:51], a[12:15], 0
  s_waitcnt vmcnt(22)
  s_barrier
  v_mfma_f32_16x16x32_bf16 v[140:143], v[52:55], a[28:31], v[140:143]
  ds_read_b64_tr_b16 v[48:49], v11 offset:16384
  v_mul_f32 v82, v66, v82
  v_mfma_f32_16x16x32_bf16 v[144:147], v[56:59], a[0:3], 0
  v_exp_f32 v64, v64
  v_mfma_f32_16x16x32_bf16 v[144:147], v[60:63], a[16:19], v[144:147]
  ds_read_b64_tr_b16 v[50:51], v11 offset:16896
  v_add_f32 v64, 1.0, v64
  v_mfma_f32_16x16x32_bf16 v[148:151], v[56:59], a[4:7], 0
  buffer_load_dwordx4 v20, s[40:43], s73 offen offset:3072 lds
  v_mfma_f32_16x16x32_bf16 v[148:151], v[60:63], a[20:23], v[148:151]
  ds_read_b64_tr_b16 v[52:53], v11 offset:24576
  v_mul_f32 v66, s77, v66
  v_mfma_f32_16x16x32_bf16 v[152:155], v[56:59], a[8:11], 0
  v_rcp_f32 v64, v64
  v_mfma_f32_16x16x32_bf16 v[152:155], v[60:63], a[24:27], v[152:155]
  ds_read_b64_tr_b16 v[54:55], v11 offset:25088
  v_mul_f32 v80, v64, v80
  v_mfma_f32_16x16x32_bf16 v[156:159], v[56:59], a[12:15], 0
  v_exp_f32 v65, v65
  v_mfma_f32_16x16x32_bf16 v[156:159], v[60:63], a[28:31], v[156:159]
  ds_read_b64_tr_b16 v[56:57], v11 offset:20480
  s_waitcnt lgkmcnt(5)
  v_mfma_f32_16x16x32_bf16 v[160:163], v[32:35], a[0:3], 0
  s_cmp_eq_u32 s70, 2
  s_cselect_b32 s71, s2, 2147418112
  v_mfma_f32_16x16x32_bf16 v[160:163], v[36:39], a[16:19], v[160:163]
  ds_read_b64_tr_b16 v[58:59], v11 offset:20992
  s_add_u32 s73, s73, 589824
  v_mfma_f32_16x16x32_bf16 v[164:167], v[32:35], a[4:7], 0
  v_exp_f32 v66, v66
  v_mfma_f32_16x16x32_bf16 v[164:167], v[36:39], a[20:23], v[164:167]
  s_add_u32 m0, s74, 131072
  s_nop 0
  buffer_load_dwordx4 v17, s[40:43], s73 offen lds
  v_mfma_f32_16x16x32_bf16 v[168:171], v[32:35], a[8:11], 0
  ds_read_b64_tr_b16 v[60:61], v11 offset:28672
  v_add_f32 v65, 1.0, v65
  v_mfma_f32_16x16x32_bf16 v[168:171], v[36:39], a[24:27], v[168:171]
  ds_read_b64_tr_b16 v[62:63], v11 offset:29184
  v_add_f32 v66, 1.0, v66
  v_mfma_f32_16x16x32_bf16 v[172:175], v[32:35], a[12:15], 0
  buffer_load_dwordx4 v18, s[40:43], s73 offen offset:1024 lds
  v_mfma_f32_16x16x32_bf16 v[172:175], v[36:39], a[28:31], v[172:175]
  ds_read_b64_tr_b16 v[32:33], v12 offset:16384
  v_mul_f32 v83, v67, v83
  v_mfma_f32_16x16x32_bf16 v[176:179], v[40:43], a[0:3], 0
  buffer_load_dwordx4 v19, s[40:43], s73 offen offset:2048 lds
  v_mfma_f32_16x16x32_bf16 v[176:179], v[44:47], a[16:19], v[176:179]
  ds_read_b64_tr_b16 v[34:35], v12 offset:16896
  v_mul_f32 v67, s77, v67
  v_mfma_f32_16x16x32_bf16 v[180:183], v[40:43], a[4:7], 0
  buffer_store_byte v241, v240, s[60:63], s71 offen sc1
  v_mfma_f32_16x16x32_bf16 v[180:183], v[44:47], a[20:23], v[180:183]
  ds_read_b64_tr_b16 v[36:37], v12 offset:24576
  v_mul_f32 v112, v96, v112
  v_mfma_f32_16x16x32_bf16 v[184:187], v[40:43], a[8:11], 0
  buffer_load_dwordx4 v20, s[40:43], s73 offen offset:3072 lds
  v_mfma_f32_16x16x32_bf16 v[184:187], v[44:47], a[24:27], v[184:187]
  v_rcp_f32 v65, v65
  v_mfma_f32_16x16x32_bf16 v[188:191], v[40:43], a[12:15], 0
  ds_read_b64_tr_b16 v[38:39], v12 offset:25088
  v_mul_f32 v81, v65, v81
  v_mfma_f32_16x16x32_bf16 v[188:191], v[44:47], a[28:31], v[188:191]
  ds_read_b64_tr_b16 v[40:41], v12 offset:20480
  s_waitcnt lgkmcnt(5)
  v_mfma_f32_16x16x32_bf16 v[128:131], v[48:51], a[32:35], v[128:131]
  v_rcp_f32 v66, v66
  v_mfma_f32_16x16x32_bf16 v[128:131], v[52:55], a[48:51], v[128:131]
  ds_read_b64_tr_b16 v[42:43], v12 offset:20992
  s_add_u32 s73, s73, 589824
  v_mfma_f32_16x16x32_bf16 v[132:135], v[48:51], a[36:39], v[132:135]
  buffer_load_dword v253, v22, s[40:43], s80 offen
  v_mfma_f32_16x16x32_bf16 v[132:135], v[52:55], a[52:55], v[132:135]
  ds_read_b64_tr_b16 v[44:45], v12 offset:28672
  v_mul_f32 v82, v66, v82
  v_mfma_f32_16x16x32_bf16 v[136:139], v[48:51], a[40:43], v[136:139]
  buffer_load_dword v253, v0, s[44:47], s78 offen
  v_mfma_f32_16x16x32_bf16 v[136:139], v[52:55], a[56:59], v[136:139]
  ds_read_b64_tr_b16 v[46:47], v12 offset:29184
  s_add_u32 s78, s78, 2688
  v_mfma_f32_16x16x32_bf16 v[140:143], v[48:51], a[44:47], v[140:143]
  s_add_u32 s72, s72, s97
  s_add_u32 s72, s72, 4718592
  buffer_load_dword v253, v254, s[40:43], s72 offen
  v_mfma_f32_16x16x32_bf16 v[140:143], v[52:55], a[60:63], v[140:143]
  s_waitcnt vmcnt(25)
  s_barrier
  v_mfma_f32_16x16x32_bf16 v[144:147], v[56:59], a[32:35], v[144:147]
  ds_read_b64_tr_b16 v[48:49], v9 offset:32768
  v_mul_f32 v96, s77, v96
  v_mfma_f32_16x16x32_bf16 v[144:147], v[60:63], a[48:51], v[144:147]
  v_exp_f32 v67, v67
  v_mfma_f32_16x16x32_bf16 v[148:151], v[56:59], a[36:39], v[148:151]
  ds_read_b64_tr_b16 v[50:51], v9 offset:33280
  v_add_f32 v67, 1.0, v67
  v_mfma_f32_16x16x32_bf16 v[148:151], v[60:63], a[52:55], v[148:151]
  ds_read_b64_tr_b16 v[52:53], v9 offset:40960
  v_mul_f32 v113, v97, v113
  v_mfma_f32_16x16x32_bf16 v[152:155], v[56:59], a[40:43], v[152:155]
  v_rcp_f32 v67, v67
  v_mfma_f32_16x16x32_bf16 v[152:155], v[60:63], a[56:59], v[152:155]
  ds_read_b64_tr_b16 v[54:55], v9 offset:41472
  v_mul_f32 v83, v67, v83
  v_mfma_f32_16x16x32_bf16 v[156:159], v[56:59], a[44:47], v[156:159]
  v_exp_f32 v96, v96
  v_mfma_f32_16x16x32_bf16 v[156:159], v[60:63], a[60:63], v[156:159]
  ds_read_b64_tr_b16 v[56:57], v9 offset:36864
  s_waitcnt lgkmcnt(5)
  v_mfma_f32_16x16x32_bf16 v[160:163], v[32:35], a[32:35], v[160:163]
  v_add_f32 v96, 1.0, v96
  v_mul_f32 v97, s77, v97
  v_mfma_f32_16x16x32_bf16 v[160:163], v[36:39], a[48:51], v[160:163]
  ds_read_b64_tr_b16 v[58:59], v9 offset:37376
  v_mul_f32 v114, v98, v114
  v_mfma_f32_16x16x32_bf16 v[164:167], v[32:35], a[36:39], v[164:167]
  v_rcp_f32 v96, v96
  v_mfma_f32_16x16x32_bf16 v[164:167], v[36:39], a[52:55], v[164:167]
  ds_read_b64_tr_b16 v[60:61], v9 offset:45056
  v_mul_f32 v112, v96, v112
  v_mfma_f32_16x16x32_bf16 v[168:171], v[32:35], a[40:43], v[168:171]
  v_exp_f32 v97, v97
  v_mfma_f32_16x16x32_bf16 v[168:171], v[36:39], a[56:59], v[168:171]
  ds_read_b64_tr_b16 v[62:63], v9 offset:45568
  v_add_f32 v97, 1.0, v97
  v_mfma_f32_16x16x32_bf16 v[172:175], v[32:35], a[44:47], v[172:175]
  v_rcp_f32 v97, v97
  v_mfma_f32_16x16x32_bf16 v[172:175], v[36:39], a[60:63], v[172:175]
  ds_read_b64_tr_b16 v[32:33], v10 offset:32768
  v_mul_f32 v113, v97, v113
  v_mfma_f32_16x16x32_bf16 v[176:179], v[40:43], a[32:35], v[176:179]
  v_mul_f32 v98, s77, v98
  v_mul_f32 v115, v99, v115
  v_mfma_f32_16x16x32_bf16 v[176:179], v[44:47], a[48:51], v[176:179]
  ds_read_b64_tr_b16 v[34:35], v10 offset:33280
  v_mul_f32 v99, s77, v99
  v_mfma_f32_16x16x32_bf16 v[180:183], v[40:43], a[36:39], v[180:183]
  v_exp_f32 v98, v98
  v_mfma_f32_16x16x32_bf16 v[180:183], v[44:47], a[52:55], v[180:183]
  ds_read_b64_tr_b16 v[36:37], v10 offset:40960
  v_add_f32 v98, 1.0, v98
  v_mfma_f32_16x16x32_bf16 v[184:187], v[40:43], a[40:43], v[184:187]
  v_rcp_f32 v98, v98
  v_mfma_f32_16x16x32_bf16 v[184:187], v[44:47], a[56:59], v[184:187]
  ds_read_b64_tr_b16 v[38:39], v10 offset:41472
  v_mul_f32 v114, v98, v114
  v_mfma_f32_16x16x32_bf16 v[188:191], v[40:43], a[44:47], v[188:191]
  v_exp_f32 v99, v99
  v_mfma_f32_16x16x32_bf16 v[188:191], v[44:47], a[60:63], v[188:191]
  ds_read_b64_tr_b16 v[40:41], v10 offset:36864
  s_waitcnt lgkmcnt(5)
  v_mfma_f32_16x16x32_bf16 v[128:131], v[48:51], a[64:67], v[128:131]
  v_add_f32 v99, 1.0, v99
  v_cvt_pk_bf16_f32 v64, v80, v81
  v_mfma_f32_16x16x32_bf16 v[128:131], v[52:55], a[80:83], v[128:131]
  ds_read_b64_tr_b16 v[42:43], v10 offset:37376
  v_cvt_pk_bf16_f32 v65, v82, v83
  v_mfma_f32_16x16x32_bf16 v[132:135], v[48:51], a[68:71], v[132:135]
  v_rcp_f32 v99, v99
  v_mfma_f32_16x16x32_bf16 v[132:135], v[52:55], a[84:87], v[132:135]
  ds_read_b64_tr_b16 v[44:45], v10 offset:45056
  v_mul_f32 v115, v99, v115
  v_mfma_f32_16x16x32_bf16 v[136:139], v[48:51], a[72:75], v[136:139]
  v_cvt_pk_bf16_f32 v66, v112, v113
  v_mul_f32 v84, v68, v84
  v_mfma_f32_16x16x32_bf16 v[136:139], v[52:55], a[88:91], v[136:139]
  ds_read_b64_tr_b16 v[46:47], v10 offset:45568
  v_cvt_pk_bf16_f32 v67, v114, v115
  v_mfma_f32_16x16x32_bf16 v[140:143], v[48:51], a[76:79], v[140:143]
  s_waitcnt vmcnt(21)
  s_barrier
  v_mfma_f32_16x16x32_bf16 v[140:143], v[52:55], a[92:95], v[140:143]
  ds_read_b64_tr_b16 v[48:49], v9 offset:0
  v_add_u32 v28, 81920, v26
  v_mfma_f32_16x16x32_bf16 v[144:147], v[56:59], a[64:67], v[144:147]
  ds_write_b128 v28, v[64:67] offset:0
  v_mfma_f32_16x16x32_bf16 v[144:147], v[60:63], a[80:83], v[144:147]
  ds_read_b64_tr_b16 v[50:51], v9 offset:512
  v_mul_f32 v68, s77, v68
  v_mfma_f32_16x16x32_bf16 v[148:151], v[56:59], a[68:71], v[148:151]
  s_add_u32 s24, s24, 16384
  buffer_store_dwordx4 v[64:67], v26, s[48:51], s24 offen offset:0 sc1
  v_mfma_f32_16x16x32_bf16 v[148:151], v[60:63], a[84:87], v[148:151]
  ds_read_b64_tr_b16 v[52:53], v9 offset:8192
  v_mul_f32 v85, v69, v85
  v_mfma_f32_16x16x32_bf16 v[152:155], v[56:59], a[72:75], v[152:155]
  v_exp_f32 v68, v68
  v_mfma_f32_16x16x32_bf16 v[152:155], v[60:63], a[88:91], v[152:155]
  ds_read_b64_tr_b16 v[54:55], v9 offset:8704
  v_add_f32 v68, 1.0, v68
  v_mfma_f32_16x16x32_bf16 v[156:159], v[56:59], a[76:79], v[156:159]
  v_rcp_f32 v68, v68
  v_mfma_f32_16x16x32_bf16 v[156:159], v[60:63], a[92:95], v[156:159]
  ds_read_b64_tr_b16 v[56:57], v9 offset:4096
  s_waitcnt lgkmcnt(6)
  v_mfma_f32_16x16x32_bf16 v[160:163], v[32:35], a[64:67], v[160:163]
  v_mul_f32 v84, v68, v84
  v_mul_f32 v69, s77, v69
  v_mfma_f32_16x16x32_bf16 v[160:163], v[36:39], a[80:83], v[160:163]
  ds_read_b64_tr_b16 v[58:59], v9 offset:4608
  v_mul_f32 v86, v70, v86
  v_mfma_f32_16x16x32_bf16 v[164:167], v[32:35], a[68:71], v[164:167]
  v_exp_f32 v69, v69
  v_mfma_f32_16x16x32_bf16 v[164:167], v[36:39], a[84:87], v[164:167]
  ds_read_b64_tr_b16 v[60:61], v9 offset:12288
  v_add_f32 v69, 1.0, v69
  v_mfma_f32_16x16x32_bf16 v[168:171], v[32:35], a[72:75], v[168:171]
  v_rcp_f32 v69, v69
  v_mfma_f32_16x16x32_bf16 v[168:171], v[36:39], a[88:91], v[168:171]
  ds_read_b64_tr_b16 v[62:63], v9 offset:12800
  v_mul_f32 v85, v69, v85
  v_mfma_f32_16x16x32_bf16 v[172:175], v[32:35], a[76:79], v[172:175]
  v_mul_f32 v70, s77, v70
  v_mul_f32 v87, v71, v87
  v_mfma_f32_16x16x32_bf16 v[172:175], v[36:39], a[92:95], v[172:175]
  ds_read_b64_tr_b16 v[32:33], v10 offset:0
  v_mul_f32 v71, s77, v71
  v_mfma_f32_16x16x32_bf16 v[176:179], v[40:43], a[64:67], v[176:179]
  v_exp_f32 v70, v70
  v_mfma_f32_16x16x32_bf16 v[176:179], v[44:47], a[80:83], v[176:179]
  ds_read_b64_tr_b16 v[34:35], v10 offset:512
  v_add_f32 v70, 1.0, v70
  v_mfma_f32_16x16x32_bf16 v[180:183], v[40:43], a[68:71], v[180:183]
  v_rcp_f32 v70, v70
  v_mfma_f32_16x16x32_bf16 v[180:183], v[44:47], a[84:87], v[180:183]
  ds_read_b64_tr_b16 v[36:37], v10 offset:8192
  v_mul_f32 v86, v70, v86
  v_mfma_f32_16x16x32_bf16 v[184:187], v[40:43], a[72:75], v[184:187]
  v_exp_f32 v71, v71
  v_mfma_f32_16x16x32_bf16 v[184:187], v[44:47], a[88:91], v[184:187]
  ds_read_b64_tr_b16 v[38:39], v10 offset:8704
  v_add_f32 v71, 1.0, v71
  v_mfma_f32_16x16x32_bf16 v[188:191], v[40:43], a[76:79], v[188:191]
  v_rcp_f32 v71, v71
  v_mfma_f32_16x16x32_bf16 v[188:191], v[44:47], a[92:95], v[188:191]
  ds_read_b64_tr_b16 v[40:41], v10 offset:4096
  s_waitcnt lgkmcnt(5)
  v_mfma_f32_16x16x32_bf16 v[128:131], v[48:51], a[96:99], v[128:131]
  v_mul_f32 v87, v71, v87
  v_mul_f32 v116, v100, v116
  v_mfma_f32_16x16x32_bf16 v[128:131], v[52:55], a[112:115], v[128:131]
  ds_read_b64_tr_b16 v[42:43], v10 offset:4608
  v_mul_f32 v100, s77, v100
  v_mfma_f32_16x16x32_bf16 v[132:135], v[48:51], a[100:103], v[132:135]
  v_exp_f32 v100, v100
  v_mfma_f32_16x16x32_bf16 v[132:135], v[52:55], a[116:119], v[132:135]
  ds_read_b64_tr_b16 v[44:45], v10 offset:12288
  v_add_f32 v100, 1.0, v100
  v_mfma_f32_16x16x32_bf16 v[136:139], v[48:51], a[104:107], v[136:139]
  v_rcp_f32 v100, v100
  v_mfma_f32_16x16x32_bf16 v[136:139], v[52:55], a[120:123], v[136:139]
  ds_read_b64_tr_b16 v[46:47], v10 offset:12800
  v_mul_f32 v116, v100, v116
  v_mfma_f32_16x16x32_bf16 v[140:143], v[48:51], a[108:111], v[140:143]
  s_waitcnt vmcnt(18)
  s_barrier
  v_mfma_f32_16x16x32_bf16 v[140:143], v[52:55], a[124:127], v[140:143]
  ds_read_b64_tr_b16 v[48:49], v9 offset:49152
  v_mul_f32 v117, v101, v117
  v_mfma_f32_16x16x32_bf16 v[144:147], v[56:59], a[96:99], v[144:147]
  v_mul_f32 v101, s77, v101
  v_mul_f32 v118, v102, v118
  v_mfma_f32_16x16x32_bf16 v[144:147], v[60:63], a[112:115], v[144:147]
  ds_read_b64_tr_b16 v[50:51], v9 offset:49664
  v_mul_f32 v102, s77, v102
  v_mfma_f32_16x16x32_bf16 v[148:151], v[56:59], a[100:103], v[148:151]
  v_exp_f32 v101, v101
  v_mfma_f32_16x16x32_bf16 v[148:151], v[60:63], a[116:119], v[148:151]
  ds_read_b64_tr_b16 v[52:53], v9 offset:57344
  v_add_f32 v101, 1.0, v101
  v_mfma_f32_16x16x32_bf16 v[152:155], v[56:59], a[104:107], v[152:155]
  v_rcp_f32 v101, v101
  v_mfma_f32_16x16x32_bf16 v[152:155], v[60:63], a[120:123], v[152:155]
  ds_read_b64_tr_b16 v[54:55], v9 offset:57856
  v_mul_f32 v117, v101, v117
  v_mfma_f32_16x16x32_bf16 v[156:159], v[56:59], a[108:111], v[156:159]
  v_exp_f32 v102, v102
  v_mfma_f32_16x16x32_bf16 v[156:159], v[60:63], a[124:127], v[156:159]
  ds_read_b64_tr_b16 v[56:57], v9 offset:53248
  s_waitcnt lgkmcnt(5)
  v_mfma_f32_16x16x32_bf16 v[160:163], v[32:35], a[96:99], v[160:163]
k1_pg4:
  s_cbranch_execz k1_pg8
  v_add_f32 v102, 1.0, v102
  v_mul_f32 v119, v103, v119
  v_mfma_f32_16x16x32_bf16 v[160:163], v[36:39], a[112:115], v[160:163]
  ds_read_b64_tr_b16 v[58:59], v9 offset:53760
  v_mul_f32 v103, s77, v103
  v_mfma_f32_16x16x32_bf16 v[164:167], v[32:35], a[100:103], v[164:167]
  v_rcp_f32 v102, v102
  v_mfma_f32_16x16x32_bf16 v[164:167], v[36:39], a[116:119], v[164:167]
  ds_read_b64_tr_b16 v[60:61], v9 offset:61440
  v_mul_f32 v118, v102, v118
  v_mfma_f32_16x16x32_bf16 v[168:171], v[32:35], a[104:107], v[168:171]
  s_cmp_eq_u32 s70, 3
  s_cselect_b32 s71, s2, 2147418112
  v_mfma_f32_16x16x32_bf16 v[168:171], v[36:39], a[120:123], v[168:171]
  ds_read_b64_tr_b16 v[62:63], v9 offset:61952
  v_cvt_pk_bf16_f32 v68, v84, v85
  v_mfma_f32_16x16x32_bf16 v[172:175], v[32:35], a[108:111], v[172:175]
  v_exp_f32 v103, v103
  v_mfma_f32_16x16x32_bf16 v[172:175], v[36:39], a[124:127], v[172:175]
  ds_read_b64_tr_b16 v[32:33], v10 offset:49152
  v_add_f32 v103, 1.0, v103
  v_mfma_f32_16x16x32_bf16 v[176:179], v[40:43], a[96:99], v[176:179]
  v_rcp_f32 v103, v103
  v_mfma_f32_16x16x32_bf16 v[176:179], v[44:47], a[112:115], v[176:179]
  ds_read_b64_tr_b16 v[34:35], v10 offset:49664
  v_mul_f32 v119, v103, v119
  v_mfma_f32_16x16x32_bf16 v[180:183], v[40:43], a[100:103], v[180:183]
  v_cvt_pk_bf16_f32 v69, v86, v87
  v_mul_f32 v88, v72, v88
  v_mfma_f32_16x16x32_bf16 v[180:183], v[44:47], a[116:119], v[180:183]
  ds_read_b64_tr_b16 v[36:37], v10 offset:57344
  v_cvt_pk_bf16_f32 v70, v116, v117
  v_mfma_f32_16x16x32_bf16 v[184:187], v[40:43], a[104:107], v[184:187]
  buffer_store_byte v241, v240, s[60:63], s71 offen sc1
  v_mfma_f32_16x16x32_bf16 v[184:187], v[44:47], a[120:123], v[184:187]
  ds_read_b64_tr_b16 v[38:39], v10 offset:57856
  v_cvt_pk_bf16_f32 v71, v118, v119
  v_mfma_f32_16x16x32_bf16 v[188:191], v[40:43], a[108:111], v[188:191]
  ds_write_b128 v28, v[68:71] offset:1024
  v_mfma_f32_16x16x32_bf16 v[188:191], v[44:47], a[124:127], v[188:191]
  ds_read_b64_tr_b16 v[40:41], v10 offset:53248
  s_waitcnt lgkmcnt(6)
  v_mfma_f32_16x16x32_bf16 v[128:131], v[48:51], a[128:131], v[128:131]
  buffer_store_dwordx4 v[68:71], v26, s[48:51], s24 offen offset:1024 sc1
  v_mfma_f32_16x16x32_bf16 v[128:131], v[52:55], a[144:147], v[128:131]
  ds_read_b64_tr_b16 v[42:43], v10 offset:53760
  v_mul_f32 v72, s77, v72
  v_mfma_f32_16x16x32_bf16 v[132:135], v[48:51], a[132:135], v[132:135]
  v_exp_f32 v72, v72
  v_mfma_f32_16x16x32_bf16 v[132:135], v[52:55], a[148:151], v[132:135]
  ds_read_b64_tr_b16 v[44:45], v10 offset:61440
  v_add_f32 v72, 1.0, v72
  v_mfma_f32_16x16x32_bf16 v[136:139], v[48:51], a[136:139], v[136:139]
  v_rcp_f32 v72, v72
  v_mfma_f32_16x16x32_bf16 v[136:139], v[52:55], a[152:155], v[136:139]
  ds_read_b64_tr_b16 v[46:47], v10 offset:61952
  v_mul_f32 v88, v72, v88
  v_mfma_f32_16x16x32_bf16 v[140:143], v[48:51], a[140:143], v[140:143]
  s_waitcnt vmcnt(16)
  s_barrier
  v_mfma_f32_16x16x32_bf16 v[140:143], v[52:55], a[156:159], v[140:143]
  ds_read_b64_tr_b16 v[48:49], v7 offset:0
  v_mul_f32 v89, v73, v89
  v_mfma_f32_16x16x32_bf16 v[144:147], v[56:59], a[128:131], v[144:147]
  v_mul_f32 v73, s77, v73
  v_mul_f32 v90, v74, v90
  v_mfma_f32_16x16x32_bf16 v[144:147], v[60:63], a[144:147], v[144:147]
  ds_read_b64_tr_b16 v[50:51], v7 offset:512
  v_mul_f32 v74, s77, v74
  v_mfma_f32_16x16x32_bf16 v[148:151], v[56:59], a[132:135], v[148:151]
  v_exp_f32 v73, v73
  v_mfma_f32_16x16x32_bf16 v[148:151], v[60:63], a[148:151], v[148:151]
  ds_read_b64_tr_b16 v[52:53], v7 offset:8192
  v_add_f32 v73, 1.0, v73
  v_mfma_f32_16x16x32_bf16 v[152:155], v[56:59], a[136:139], v[152:155]
  v_rcp_f32 v73, v73
  v_mfma_f32_16x16x32_bf16 v[152:155], v[60:63], a[152:155], v[152:155]
  ds_read_b64_tr_b16 v[54:55], v7 offset:8704
  v_mul_f32 v89, v73, v89
  v_mfma_f32_16x16x32_bf16 v[156:159], v[56:59], a[140:143], v[156:159]
  v_exp_f32 v74, v74
  v_mfma_f32_16x16x32_bf16 v[156:159], v[60:63], a[156:159], v[156:159]
  ds_read_b64_tr_b16 v[56:57], v7 offset:4096
  s_waitcnt lgkmcnt(5)
  v_mfma_f32_16x16x32_bf16 v[160:163], v[32:35], a[128:131], v[160:163]
  v_add_f32 v74, 1.0, v74
  v_mul_f32 v91, v75, v91
  v_mfma_f32_16x16x32_bf16 v[160:163], v[36:39], a[144:147], v[160:163]
  ds_read_b64_tr_b16 v[58:59], v7 offset:4608
  v_mul_f32 v75, s77, v75
  v_mfma_f32_16x16x32_bf16 v[164:167], v[32:35], a[132:135], v[164:167]
  v_rcp_f32 v74, v74
  v_mfma_f32_16x16x32_bf16 v[164:167], v[36:39], a[148:151], v[164:167]
  ds_read_b64_tr_b16 v[60:61], v7 offset:12288
  s_add_u32 m0, s74, 49152
  v_mfma_f32_16x16x32_bf16 v[168:171], v[32:35], a[136:139], v[168:171]
  buffer_load_dwordx4 v17, s[40:43], s73 offen lds
  v_mfma_f32_16x16x32_bf16 v[168:171], v[36:39], a[152:155], v[168:171]
  ds_read_b64_tr_b16 v[62:63], v7 offset:12800
  v_mul_f32 v90, v74, v90
  v_mfma_f32_16x16x32_bf16 v[172:175], v[32:35], a[140:143], v[172:175]
  v_exp_f32 v75, v75
  v_mfma_f32_16x16x32_bf16 v[172:175], v[36:39], a[156:159], v[172:175]
  ds_read_b64_tr_b16 v[32:33], v8 offset:0
  v_add_f32 v75, 1.0, v75
  v_mfma_f32_16x16x32_bf16 v[176:179], v[40:43], a[128:131], v[176:179]
  buffer_load_dwordx4 v18, s[40:43], s73 offen offset:1024 lds
  v_mfma_f32_16x16x32_bf16 v[176:179], v[44:47], a[144:147], v[176:179]
  ds_read_b64_tr_b16 v[34:35], v8 offset:512
  v_mul_f32 v120, v104, v120
  v_mfma_f32_16x16x32_bf16 v[180:183], v[40:43], a[132:135], v[180:183]
  v_rcp_f32 v75, v75
  v_mfma_f32_16x16x32_bf16 v[180:183], v[44:47], a[148:151], v[180:183]
  ds_read_b64_tr_b16 v[36:37], v8 offset:8192
  v_mul_f32 v91, v75, v91
  v_mfma_f32_16x16x32_bf16 v[184:187], v[40:43], a[136:139], v[184:187]
  v_mul_f32 v104, s77, v104
  v_mul_f32 v121, v105, v121
  v_mfma_f32_16x16x32_bf16 v[184:187], v[44:47], a[152:155], v[184:187]
  ds_read_b64_tr_b16 v[38:39], v8 offset:8704
  v_mul_f32 v105, s77, v105
  v_mfma_f32_16x16x32_bf16 v[188:191], v[40:43], a[140:143], v[188:191]
  buffer_load_dwordx4 v19, s[40:43], s73 offen offset:2048 lds
  v_mfma_f32_16x16x32_bf16 v[188:191], v[44:47], a[156:159], v[188:191]
  ds_read_b64_tr_b16 v[40:41], v8 offset:4096
  s_waitcnt lgkmcnt(5)
  v_mfma_f32_16x16x32_bf16 v[128:131], v[48:51], a[160:163], v[128:131]
  v_exp_f32 v104, v104
  v_mfma_f32_16x16x32_bf16 v[128:131], v[52:55], a[176:179], v[128:131]
  ds_read_b64_tr_b16 v[42:43], v8 offset:4608
  v_add_f32 v104, 1.0, v104
  v_mfma_f32_16x16x32_bf16 v[132:135], v[48:51], a[164:167], v[132:135]
  buffer_load_dwordx4 v20, s[40:43], s73 offen offset:3072 lds
  v_mfma_f32_16x16x32_bf16 v[132:135], v[52:55], a[180:183], v[132:135]
  ds_read_b64_tr_b16 v[44:45], v8 offset:12288
  v_mul_f32 v122, v106, v122
  v_mfma_f32_16x16x32_bf16 v[136:139], v[48:51], a[168:171], v[136:139]
  v_rcp_f32 v104, v104
  v_mfma_f32_16x16x32_bf16 v[136:139], v[52:55], a[184:187], v[136:139]
  ds_read_b64_tr_b16 v[46:47], v8 offset:12800
  v_mul_f32 v120, v104, v120
  v_mfma_f32_16x16x32_bf16 v[140:143], v[48:51], a[172:175], v[140:143]
  s_waitcnt vmcnt(15)
  s_barrier
  v_mfma_f32_16x16x32_bf16 v[140:143], v[52:55], a[188:191], v[140:143]
  ds_read_b64_tr_b16 v[48:49], v7 offset:16384
  s_add_u32 s73, s73, s97
  v_mfma_f32_16x16x32_bf16 v[144:147], v[56:59], a[160:163], v[144:147]
  v_exp_f32 v105, v105
  v_mfma_f32_16x16x32_bf16 v[144:147], v[60:63], a[176:179], v[144:147]
  ds_read_b64_tr_b16 v[50:51], v7 offset:16896
  s_add_u32 m0, s74, 147456
  v_mfma_f32_16x16x32_bf16 v[148:151], v[56:59], a[164:167], v[148:151]
  buffer_load_dwordx4 v17, s[40:43], s73 offen lds
  v_mfma_f32_16x16x32_bf16 v[148:151], v[60:63], a[180:183], v[148:151]
  ds_read_b64_tr_b16 v[52:53], v7 offset:24576
  v_add_f32 v105, 1.0, v105
  v_mfma_f32_16x16x32_bf16 v[152:155], v[56:59], a[168:171], v[152:155]
  buffer_load_dwordx4 v18, s[40:43], s73 offen offset:1024 lds
  v_mfma_f32_16x16x32_bf16 v[152:155], v[60:63], a[184:187], v[152:155]
  ds_read_b64_tr_b16 v[54:55], v7 offset:25088
  v_mul_f32 v106, s77, v106
  v_mfma_f32_16x16x32_bf16 v[156:159], v[56:59], a[172:175], v[156:159]
  v_rcp_f32 v105, v105
  v_mfma_f32_16x16x32_bf16 v[156:159], v[60:63], a[188:191], v[156:159]
  ds_read_b64_tr_b16 v[56:57], v7 offset:20480
  s_waitcnt lgkmcnt(5)
  v_mfma_f32_16x16x32_bf16 v[160:163], v[32:35], a[160:163], v[160:163]
  buffer_load_dwordx4 v19, s[40:43], s73 offen offset:2048 lds
  v_mfma_f32_16x16x32_bf16 v[160:163], v[36:39], a[176:179], v[160:163]
  ds_read_b64_tr_b16 v[58:59], v7 offset:20992
  v_mul_f32 v121, v105, v121
  v_mfma_f32_16x16x32_bf16 v[164:167], v[32:35], a[164:167], v[164:167]
  v_exp_f32 v106, v106
  v_mfma_f32_16x16x32_bf16 v[164:167], v[36:39], a[180:183], v[164:167]
  ds_read_b64_tr_b16 v[60:61], v7 offset:28672
  v_add_f32 v106, 1.0, v106
  v_mfma_f32_16x16x32_bf16 v[168:171], v[32:35], a[168:171], v[168:171]
  v_rcp_f32 v106, v106
  v_mfma_f32_16x16x32_bf16 v[168:171], v[36:39], a[184:187], v[168:171]
  ds_read_b64_tr_b16 v[62:63], v7 offset:29184
  v_mul_f32 v122, v106, v122
  v_mfma_f32_16x16x32_bf16 v[172:175], v[32:35], a[172:175], v[172:175]
  buffer_load_dwordx4 v20, s[40:43], s73 offen offset:3072 lds
  v_mfma_f32_16x16x32_bf16 v[172:175], v[36:39], a[188:191], v[172:175]
  ds_read_b64_tr_b16 v[32:33], v8 offset:16384
  v_mul_f32 v123, v107, v123
  v_mfma_f32_16x16x32_bf16 v[176:179], v[40:43], a[160:163], v[176:179]
  v_mul_f32 v107, s77, v107
  v_cvt_pk_bf16_f32 v72, v88, v89
  v_mfma_f32_16x16x32_bf16 v[176:179], v[44:47], a[176:179], v[176:179]
  ds_read_b64_tr_b16 v[34:35], v8 offset:16896
  v_cvt_pk_bf16_f32 v73, v90, v91
  v_mfma_f32_16x16x32_bf16 v[180:183], v[40:43], a[164:167], v[180:183]
  v_exp_f32 v107, v107
  v_mfma_f32_16x16x32_bf16 v[180:183], v[44:47], a[180:183], v[180:183]
  ds_read_b64_tr_b16 v[36:37], v8 offset:24576
  s_add_u32 s73, s73, 589824
  v_mfma_f32_16x16x32_bf16 v[184:187], v[40:43], a[168:171], v[184:187]
  s_add_u32 m0, s74, 98304
  v_add_f32 v107, 1.0, v107
  v_mfma_f32_16x16x32_bf16 v[184:187], v[44:47], a[184:187], v[184:187]
  ds_read_b64_tr_b16 v[38:39], v8 offset:25088
  v_cvt_pk_bf16_f32 v74, v120, v121
  v_mfma_f32_16x16x32_bf16 v[188:191], v[40:43], a[172:175], v[188:191]
  buffer_load_dwordx4 v17, s[40:43], s73 offen lds
  v_mfma_f32_16x16x32_bf16 v[188:191], v[44:47], a[188:191], v[188:191]
  ds_read_b64_tr_b16 v[40:41], v8 offset:20480
  s_waitcnt lgkmcnt(5)
  v_mfma_f32_16x16x32_bf16 v[128:131], v[48:51], a[192:195], v[128:131]
  buffer_load_dwordx4 v18, s[40:43], s73 offen offset:1024 lds
  v_mfma_f32_16x16x32_bf16 v[128:131], v[52:55], a[208:211], v[128:131]
  ds_read_b64_tr_b16 v[42:43], v8 offset:20992
  v_mul_f32 v92, v76, v92
  v_mfma_f32_16x16x32_bf16 v[132:135], v[48:51], a[196:199], v[132:135]
  v_rcp_f32 v107, v107
  v_mfma_f32_16x16x32_bf16 v[132:135], v[52:55], a[212:215], v[132:135]
  ds_read_b64_tr_b16 v[44:45], v8 offset:28672
  v_mul_f32 v123, v107, v123
  v_mfma_f32_16x16x32_bf16 v[136:139], v[48:51], a[200:203], v[136:139]
  buffer_load_dwordx4 v19, s[40:43], s73 offen offset:2048 lds
  v_mfma_f32_16x16x32_bf16 v[136:139], v[52:55], a[216:219], v[136:139]
  ds_read_b64_tr_b16 v[46:47], v8 offset:29184
  v_cvt_pk_bf16_f32 v75, v122, v123
  v_mfma_f32_16x16x32_bf16 v[140:143], v[48:51], a[204:207], v[140:143]
  s_waitcnt vmcnt(17)
  s_barrier
  v_mfma_f32_16x16x32_bf16 v[140:143], v[52:55], a[220:223], v[140:143]
  ds_read_b64_tr_b16 v[48:49], v11 offset:0
  v_mul_f32 v76, s77, v76
  v_mfma_f32_16x16x32_bf16 v[144:147], v[56:59], a[192:195], v[144:147]
  buffer_load_dwordx4 v20, s[40:43], s73 offen offset:3072 lds
  v_mfma_f32_16x16x32_bf16 v[144:147], v[60:63], a[208:211], v[144:147]
  ds_read_b64_tr_b16 v[50:51], v11 offset:512
  v_mul_f32 v93, v77, v93
  v_mfma_f32_16x16x32_bf16 v[148:151], v[56:59], a[196:199], v[148:151]
  ds_write_b128 v28, v[72:75] offset:2048
  v_mfma_f32_16x16x32_bf16 v[148:151], v[60:63], a[212:215], v[148:151]
  ds_read_b64_tr_b16 v[52:53], v11 offset:8192
  v_mul_f32 v77, s77, v77
  v_mfma_f32_16x16x32_bf16 v[152:155], v[56:59], a[200:203], v[152:155]
  buffer_store_dwordx4 v[72:75], v26, s[48:51], s24 offen offset:2048 sc1
  v_mfma_f32_16x16x32_bf16 v[152:155], v[60:63], a[216:219], v[152:155]
  ds_read_b64_tr_b16 v[54:55], v11 offset:8704
  s_add_u32 s73, s73, 589824
  v_mfma_f32_16x16x32_bf16 v[156:159], v[56:59], a[204:207], v[156:159]
  v_exp_f32 v76, v76
  v_mfma_f32_16x16x32_bf16 v[156:159], v[60:63], a[220:223], v[156:159]
  ds_read_b64_tr_b16 v[56:57], v11 offset:4096
  s_waitcnt lgkmcnt(6)
  v_mfma_f32_16x16x32_bf16 v[160:163], v[32:35], a[192:195], v[160:163]
  v_exp_f32 v77, v77
  v_mfma_f32_16x16x32_bf16 v[160:163], v[36:39], a[208:211], v[160:163]
  ds_read_b64_tr_b16 v[58:59], v11 offset:4608
  s_add_u32 m0, s74, 65536
  v_mfma_f32_16x16x32_bf16 v[164:167], v[32:35], a[196:199], v[164:167]
  buffer_load_dwordx4 v17, s[40:43], s73 offen lds
  v_mfma_f32_16x16x32_bf16 v[164:167], v[36:39], a[212:215], v[164:167]
  v_add_f32 v76, 1.0, v76
  ds_read_b64_tr_b16 v[60:61], v11 offset:12288
  v_mfma_f32_16x16x32_bf16 v[168:171], v[32:35], a[200:203], v[168:171]
  buffer_load_dwordx4 v18, s[40:43], s73 offen offset:1024 lds
  v_mfma_f32_16x16x32_bf16 v[168:171], v[36:39], a[216:219], v[168:171]
  v_rcp_f32 v76, v76
  v_mfma_f32_16x16x32_bf16 v[172:175], v[32:35], a[204:207], v[172:175]
  ds_read_b64_tr_b16 v[62:63], v11 offset:12800
  v_mul_f32 v92, v76, v92
  v_mfma_f32_16x16x32_bf16 v[172:175], v[36:39], a[220:223], v[172:175]
  ds_read_b64_tr_b16 v[32:33], v12 offset:0
  v_add_f32 v77, 1.0, v77
  v_mfma_f32_16x16x32_bf16 v[176:179], v[40:43], a[192:195], v[176:179]
  buffer_load_dwordx4 v19, s[40:43], s73 offen offset:2048 lds
  v_mfma_f32_16x16x32_bf16 v[176:179], v[44:47], a[208:211], v[176:179]
  ds_read_b64_tr_b16 v[34:35], v12 offset:512
  v_mul_f32 v94, v78, v94
  v_mfma_f32_16x16x32_bf16 v[180:183], v[40:43], a[196:199], v[180:183]
  v_rcp_f32 v77, v77
  v_mfma_f32_16x16x32_bf16 v[180:183], v[44:47], a[212:215], v[180:183]
  ds_read_b64_tr_b16 v[36:37], v12 offset:8192
  v_mul_f32 v93, v77, v93
  v_mfma_f32_16x16x32_bf16 v[184:187], v[40:43], a[200:203], v[184:187]
  buffer_load_dwordx4 v20, s[40:43], s73 offen offset:3072 lds
  v_mfma_f32_16x16x32_bf16 v[184:187], v[44:47], a[216:219], v[184:187]
  ds_read_b64_tr_b16 v[38:39], v12 offset:8704
  v_mul_f32 v78, s77, v78
  v_mfma_f32_16x16x32_bf16 v[188:191], v[40:43], a[204:207], v[188:191]
  v_exp_f32 v78, v78
  v_mfma_f32_16x16x32_bf16 v[188:191], v[44:47], a[220:223], v[188:191]
  ds_read_b64_tr_b16 v[40:41], v12 offset:4096
  s_waitcnt lgkmcnt(5)
  v_mfma_f32_16x16x32_bf16 v[128:131], v[48:51], a[224:227], v[128:131]
  s_add_u32 s73, s73, 589824
  s_add_u32 m0, s74, 114688
  v_mfma_f32_16x16x32_bf16 v[128:131], v[52:55], a[240:243], v[128:131]
  ds_read_b64_tr_b16 v[42:43], v12 offset:4608
  v_add_f32 v78, 1.0, v78
  v_mfma_f32_16x16x32_bf16 v[132:135], v[48:51], a[228:231], v[132:135]
  buffer_load_dwordx4 v17, s[40:43], s73 offen lds
  v_mfma_f32_16x16x32_bf16 v[132:135], v[52:55], a[244:247], v[132:135]
  ds_read_b64_tr_b16 v[44:45], v12 offset:12288
  v_mul_f32 v95, v79, v95
  v_mfma_f32_16x16x32_bf16 v[136:139], v[48:51], a[232:235], v[136:139]
  buffer_load_dwordx4 v18, s[40:43], s73 offen offset:1024 lds
  v_mfma_f32_16x16x32_bf16 v[136:139], v[52:55], a[248:251], v[136:139]
  v_rcp_f32 v78, v78
  v_mfma_f32_16x16x32_bf16 v[140:143], v[48:51], a[236:239], v[140:143]
  s_waitcnt vmcnt(15)
  s_barrier
  v_mfma_f32_16x16x32_bf16 v[140:143], v[52:55], a[252:255], v[140:143]
  v_mul_f32 v94, v78, v94
  v_mul_f32 v79, s77, v79
  v_mfma_f32_16x16x32_bf16 v[144:147], v[56:59], a[224:227], v[144:147]
  ds_read_b64_tr_b16 v[46:47], v12 offset:12800
  v_mul_f32 v124, v108, v124
  v_mfma_f32_16x16x32_bf16 v[144:147], v[60:63], a[240:243], v[144:147]
  v_exp_f32 v79, v79
  v_mfma_f32_16x16x32_bf16 v[148:151], v[56:59], a[228:231], v[148:151]
  ds_read_b64_tr_b16 v[48:49], v7 offset:49152
  v_add_f32 v79, 1.0, v79
  v_mfma_f32_16x16x32_bf16 v[148:151], v[60:63], a[244:247], v[148:151]
  ds_read_b64_tr_b16 v[50:51], v7 offset:49664
  v_mul_f32 v108, s77, v108
  v_mfma_f32_16x16x32_bf16 v[152:155], v[56:59], a[232:235], v[152:155]
  ds_read_b64_tr_b16 v[52:53], v7 offset:57344
  v_mul_f32 v125, v109, v125
  v_mfma_f32_16x16x32_bf16 v[152:155], v[60:63], a[248:251], v[152:155]
  v_rcp_f32 v79, v79
  v_mfma_f32_16x16x32_bf16 v[156:159], v[56:59], a[236:239], v[156:159]
  ds_read_b64_tr_b16 v[54:55], v7 offset:57856
  v_mul_f32 v95, v79, v95
  v_mfma_f32_16x16x32_bf16 v[156:159], v[60:63], a[252:255], v[156:159]
  buffer_load_dwordx4 v19, s[40:43], s73 offen offset:2048 lds
  s_waitcnt lgkmcnt(4)
  v_mfma_f32_16x16x32_bf16 v[160:163], v[32:35], a[224:227], v[160:163]
  ds_read_b64_tr_b16 v[56:57], v7 offset:53248
  v_mul_f32 v109, s77, v109
  v_mfma_f32_16x16x32_bf16 v[160:163], v[36:39], a[240:243], v[160:163]
  v_exp_f32 v108, v108
  v_mfma_f32_16x16x32_bf16 v[164:167], v[32:35], a[228:231], v[164:167]
  ds_read_b64_tr_b16 v[58:59], v7 offset:53760
  v_add_f32 v108, 1.0, v108
  v_mfma_f32_16x16x32_bf16 v[164:167], v[36:39], a[244:247], v[164:167]
  ds_read_b64_tr_b16 v[60:61], v7 offset:61440
  v_mul_f32 v126, v110, v126
  v_mfma_f32_16x16x32_bf16 v[168:171], v[32:35], a[232:235], v[168:171]
  buffer_load_dwordx4 v20, s[40:43], s73 offen offset:3072 lds
  v_mfma_f32_16x16x32_bf16 v[168:171], v[36:39], a[248:251], v[168:171]
  v_rcp_f32 v108, v108
  v_mfma_f32_16x16x32_bf16 v[172:175], v[32:35], a[236:239], v[172:175]
  ds_read_b64_tr_b16 v[62:63], v7 offset:61952
  s_add_u32 s73, s73, 589824
  v_mfma_f32_16x16x32_bf16 v[172:175], v[36:39], a[252:255], v[172:175]
  v_mul_f32 v124, v108, v124
  ds_read_b64_tr_b16 v[32:33], v8 offset:49152
  v_mfma_f32_16x16x32_bf16 v[176:179], v[40:43], a[224:227], v[176:179]
  s_add_u32 m0, s74, 0
  s_nop 0
  buffer_load_dwordx4 v17, s[40:43], s73 offen lds
  v_mfma_f32_16x16x32_bf16 v[176:179], v[44:47], a[240:243], v[176:179]
  v_exp_f32 v109, v109
  v_mfma_f32_16x16x32_bf16 v[180:183], v[40:43], a[228:231], v[180:183]
  ds_read_b64_tr_b16 v[34:35], v8 offset:49664
  v_add_f32 v109, 1.0, v109
  v_mfma_f32_16x16x32_bf16 v[180:183], v[44:47], a[244:247], v[180:183]
  ds_read_b64_tr_b16 v[36:37], v8 offset:57344
  v_mul_f32 v110, s77, v110
  v_mfma_f32_16x16x32_bf16 v[184:187], v[40:43], a[232:235], v[184:187]
  buffer_load_dwordx4 v18, s[40:43], s73 offen offset:1024 lds
  v_mfma_f32_16x16x32_bf16 v[184:187], v[44:47], a[248:251], v[184:187]
  v_rcp_f32 v109, v109
  v_mfma_f32_16x16x32_bf16 v[188:191], v[40:43], a[236:239], v[188:191]
  ds_read_b64_tr_b16 v[38:39], v8 offset:57856
  v_mul_f32 v125, v109, v125
  v_mfma_f32_16x16x32_bf16 v[188:191], v[44:47], a[252:255], v[188:191]
  ds_read_b64_tr_b16 v[40:41], v8 offset:53248
  s_waitcnt lgkmcnt(5)
  v_mfma_f32_16x16x32_bf16 v[128:131], v[48:51], v[192:195], v[128:131]
  buffer_load_dwordx4 v19, s[40:43], s73 offen offset:2048 lds
  v_mfma_f32_16x16x32_bf16 v[128:131], v[52:55], v[208:211], v[128:131]
  v_exp_f32 v110, v110
  v_mfma_f32_16x16x32_bf16 v[132:135], v[48:51], v[196:199], v[132:135]
  ds_read_b64_tr_b16 v[42:43], v8 offset:53760
  v_add_f32 v110, 1.0, v110
  v_mfma_f32_16x16x32_bf16 v[132:135], v[52:55], v[212:215], v[132:135]
  ds_read_b64_tr_b16 v[44:45], v8 offset:61440
  v_mul_f32 v127, v111, v127
  v_mfma_f32_16x16x32_bf16 v[136:139], v[48:51], v[200:203], v[136:139]
  buffer_load_dwordx4 v20, s[40:43], s73 offen offset:3072 lds
  v_mfma_f32_16x16x32_bf16 v[136:139], v[52:55], v[216:219], v[136:139]
  v_rcp_f32 v110, v110
  v_mfma_f32_16x16x32_bf16 v[140:143], v[48:51], v[204:207], v[140:143]
  s_waitcnt vmcnt(17)
  s_barrier
  v_mfma_f32_16x16x32_bf16 v[140:143], v[52:55], v[220:223], v[140:143]
  v_mul_f32 v126, v110, v126
  v_mul_f32 v111, s77, v111
  v_mfma_f32_16x16x32_bf16 v[144:147], v[56:59], v[192:195], v[144:147]
  ds_read_b64_tr_b16 v[46:47], v8 offset:61952
  s_add_u32 s73, s73, 589824
  v_mfma_f32_16x16x32_bf16 v[144:147], v[60:63], v[208:211], v[144:147]
  v_exp_f32 v111, v111
  v_mfma_f32_16x16x32_bf16 v[148:151], v[56:59], v[196:199], v[148:151]
  ds_read_b64_tr_b16 v[48:49], v11 offset:16384
  s_add_u32 m0, s74, 16384
  v_mfma_f32_16x16x32_bf16 v[148:151], v[60:63], v[212:215], v[148:151]
  buffer_load_dwordx4 v17, s[40:43], s73 offen lds
  v_add_f32 v111, 1.0, v111
  v_mfma_f32_16x16x32_bf16 v[152:155], v[56:59], v[200:203], v[152:155]
  ds_read_b64_tr_b16 v[50:51], v11 offset:16896
  v_cvt_pk_bf16_f32 v76, v92, v93
  v_mfma_f32_16x16x32_bf16 v[152:155], v[60:63], v[216:219], v[152:155]
  v_rcp_f32 v111, v111
  v_mfma_f32_16x16x32_bf16 v[156:159], v[56:59], v[204:207], v[156:159]
  ds_read_b64_tr_b16 v[52:53], v11 offset:24576
  v_mul_f32 v127, v111, v127
  v_mfma_f32_16x16x32_bf16 v[156:159], v[60:63], v[220:223], v[156:159]
  ds_read_b64_tr_b16 v[54:55], v11 offset:25088
  s_waitcnt lgkmcnt(4)
  v_mfma_f32_16x16x32_bf16 v[160:163], v[32:35], v[192:195], v[160:163]
  buffer_load_dwordx4 v18, s[40:43], s73 offen offset:1024 lds
  v_mfma_f32_16x16x32_bf16 v[160:163], v[36:39], v[208:211], v[160:163]
  ds_read_b64_tr_b16 v[56:57], v11 offset:20480
  v_cvt_pk_bf16_f32 v77, v94, v95
  v_mfma_f32_16x16x32_bf16 v[164:167], v[32:35], v[196:199], v[164:167]
  ds_read_b64_tr_b16 v[58:59], v11 offset:20992
  v_cvt_pk_bf16_f32 v78, v124, v125
  v_mfma_f32_16x16x32_bf16 v[164:167], v[36:39], v[212:215], v[164:167]
  ds_read_b64_tr_b16 v[60:61], v11 offset:28672
  v_cvt_pk_bf16_f32 v79, v126, v127
  v_mfma_f32_16x16x32_bf16 v[168:171], v[32:35], v[200:203], v[168:171]
  buffer_load_dwordx4 v19, s[40:43], s73 offen offset:2048 lds
  v_mfma_f32_16x16x32_bf16 v[168:171], v[36:39], v[216:219], v[168:171]
  ds_read_b64_tr_b16 v[62:63], v11 offset:29184
  v_mfma_f32_16x16x32_bf16 v[172:175], v[32:35], v[204:207], v[172:175]
  buffer_load_dwordx4 v20, s[40:43], s73 offen offset:3072 lds
  v_mfma_f32_16x16x32_bf16 v[172:175], v[36:39], v[220:223], v[172:175]
  ds_write_b128 v28, v[76:79] offset:3072
  v_mfma_f32_16x16x32_bf16 v[176:179], v[40:43], v[192:195], v[176:179]
  ds_read_b64_tr_b16 v[32:33], v12 offset:16384
  v_mfma_f32_16x16x32_bf16 v[176:179], v[44:47], v[208:211], v[176:179]
  buffer_store_dwordx4 v[76:79], v26, s[48:51], s24 offen offset:3072 sc1
  v_mfma_f32_16x16x32_bf16 v[180:183], v[40:43], v[196:199], v[180:183]
  ds_read_b64_tr_b16 v[34:35], v12 offset:16896
  s_add_u32 s73, s73, 589824
  v_mfma_f32_16x16x32_bf16 v[180:183], v[44:47], v[212:215], v[180:183]
  ds_read_b64_tr_b16 v[36:37], v12 offset:24576
  s_add_u32 m0, s74, 131072
  v_mfma_f32_16x16x32_bf16 v[184:187], v[40:43], v[200:203], v[184:187]
  buffer_load_dwordx4 v17, s[40:43], s73 offen lds
  v_mfma_f32_16x16x32_bf16 v[184:187], v[44:47], v[216:219], v[184:187]
  ds_read_b64_tr_b16 v[38:39], v12 offset:25088
  v_mfma_f32_16x16x32_bf16 v[188:191], v[40:43], v[204:207], v[188:191]
  buffer_load_dwordx4 v18, s[40:43], s73 offen offset:1024 lds
  v_mfma_f32_16x16x32_bf16 v[188:191], v[44:47], v[220:223], v[188:191]
  ds_read_b64_tr_b16 v[40:41], v12 offset:20480
  s_waitcnt lgkmcnt(6)
  v_mfma_f32_16x16x32_bf16 v[64:67], v[48:51], a[0:3], 0
  v_mfma_f32_16x16x32_bf16 v[64:67], v[52:55], a[16:19], v[64:67]
  ds_read_b64_tr_b16 v[42:43], v12 offset:20992
  v_mfma_f32_16x16x32_bf16 v[68:71], v[48:51], a[4:7], 0
  buffer_load_dwordx4 v19, s[40:43], s73 offen offset:2048 lds
  v_mfma_f32_16x16x32_bf16 v[68:71], v[52:55], a[20:23], v[68:71]
  ds_read_b64_tr_b16 v[44:45], v12 offset:28672
  v_mul_f32 v144, v128, v144
  v_mfma_f32_16x16x32_bf16 v[72:75], v[48:51], a[8:11], 0
  v_mul_f32 v128, s77, v128
  v_mul_f32 v145, v129, v145
  v_mfma_f32_16x16x32_bf16 v[72:75], v[52:55], a[24:27], v[72:75]
  ds_read_b64_tr_b16 v[46:47], v12 offset:29184
  v_mul_f32 v129, s77, v129
  v_mfma_f32_16x16x32_bf16 v[76:79], v[48:51], a[12:15], 0
  s_waitcnt vmcnt(21)
  s_barrier
  v_mfma_f32_16x16x32_bf16 v[76:79], v[52:55], a[28:31], v[76:79]
  ds_read_b64_tr_b16 v[48:49], v9 offset:32768
  v_mul_f32 v146, v130, v146
  v_mfma_f32_16x16x32_bf16 v[80:83], v[56:59], a[0:3], 0
  buffer_load_dwordx4 v20, s[40:43], s73 offen offset:3072 lds
  v_mfma_f32_16x16x32_bf16 v[80:83], v[60:63], a[16:19], v[80:83]
  ds_read_b64_tr_b16 v[50:51], v9 offset:33280
  v_mul_f32 v130, s77, v130
  v_mfma_f32_16x16x32_bf16 v[84:87], v[56:59], a[4:7], 0
  v_exp_f32 v128, v128
  v_mfma_f32_16x16x32_bf16 v[84:87], v[60:63], a[20:23], v[84:87]
  ds_read_b64_tr_b16 v[52:53], v9 offset:40960
  v_add_f32 v128, 1.0, v128
  v_mfma_f32_16x16x32_bf16 v[88:91], v[56:59], a[8:11], 0
  v_rcp_f32 v128, v128
  v_mfma_f32_16x16x32_bf16 v[88:91], v[60:63], a[24:27], v[88:91]
  ds_read_b64_tr_b16 v[54:55], v9 offset:41472
  s_add_u32 s73, s73, 589824
  v_mfma_f32_16x16x32_bf16 v[92:95], v[56:59], a[12:15], 0
  v_exp_f32 v129, v129
  v_mfma_f32_16x16x32_bf16 v[92:95], v[60:63], a[28:31], v[92:95]
  ds_read_b64_tr_b16 v[56:57], v9 offset:36864
  s_waitcnt lgkmcnt(5)
  v_mfma_f32_16x16x32_bf16 v[96:99], v[32:35], a[0:3], 0
  v_exp_f32 v130, v130
  v_mfma_f32_16x16x32_bf16 v[96:99], v[36:39], a[16:19], v[96:99]
  ds_read_b64_tr_b16 v[58:59], v9 offset:37376
  v_mul_f32 v144, v128, v144
  v_mfma_f32_16x16x32_bf16 v[100:103], v[32:35], a[4:7], 0
  v_add_f32 v129, 1.0, v129
  v_add_f32 v130, 1.0, v130
  v_mfma_f32_16x16x32_bf16 v[100:103], v[36:39], a[20:23], v[100:103]
  ds_read_b64_tr_b16 v[60:61], v9 offset:45056
  v_mul_f32 v147, v131, v147
  v_mfma_f32_16x16x32_bf16 v[104:107], v[32:35], a[8:11], 0
  v_rcp_f32 v129, v129
  v_mfma_f32_16x16x32_bf16 v[104:107], v[36:39], a[24:27], v[104:107]
  ds_read_b64_tr_b16 v[62:63], v9 offset:45568
  v_mul_f32 v145, v129, v145
  v_mfma_f32_16x16x32_bf16 v[108:111], v[32:35], a[12:15], 0
  v_rcp_f32 v130, v130
  v_mfma_f32_16x16x32_bf16 v[108:111], v[36:39], a[28:31], v[108:111]
  ds_read_b64_tr_b16 v[32:33], v10 offset:32768
  v_mul_f32 v146, v130, v146
  v_mfma_f32_16x16x32_bf16 v[112:115], v[40:43], a[0:3], 0
  v_mul_f32 v131, s77, v131
  v_mul_f32 v176, v160, v176
  v_mfma_f32_16x16x32_bf16 v[112:115], v[44:47], a[16:19], v[112:115]
  ds_read_b64_tr_b16 v[34:35], v10 offset:33280
  v_mul_f32 v160, s77, v160
  v_mfma_f32_16x16x32_bf16 v[116:119], v[40:43], a[4:7], 0
  v_exp_f32 v131, v131
  v_mfma_f32_16x16x32_bf16 v[116:119], v[44:47], a[20:23], v[116:119]
  ds_read_b64_tr_b16 v[36:37], v10 offset:40960
  v_add_f32 v131, 1.0, v131
  v_mfma_f32_16x16x32_bf16 v[120:123], v[40:43], a[8:11], 0
  v_rcp_f32 v131, v131
  v_mfma_f32_16x16x32_bf16 v[120:123], v[44:47], a[24:27], v[120:123]
  ds_read_b64_tr_b16 v[38:39], v10 offset:41472
  v_mov_b32 v243, 2
  v_mfma_f32_16x16x32_bf16 v[124:127], v[40:43], a[12:15], 0
  v_exp_f32 v160, v160
  v_mfma_f32_16x16x32_bf16 v[124:127], v[44:47], a[28:31], v[124:127]
  ds_read_b64_tr_b16 v[40:41], v10 offset:36864
  s_waitcnt lgkmcnt(5)
  v_mfma_f32_16x16x32_bf16 v[64:67], v[48:51], a[32:35], v[64:67]
  v_mul_f32 v147, v131, v147
  v_add_f32 v160, 1.0, v160
  v_mfma_f32_16x16x32_bf16 v[64:67], v[52:55], a[48:51], v[64:67]
  ds_read_b64_tr_b16 v[42:43], v10 offset:37376
  v_mul_f32 v177, v161, v177
  v_mfma_f32_16x16x32_bf16 v[68:71], v[48:51], a[36:39], v[68:71]
  v_rcp_f32 v160, v160
  v_mfma_f32_16x16x32_bf16 v[68:71], v[52:55], a[52:55], v[68:71]
  ds_read_b64_tr_b16 v[44:45], v10 offset:45056
  v_mul_f32 v176, v160, v176
  v_mfma_f32_16x16x32_bf16 v[72:75], v[48:51], a[40:43], v[72:75]
  v_mul_f32 v161, s77, v161
  v_mul_f32 v178, v162, v178
  v_mfma_f32_16x16x32_bf16 v[72:75], v[52:55], a[56:59], v[72:75]
  ds_read_b64_tr_b16 v[46:47], v10 offset:45568
  v_mul_f32 v162, s77, v162
  v_mfma_f32_16x16x32_bf16 v[76:79], v[48:51], a[44:47], v[76:79]
  s_waitcnt vmcnt(4)
  s_barrier
  v_mfma_f32_16x16x32_bf16 v[76:79], v[52:55], a[60:63], v[76:79]
  ds_read_b64_tr_b16 v[48:49], v9 offset:0
  s_add_u32 m0, s74, 147456
  v_mfma_f32_16x16x32_bf16 v[80:83], v[56:59], a[32:35], v[80:83]
  buffer_load_dwordx4 v17, s[40:43], s73 offen lds
  v_mfma_f32_16x16x32_bf16 v[80:83], v[60:63], a[48:51], v[80:83]
  ds_read_b64_tr_b16 v[50:51], v9 offset:512
  v_mul_f32 v179, v163, v179
  v_mfma_f32_16x16x32_bf16 v[84:87], v[56:59], a[36:39], v[84:87]
  buffer_store_dword v243, off, s[48:51], s26 sc1
  v_mfma_f32_16x16x32_bf16 v[84:87], v[60:63], a[52:55], v[84:87]
  ds_read_b64_tr_b16 v[52:53], v9 offset:8192
  v_mul_f32 v163, s77, v163
  v_mfma_f32_16x16x32_bf16 v[88:91], v[56:59], a[40:43], v[88:91]
  buffer_load_dwordx4 v18, s[40:43], s73 offen offset:1024 lds
  v_mfma_f32_16x16x32_bf16 v[88:91], v[60:63], a[56:59], v[88:91]
  ds_read_b64_tr_b16 v[54:55], v9 offset:8704
  v_cvt_pk_bf16_f32 v128, v144, v145
  v_mfma_f32_16x16x32_bf16 v[92:95], v[56:59], a[44:47], v[92:95]
  v_exp_f32 v161, v161
  v_mfma_f32_16x16x32_bf16 v[92:95], v[60:63], a[60:63], v[92:95]
  ds_read_b64_tr_b16 v[56:57], v9 offset:4096
  s_waitcnt lgkmcnt(5)
  v_mfma_f32_16x16x32_bf16 v[96:99], v[32:35], a[32:35], v[96:99]
  buffer_load_dwordx4 v19, s[40:43], s73 offen offset:2048 lds
  v_mfma_f32_16x16x32_bf16 v[96:99], v[36:39], a[48:51], v[96:99]
  ds_read_b64_tr_b16 v[58:59], v9 offset:4608
  v_add_f32 v161, 1.0, v161
  v_mfma_f32_16x16x32_bf16 v[100:103], v[32:35], a[36:39], v[100:103]
  v_rcp_f32 v161, v161
  v_mfma_f32_16x16x32_bf16 v[100:103], v[36:39], a[52:55], v[100:103]
  ds_read_b64_tr_b16 v[60:61], v9 offset:12288
  v_mul_f32 v177, v161, v177
  v_mfma_f32_16x16x32_bf16 v[104:107], v[32:35], a[40:43], v[104:107]
  v_exp_f32 v162, v162
  v_mfma_f32_16x16x32_bf16 v[104:107], v[36:39], a[56:59], v[104:107]
  ds_read_b64_tr_b16 v[62:63], v9 offset:12800
  v_add_f32 v162, 1.0, v162
  v_mfma_f32_16x16x32_bf16 v[108:111], v[32:35], a[44:47], v[108:111]
  buffer_load_dwordx4 v20, s[40:43], s73 offen offset:3072 lds
  v_mfma_f32_16x16x32_bf16 v[108:111], v[36:39], a[60:63], v[108:111]
  ds_read_b64_tr_b16 v[32:33], v10 offset:0
  v_cvt_pk_bf16_f32 v129, v146, v147
k1_pg5:
  s_cbranch_execz k1_pg9
  v_mfma_f32_16x16x32_bf16 v[112:115], v[40:43], a[32:35], v[112:115]
  v_rcp_f32 v162, v162
  v_mfma_f32_16x16x32_bf16 v[112:115], v[44:47], a[48:51], v[112:115]
  ds_read_b64_tr_b16 v[34:35], v10 offset:512
  v_mul_f32 v178, v162, v178
  v_mfma_f32_16x16x32_bf16 v[116:119], v[40:43], a[36:39], v[116:119]
  v_exp_f32 v163, v163
  v_mfma_f32_16x16x32_bf16 v[116:119], v[44:47], a[52:55], v[116:119]
  ds_read_b64_tr_b16 v[36:37], v10 offset:8192
  s_add_u32 s73, s73, 589824
  v_mfma_f32_16x16x32_bf16 v[120:123], v[40:43], a[40:43], v[120:123]
  v_add_f32 v163, 1.0, v163
  v_cvt_pk_bf16_f32 v130, v176, v177
  v_mfma_f32_16x16x32_bf16 v[120:123], v[44:47], a[56:59], v[120:123]
  ds_read_b64_tr_b16 v[38:39], v10 offset:8704
  v_mul_f32 v148, v132, v148
  v_mfma_f32_16x16x32_bf16 v[124:127], v[40:43], a[44:47], v[124:127]
  v_rcp_f32 v163, v163
  v_mfma_f32_16x16x32_bf16 v[124:127], v[44:47], a[60:63], v[124:127]
  ds_read_b64_tr_b16 v[40:41], v10 offset:4096
  s_waitcnt lgkmcnt(5)
  v_mfma_f32_16x16x32_bf16 v[64:67], v[48:51], a[64:67], v[64:67]
  v_mul_f32 v179, v163, v179
  v_cvt_pk_bf16_f32 v131, v178, v179
  v_mfma_f32_16x16x32_bf16 v[64:67], v[52:55], a[80:83], v[64:67]
  ds_read_b64_tr_b16 v[42:43], v10 offset:4608
  v_add_u32 v28, 49152, v26
  v_mfma_f32_16x16x32_bf16 v[68:71], v[48:51], a[68:71], v[68:71]
  ds_write_b128 v28, v[128:131] offset:0
  v_mfma_f32_16x16x32_bf16 v[68:71], v[52:55], a[84:87], v[68:71]
  ds_read_b64_tr_b16 v[44:45], v10 offset:12288
  v_mul_f32 v132, s77, v132
  v_mfma_f32_16x16x32_bf16 v[72:75], v[48:51], a[72:75], v[72:75]
  s_add_u32 s24, s24, 16384
  buffer_store_dwordx4 v[128:131], v26, s[48:51], s24 offen offset:0 sc1
  v_mfma_f32_16x16x32_bf16 v[72:75], v[52:55], a[88:91], v[72:75]
  ds_read_b64_tr_b16 v[46:47], v10 offset:12800
  v_mul_f32 v149, v133, v149
  v_mfma_f32_16x16x32_bf16 v[76:79], v[48:51], a[76:79], v[76:79]
  s_barrier
  v_mfma_f32_16x16x32_bf16 v[76:79], v[52:55], a[92:95], v[76:79]
  ds_read_b64_tr_b16 v[48:49], v9 offset:49152
  s_add_u32 m0, s74, 98304
  v_mfma_f32_16x16x32_bf16 v[80:83], v[56:59], a[64:67], v[80:83]
  buffer_load_dwordx4 v17, s[40:43], s73 offen lds
  v_mfma_f32_16x16x32_bf16 v[80:83], v[60:63], a[80:83], v[80:83]
  ds_read_b64_tr_b16 v[50:51], v9 offset:49664
  v_mul_f32 v133, s77, v133
  v_mfma_f32_16x16x32_bf16 v[84:87], v[56:59], a[68:71], v[84:87]
  v_exp_f32 v132, v132
  v_mfma_f32_16x16x32_bf16 v[84:87], v[60:63], a[84:87], v[84:87]
  ds_read_b64_tr_b16 v[52:53], v9 offset:57344
  v_add_f32 v132, 1.0, v132
  v_mfma_f32_16x16x32_bf16 v[88:91], v[56:59], a[72:75], v[88:91]
  buffer_load_dwordx4 v18, s[40:43], s73 offen offset:1024 lds
  v_mfma_f32_16x16x32_bf16 v[88:91], v[60:63], a[88:91], v[88:91]
  ds_read_b64_tr_b16 v[54:55], v9 offset:57856
  v_mul_f32 v150, v134, v150
  v_mfma_f32_16x16x32_bf16 v[92:95], v[56:59], a[76:79], v[92:95]
  v_rcp_f32 v132, v132
  v_mfma_f32_16x16x32_bf16 v[92:95], v[60:63], a[92:95], v[92:95]
  ds_read_b64_tr_b16 v[56:57], v9 offset:53248
  s_waitcnt lgkmcnt(5)
  v_mfma_f32_16x16x32_bf16 v[96:99], v[32:35], a[64:67], v[96:99]
  buffer_load_dwordx4 v19, s[40:43], s73 offen offset:2048 lds
  v_mfma_f32_16x16x32_bf16 v[96:99], v[36:39], a[80:83], v[96:99]
  ds_read_b64_tr_b16 v[58:59], v9 offset:53760
  v_mul_f32 v148, v132, v148
  v_mfma_f32_16x16x32_bf16 v[100:103], v[32:35], a[68:71], v[100:103]
  v_exp_f32 v133, v133
  v_mfma_f32_16x16x32_bf16 v[100:103], v[36:39], a[84:87], v[100:103]
  ds_read_b64_tr_b16 v[60:61], v9 offset:61440
  v_add_f32 v133, 1.0, v133
  v_mfma_f32_16x16x32_bf16 v[104:107], v[32:35], a[72:75], v[104:107]
  v_rcp_f32 v133, v133
  v_mfma_f32_16x16x32_bf16 v[104:107], v[36:39], a[88:91], v[104:107]
  ds_read_b64_tr_b16 v[62:63], v9 offset:61952
  v_mul_f32 v149, v133, v149
  v_mfma_f32_16x16x32_bf16 v[108:111], v[32:35], a[76:79], v[108:111]
  buffer_load_dwordx4 v20, s[40:43], s73 offen offset:3072 lds
  v_mfma_f32_16x16x32_bf16 v[108:111], v[36:39], a[92:95], v[108:111]
  ds_read_b64_tr_b16 v[32:33], v10 offset:49152
  v_mul_f32 v134, s77, v134
  v_mfma_f32_16x16x32_bf16 v[112:115], v[40:43], a[64:67], v[112:115]
  v_exp_f32 v134, v134
  v_mfma_f32_16x16x32_bf16 v[112:115], v[44:47], a[80:83], v[112:115]
  ds_read_b64_tr_b16 v[34:35], v10 offset:49664
  v_add_f32 v134, 1.0, v134
  v_mfma_f32_16x16x32_bf16 v[116:119], v[40:43], a[68:71], v[116:119]
  v_rcp_f32 v134, v134
  v_mfma_f32_16x16x32_bf16 v[116:119], v[44:47], a[84:87], v[116:119]
  ds_read_b64_tr_b16 v[36:37], v10 offset:57344
  s_mov_b32 s73, s79
  v_mfma_f32_16x16x32_bf16 v[120:123], v[40:43], a[72:75], v[120:123]
  v_lshrrev_b32 v30, 7, v21
  v_mul_u32_u24 v17, 1152, v30
  v_mfma_f32_16x16x32_bf16 v[120:123], v[44:47], a[88:91], v[120:123]
  ds_read_b64_tr_b16 v[38:39], v10 offset:57856
  v_lshrrev_b32 v30, 8, v21
  v_mfma_f32_16x16x32_bf16 v[124:127], v[40:43], a[76:79], v[124:127]
  v_lshlrev_b32 v30, 5, v30
  v_and_b32 v18, 0x70, v21
  v_mfma_f32_16x16x32_bf16 v[124:127], v[44:47], a[92:95], v[124:127]
  ds_read_b64_tr_b16 v[40:41], v10 offset:53248
  s_waitcnt lgkmcnt(5)
  v_mfma_f32_16x16x32_bf16 v[64:67], v[48:51], a[96:99], v[64:67]
  v_xor_b32 v30, v30, v18
  v_add_u32 v17, v17, v30
  v_add_u32 v18, 8192, v17
  v_add_u32 v19, 16384, v17
  v_add_u32 v20, 24576, v17
  v_mfma_f32_16x16x32_bf16 v[64:67], v[52:55], a[112:115], v[64:67]
  ds_read_b64_tr_b16 v[42:43], v10 offset:53760
  v_mul_f32 v150, v134, v150
  v_mfma_f32_16x16x32_bf16 v[68:71], v[48:51], a[100:103], v[68:71]
  v_mul_f32 v151, v135, v151
  v_mul_f32 v180, v164, v180
  v_mfma_f32_16x16x32_bf16 v[68:71], v[52:55], a[116:119], v[68:71]
  ds_read_b64_tr_b16 v[44:45], v10 offset:61440
  v_mul_f32 v135, s77, v135
  v_mfma_f32_16x16x32_bf16 v[72:75], v[48:51], a[104:107], v[72:75]
  v_exp_f32 v135, v135
  v_mfma_f32_16x16x32_bf16 v[72:75], v[52:55], a[120:123], v[72:75]
  ds_read_b64_tr_b16 v[46:47], v10 offset:61952
  v_add_f32 v135, 1.0, v135
  v_mfma_f32_16x16x32_bf16 v[76:79], v[48:51], a[108:111], v[76:79]
  s_barrier
  v_mfma_f32_16x16x32_bf16 v[76:79], v[52:55], a[124:127], v[76:79]
  ds_read_b64_tr_b16 v[48:49], v7 offset:0
  s_add_u32 m0, s74, 65536
  v_mfma_f32_16x16x32_bf16 v[80:83], v[56:59], a[96:99], v[80:83]
  buffer_load_dwordx4 v13, s[40:43], s73 offen lds
  v_mfma_f32_16x16x32_bf16 v[80:83], v[60:63], a[112:115], v[80:83]
  ds_read_b64_tr_b16 v[50:51], v7 offset:512
  v_mul_f32 v164, s77, v164
  v_mfma_f32_16x16x32_bf16 v[84:87], v[56:59], a[100:103], v[84:87]
  v_rcp_f32 v135, v135
  v_mfma_f32_16x16x32_bf16 v[84:87], v[60:63], a[116:119], v[84:87]
  ds_read_b64_tr_b16 v[52:53], v7 offset:8192
  v_mul_f32 v151, v135, v151
  v_mfma_f32_16x16x32_bf16 v[88:91], v[56:59], a[104:107], v[88:91]
  buffer_load_dwordx4 v14, s[40:43], s73 offen offset:1024 lds
  v_mfma_f32_16x16x32_bf16 v[88:91], v[60:63], a[120:123], v[88:91]
  ds_read_b64_tr_b16 v[54:55], v7 offset:8704
  v_lshrrev_b32 v242, 2, v21
  v_mfma_f32_16x16x32_bf16 v[92:95], v[56:59], a[108:111], v[92:95]
  v_exp_f32 v164, v164
  v_mfma_f32_16x16x32_bf16 v[92:95], v[60:63], a[124:127], v[92:95]
  ds_read_b64_tr_b16 v[56:57], v7 offset:4096
  s_waitcnt lgkmcnt(5)
  v_mfma_f32_16x16x32_bf16 v[96:99], v[32:35], a[96:99], v[96:99]
  buffer_load_dwordx4 v15, s[40:43], s73 offen offset:2048 lds
  v_mfma_f32_16x16x32_bf16 v[96:99], v[36:39], a[112:115], v[96:99]
  ds_read_b64_tr_b16 v[58:59], v7 offset:4608
  v_add_f32 v164, 1.0, v164
  v_mfma_f32_16x16x32_bf16 v[100:103], v[32:35], a[100:103], v[100:103]
  v_rcp_f32 v164, v164
  v_mfma_f32_16x16x32_bf16 v[100:103], v[36:39], a[116:119], v[100:103]
  ds_read_b64_tr_b16 v[60:61], v7 offset:12288
  v_mul_f32 v180, v164, v180
  v_mfma_f32_16x16x32_bf16 v[104:107], v[32:35], a[104:107], v[104:107]
  v_mul_f32 v181, v165, v181
  v_mul_f32 v182, v166, v182
  v_mfma_f32_16x16x32_bf16 v[104:107], v[36:39], a[120:123], v[104:107]
  ds_read_b64_tr_b16 v[62:63], v7 offset:12800
  v_mul_f32 v165, s77, v165
  v_mfma_f32_16x16x32_bf16 v[108:111], v[32:35], a[108:111], v[108:111]
  buffer_load_dwordx4 v16, s[40:43], s73 offen offset:3072 lds
  v_mfma_f32_16x16x32_bf16 v[108:111], v[36:39], a[124:127], v[108:111]
  ds_read_b64_tr_b16 v[32:33], v8 offset:0
  v_mul_f32 v166, s77, v166
  v_mfma_f32_16x16x32_bf16 v[112:115], v[40:43], a[96:99], v[112:115]
  v_exp_f32 v165, v165
  v_mfma_f32_16x16x32_bf16 v[112:115], v[44:47], a[112:115], v[112:115]
  ds_read_b64_tr_b16 v[34:35], v8 offset:512
  v_add_f32 v165, 1.0, v165
  v_mfma_f32_16x16x32_bf16 v[116:119], v[40:43], a[100:103], v[116:119]
  v_rcp_f32 v165, v165
  v_mfma_f32_16x16x32_bf16 v[116:119], v[44:47], a[116:119], v[116:119]
  ds_read_b64_tr_b16 v[36:37], v8 offset:8192
  s_add_u32 s73, s73, 1179648
  v_mfma_f32_16x16x32_bf16 v[120:123], v[40:43], a[104:107], v[120:123]
  v_exp_f32 v166, v166
  v_mfma_f32_16x16x32_bf16 v[120:123], v[44:47], a[120:123], v[120:123]
  ds_read_b64_tr_b16 v[38:39], v8 offset:8704
  v_mul_f32 v181, v165, v181
  v_mfma_f32_16x16x32_bf16 v[124:127], v[40:43], a[108:111], v[124:127]
  v_add_f32 v166, 1.0, v166
  v_mul_f32 v183, v167, v183
  v_mfma_f32_16x16x32_bf16 v[124:127], v[44:47], a[124:127], v[124:127]
  ds_read_b64_tr_b16 v[40:41], v8 offset:4096
  s_waitcnt lgkmcnt(5)
  v_mfma_f32_16x16x32_bf16 v[64:67], v[48:51], a[128:131], v[64:67]
  v_rcp_f32 v166, v166
  v_mfma_f32_16x16x32_bf16 v[64:67], v[52:55], a[144:147], v[64:67]
  ds_read_b64_tr_b16 v[42:43], v8 offset:4608
  v_mul_f32 v182, v166, v182
  v_mfma_f32_16x16x32_bf16 v[68:71], v[48:51], a[132:135], v[68:71]
  v_mul_f32 v167, s77, v167
  v_cvt_pk_bf16_f32 v132, v148, v149
  v_mfma_f32_16x16x32_bf16 v[68:71], v[52:55], a[148:151], v[68:71]
  ds_read_b64_tr_b16 v[44:45], v8 offset:12288
  v_cvt_pk_bf16_f32 v133, v150, v151
  v_mfma_f32_16x16x32_bf16 v[72:75], v[48:51], a[136:139], v[72:75]
  v_exp_f32 v167, v167
  v_mfma_f32_16x16x32_bf16 v[72:75], v[52:55], a[152:155], v[72:75]
  ds_read_b64_tr_b16 v[46:47], v8 offset:12800
  v_add_f32 v167, 1.0, v167
  v_mfma_f32_16x16x32_bf16 v[76:79], v[48:51], a[140:143], v[76:79]
  s_barrier
  v_mfma_f32_16x16x32_bf16 v[76:79], v[52:55], a[156:159], v[76:79]
  ds_read_b64_tr_b16 v[48:49], v7 offset:16384
  s_add_u32 m0, s74, 114688
  v_mfma_f32_16x16x32_bf16 v[80:83], v[56:59], a[128:131], v[80:83]
  buffer_load_dwordx4 v13, s[40:43], s73 offen lds
  v_mfma_f32_16x16x32_bf16 v[80:83], v[60:63], a[144:147], v[80:83]
  ds_read_b64_tr_b16 v[50:51], v7 offset:16896
  v_cvt_pk_bf16_f32 v134, v180, v181
  v_mfma_f32_16x16x32_bf16 v[84:87], v[56:59], a[132:135], v[84:87]
  buffer_load_dword v241, v242, s[60:63], 0 offen sc1
  v_mfma_f32_16x16x32_bf16 v[84:87], v[60:63], a[148:151], v[84:87]
  ds_read_b64_tr_b16 v[52:53], v7 offset:24576
  v_and_b32 v240, 0xf0, v21
  v_mfma_f32_16x16x32_bf16 v[88:91], v[56:59], a[136:139], v[88:91]
  buffer_load_dwordx4 v14, s[40:43], s73 offen offset:1024 lds
  v_mfma_f32_16x16x32_bf16 v[88:91], v[60:63], a[152:155], v[88:91]
  v_rcp_f32 v167, v167
  v_mul_f32 v152, v136, v152
  v_mfma_f32_16x16x32_bf16 v[92:95], v[56:59], a[140:143], v[92:95]
  ds_read_b64_tr_b16 v[54:55], v7 offset:25088
  v_lshrrev_b32 v22, 8, v21
  v_mfma_f32_16x16x32_bf16 v[92:95], v[60:63], a[156:159], v[92:95]
  v_mul_f32 v183, v167, v183
  v_mul_f32 v136, s77, v136
  s_waitcnt lgkmcnt(4)
  v_mfma_f32_16x16x32_bf16 v[96:99], v[32:35], a[128:131], v[96:99]
  ds_read_b64_tr_b16 v[56:57], v7 offset:20480
  v_lshl_add_u32 v0, v22, 9, v240
  v_mfma_f32_16x16x32_bf16 v[96:99], v[36:39], a[144:147], v[96:99]
  v_exp_f32 v136, v136
  v_mfma_f32_16x16x32_bf16 v[100:103], v[32:35], a[132:135], v[100:103]
  ds_read_b64_tr_b16 v[58:59], v7 offset:20992
  v_lshl_add_u32 v22, v22, 10, v240
  v_mfma_f32_16x16x32_bf16 v[100:103], v[36:39], a[148:151], v[100:103]
  v_add_f32 v136, 1.0, v136
  ds_read_b64_tr_b16 v[60:61], v7 offset:28672
  v_mfma_f32_16x16x32_bf16 v[104:107], v[32:35], a[136:139], v[104:107]
  v_cvt_pk_bf16_f32 v135, v182, v183
  s_lshl_b32 s88, s64, 8
  v_mfma_f32_16x16x32_bf16 v[104:107], v[36:39], a[152:155], v[104:107]
  v_rcp_f32 v136, v136
  v_mul_f32 v153, v137, v153
  v_mfma_f32_16x16x32_bf16 v[108:111], v[32:35], a[140:143], v[108:111]
  buffer_load_dwordx4 v15, s[40:43], s73 offen offset:2048 lds
  v_mfma_f32_16x16x32_bf16 v[108:111], v[36:39], a[156:159], v[108:111]
  ds_write_b128 v28, v[132:135] offset:1024
  v_mul_f32 v152, v136, v152
  v_mul_f32 v137, s77, v137
  v_mfma_f32_16x16x32_bf16 v[112:115], v[40:43], a[128:131], v[112:115]
  ds_read_b64_tr_b16 v[62:63], v7 offset:29184
  v_add_u32 v22, s88, v22
  v_mfma_f32_16x16x32_bf16 v[112:115], v[44:47], a[144:147], v[112:115]
  buffer_store_dwordx4 v[132:135], v26, s[48:51], s24 offen offset:1024 sc1
  v_exp_f32 v137, v137
  v_mfma_f32_16x16x32_bf16 v[116:119], v[40:43], a[132:135], v[116:119]
  ds_read_b64_tr_b16 v[32:33], v8 offset:16384
  v_add_f32 v137, 1.0, v137
  v_mfma_f32_16x16x32_bf16 v[116:119], v[44:47], a[148:151], v[116:119]
  buffer_load_dwordx4 v16, s[40:43], s73 offen offset:3072 lds
  v_mfma_f32_16x16x32_bf16 v[120:123], v[40:43], a[136:139], v[120:123]
  ds_read_b64_tr_b16 v[34:35], v8 offset:16896
  s_add_u32 s73, s73, 1179648
  v_mfma_f32_16x16x32_bf16 v[120:123], v[44:47], a[152:155], v[120:123]
  v_rcp_f32 v137, v137
  v_mul_f32 v154, v138, v154
  v_mfma_f32_16x16x32_bf16 v[124:127], v[40:43], a[140:143], v[124:127]
  ds_read_b64_tr_b16 v[36:37], v8 offset:24576
  v_mul_f32 v153, v137, v153
  v_mfma_f32_16x16x32_bf16 v[124:127], v[44:47], a[156:159], v[124:127]
  v_mul_f32 v138, s77, v138
  s_waitcnt lgkmcnt(3)
  v_mfma_f32_16x16x32_bf16 v[64:67], v[48:51], a[160:163], v[64:67]
  ds_read_b64_tr_b16 v[38:39], v8 offset:25088
  v_mul_f32 v155, v139, v155
  v_mfma_f32_16x16x32_bf16 v[64:67], v[52:55], a[176:179], v[64:67]
  v_exp_f32 v138, v138
  v_mfma_f32_16x16x32_bf16 v[68:71], v[48:51], a[164:167], v[68:71]
  ds_read_b64_tr_b16 v[40:41], v8 offset:20480
  v_add_f32 v138, 1.0, v138
  v_mfma_f32_16x16x32_bf16 v[68:71], v[52:55], a[180:183], v[68:71]
  ds_read_b64_tr_b16 v[42:43], v8 offset:20992
  v_mul_f32 v139, s77, v139
  v_mfma_f32_16x16x32_bf16 v[72:75], v[48:51], a[168:171], v[72:75]
  ds_read_b64_tr_b16 v[44:45], v8 offset:28672
  v_mul_f32 v184, v168, v184
  v_mfma_f32_16x16x32_bf16 v[72:75], v[52:55], a[184:187], v[72:75]
  v_rcp_f32 v138, v138
  v_mfma_f32_16x16x32_bf16 v[76:79], v[48:51], a[172:175], v[76:79]
  s_waitcnt vmcnt(20)
  s_barrier
  v_mfma_f32_16x16x32_bf16 v[76:79], v[52:55], a[188:191], v[76:79]
  v_mul_f32 v154, v138, v154
  ds_read_b64_tr_b16 v[46:47], v8 offset:29184
  v_mfma_f32_16x16x32_bf16 v[80:83], v[56:59], a[160:163], v[80:83]
  ds_read_b64_tr_b16 v[48:49], v11 offset:0
  s_add_u32 m0, s74, 0
  v_mfma_f32_16x16x32_bf16 v[80:83], v[60:63], a[176:179], v[80:83]
  v_exp_f32 v139, v139
  v_mfma_f32_16x16x32_bf16 v[84:87], v[56:59], a[164:167], v[84:87]
  ds_read_b64_tr_b16 v[50:51], v11 offset:512
  v_add_f32 v139, 1.0, v139
  v_mfma_f32_16x16x32_bf16 v[84:87], v[60:63], a[180:183], v[84:87]
  ds_read_b64_tr_b16 v[52:53], v11 offset:8192
  v_mul_f32 v168, s77, v168
  v_mfma_f32_16x16x32_bf16 v[88:91], v[56:59], a[168:171], v[88:91]
  buffer_load_dwordx4 v13, s[40:43], s73 offen lds
  v_mfma_f32_16x16x32_bf16 v[88:91], v[60:63], a[184:187], v[88:91]
  v_rcp_f32 v139, v139
  v_mfma_f32_16x16x32_bf16 v[92:95], v[56:59], a[172:175], v[92:95]
  ds_read_b64_tr_b16 v[54:55], v11 offset:8704
  v_mul_f32 v155, v139, v155
  v_mfma_f32_16x16x32_bf16 v[92:95], v[60:63], a[188:191], v[92:95]
  ds_read_b64_tr_b16 v[56:57], v11 offset:4096
  s_waitcnt lgkmcnt(5)
  v_mfma_f32_16x16x32_bf16 v[96:99], v[32:35], a[160:163], v[96:99]
  buffer_load_dwordx4 v14, s[40:43], s73 offen offset:1024 lds
  v_mfma_f32_16x16x32_bf16 v[96:99], v[36:39], a[176:179], v[96:99]
  v_exp_f32 v168, v168
  v_mfma_f32_16x16x32_bf16 v[100:103], v[32:35], a[164:167], v[100:103]
  ds_read_b64_tr_b16 v[58:59], v11 offset:4608
  v_add_f32 v168, 1.0, v168
  v_mfma_f32_16x16x32_bf16 v[100:103], v[36:39], a[180:183], v[100:103]
  ds_read_b64_tr_b16 v[60:61], v11 offset:12288
  v_mul_f32 v185, v169, v185
  v_mfma_f32_16x16x32_bf16 v[104:107], v[32:35], a[168:171], v[104:107]
  buffer_load_dwordx4 v15, s[40:43], s73 offen offset:2048 lds
  v_mfma_f32_16x16x32_bf16 v[104:107], v[36:39], a[184:187], v[104:107]
  v_rcp_f32 v168, v168
  v_mfma_f32_16x16x32_bf16 v[108:111], v[32:35], a[172:175], v[108:111]
  ds_read_b64_tr_b16 v[62:63], v11 offset:12800
  v_mul_f32 v184, v168, v184
  v_mfma_f32_16x16x32_bf16 v[108:111], v[36:39], a[188:191], v[108:111]
  v_mul_f32 v169, s77, v169
  ds_read_b64_tr_b16 v[32:33], v12 offset:0
  v_mfma_f32_16x16x32_bf16 v[112:115], v[40:43], a[160:163], v[112:115]
  buffer_load_dwordx4 v16, s[40:43], s73 offen offset:3072 lds
  v_mfma_f32_16x16x32_bf16 v[112:115], v[44:47], a[176:179], v[112:115]
  v_exp_f32 v169, v169
  v_mfma_f32_16x16x32_bf16 v[116:119], v[40:43], a[164:167], v[116:119]
  ds_read_b64_tr_b16 v[34:35], v12 offset:512
  s_add_u32 s73, s73, 1179648
  v_mfma_f32_16x16x32_bf16 v[116:119], v[44:47], a[180:183], v[116:119]
  v_add_f32 v169, 1.0, v169
  ds_read_b64_tr_b16 v[36:37], v12 offset:8192
  v_mfma_f32_16x16x32_bf16 v[120:123], v[40:43], a[168:171], v[120:123]
  v_rcp_f32 v169, v169
  v_mfma_f32_16x16x32_bf16 v[120:123], v[44:47], a[184:187], v[120:123]
  v_mul_f32 v186, v170, v186
  ds_read_b64_tr_b16 v[38:39], v12 offset:8704
  v_mfma_f32_16x16x32_bf16 v[124:127], v[40:43], a[172:175], v[124:127]
  v_mul_f32 v185, v169, v185
  v_mul_f32 v170, s77, v170
  v_mfma_f32_16x16x32_bf16 v[124:127], v[44:47], a[188:191], v[124:127]
  ds_read_b64_tr_b16 v[40:41], v12 offset:4096
  s_waitcnt lgkmcnt(5)
  v_mfma_f32_16x16x32_bf16 v[64:67], v[48:51], a[192:195], v[64:67]
  v_exp_f32 v170, v170
  v_mfma_f32_16x16x32_bf16 v[64:67], v[52:55], a[208:211], v[64:67]
  ds_read_b64_tr_b16 v[42:43], v12 offset:4608
  v_add_f32 v170, 1.0, v170
  v_mfma_f32_16x16x32_bf16 v[68:71], v[48:51], a[196:199], v[68:71]
  v_rcp_f32 v170, v170
  v_mfma_f32_16x16x32_bf16 v[68:71], v[52:55], a[212:215], v[68:71]
  ds_read_b64_tr_b16 v[44:45], v12 offset:12288
  v_mul_f32 v186, v170, v186
  v_mfma_f32_16x16x32_bf16 v[72:75], v[48:51], a[200:203], v[72:75]
  v_mul_f32 v187, v171, v187
  v_cvt_pk_bf16_f32 v136, v152, v153
  v_mfma_f32_16x16x32_bf16 v[72:75], v[52:55], a[216:219], v[72:75]
  ds_read_b64_tr_b16 v[46:47], v12 offset:12800
  v_mul_f32 v171, s77, v171
  v_mfma_f32_16x16x32_bf16 v[76:79], v[48:51], a[204:207], v[76:79]
  s_waitcnt vmcnt(19)
  s_barrier
  v_mfma_f32_16x16x32_bf16 v[76:79], v[52:55], a[220:223], v[76:79]
  ds_read_b64_tr_b16 v[48:49], v11 offset:16384
  s_add_u32 m0, s74, 16384
  v_mfma_f32_16x16x32_bf16 v[80:83], v[56:59], a[192:195], v[80:83]
  buffer_load_dwordx4 v13, s[40:43], s73 offen lds
  v_mfma_f32_16x16x32_bf16 v[80:83], v[60:63], a[208:211], v[80:83]
  v_exp_f32 v171, v171
  v_mfma_f32_16x16x32_bf16 v[84:87], v[56:59], a[196:199], v[84:87]
  ds_read_b64_tr_b16 v[50:51], v11 offset:16896
  v_add_f32 v171, 1.0, v171
  v_mfma_f32_16x16x32_bf16 v[84:87], v[60:63], a[212:215], v[84:87]
  ds_read_b64_tr_b16 v[52:53], v11 offset:24576
  v_cvt_pk_bf16_f32 v137, v154, v155
  v_mfma_f32_16x16x32_bf16 v[88:91], v[56:59], a[200:203], v[88:91]
  buffer_load_dwordx4 v14, s[40:43], s73 offen offset:1024 lds
  v_mfma_f32_16x16x32_bf16 v[88:91], v[60:63], a[216:219], v[88:91]
  v_rcp_f32 v171, v171
  v_mul_f32 v156, v140, v156
  v_mfma_f32_16x16x32_bf16 v[92:95], v[56:59], a[204:207], v[92:95]
  ds_read_b64_tr_b16 v[54:55], v11 offset:25088
  v_mul_f32 v187, v171, v187
  v_mfma_f32_16x16x32_bf16 v[92:95], v[60:63], a[220:223], v[92:95]
  v_mul_f32 v140, s77, v140
  s_waitcnt lgkmcnt(4)
  v_mfma_f32_16x16x32_bf16 v[96:99], v[32:35], a[192:195], v[96:99]
  ds_read_b64_tr_b16 v[56:57], v11 offset:20480
  v_cvt_pk_bf16_f32 v138, v184, v185
  v_mfma_f32_16x16x32_bf16 v[96:99], v[36:39], a[208:211], v[96:99]
  v_exp_f32 v140, v140
  v_mfma_f32_16x16x32_bf16 v[100:103], v[32:35], a[196:199], v[100:103]
  ds_read_b64_tr_b16 v[58:59], v11 offset:20992
  v_cvt_pk_bf16_f32 v139, v186, v187
  v_mfma_f32_16x16x32_bf16 v[100:103], v[36:39], a[212:215], v[100:103]
  v_add_f32 v140, 1.0, v140
  ds_read_b64_tr_b16 v[60:61], v11 offset:28672
  v_mfma_f32_16x16x32_bf16 v[104:107], v[32:35], a[200:203], v[104:107]
  s_waitcnt vmcnt(10)
  v_cmp_ne_u32 vcc, 0x01010101, v241
  s_nop 3
  s_cmp_lg_u64 vcc, 0
  s_cbranch_scc1 k1_kernel_spin
k1_kernel_spinret:
  v_mfma_f32_16x16x32_bf16 v[104:107], v[36:39], a[216:219], v[104:107]
  v_rcp_f32 v140, v140
  v_mul_f32 v157, v141, v157
  v_mfma_f32_16x16x32_bf16 v[108:111], v[32:35], a[204:207], v[108:111]
  buffer_load_dwordx4 v15, s[40:43], s73 offen offset:2048 lds
  v_mfma_f32_16x16x32_bf16 v[108:111], v[36:39], a[220:223], v[108:111]
  ds_write_b128 v28, v[136:139] offset:2048
  v_mul_f32 v156, v140, v156
  v_mul_f32 v141, s77, v141
  v_mfma_f32_16x16x32_bf16 v[112:115], v[40:43], a[192:195], v[112:115]
  ds_read_b64_tr_b16 v[62:63], v11 offset:29184
  v_mul_f32 v158, v142, v158
  v_mfma_f32_16x16x32_bf16 v[112:115], v[44:47], a[208:211], v[112:115]
  buffer_store_dwordx4 v[136:139], v26, s[48:51], s24 offen offset:2048 sc1
  v_exp_f32 v141, v141
  v_mfma_f32_16x16x32_bf16 v[116:119], v[40:43], a[196:199], v[116:119]
  buffer_load_dword v241, off, s[48:51], s27 sc1
  v_mfma_f32_16x16x32_bf16 v[116:119], v[44:47], a[212:215], v[116:119]
  buffer_load_dwordx4 v16, s[40:43], s73 offen offset:3072 lds
  v_add_f32 v141, 1.0, v141
  v_mfma_f32_16x16x32_bf16 v[120:123], v[40:43], a[200:203], v[120:123]
  ds_read_b64_tr_b16 v[32:33], v12 offset:16384
  s_add_u32 s73, s73, 1179648
  v_mfma_f32_16x16x32_bf16 v[120:123], v[44:47], a[216:219], v[120:123]
  v_rcp_f32 v141, v141
  v_mfma_f32_16x16x32_bf16 v[124:127], v[40:43], a[204:207], v[124:127]
  ds_read_b64_tr_b16 v[34:35], v12 offset:16896
  v_mul_f32 v157, v141, v157
  v_mfma_f32_16x16x32_bf16 v[124:127], v[44:47], a[220:223], v[124:127]
  v_mul_f32 v142, s77, v142
  s_waitcnt lgkmcnt(5)
  v_mfma_f32_16x16x32_bf16 v[64:67], v[48:51], a[224:227], v[64:67]
  ds_read_b64_tr_b16 v[36:37], v12 offset:24576
  v_mul_f32 v159, v143, v159
  v_mfma_f32_16x16x32_bf16 v[64:67], v[52:55], a[240:243], v[64:67]
  v_exp_f32 v142, v142
  v_mfma_f32_16x16x32_bf16 v[68:71], v[48:51], a[228:231], v[68:71]
  ds_read_b64_tr_b16 v[38:39], v12 offset:25088
  v_add_f32 v142, 1.0, v142
  v_mfma_f32_16x16x32_bf16 v[68:71], v[52:55], a[244:247], v[68:71]
  ds_read_b64_tr_b16 v[40:41], v12 offset:20480
  v_mul_f32 v143, s77, v143
  v_mfma_f32_16x16x32_bf16 v[72:75], v[48:51], a[232:235], v[72:75]
  ds_read_b64_tr_b16 v[42:43], v12 offset:20992
  v_mul_f32 v188, v172, v188
  v_mfma_f32_16x16x32_bf16 v[72:75], v[52:55], a[248:251], v[72:75]
  v_rcp_f32 v142, v142
  v_mfma_f32_16x16x32_bf16 v[76:79], v[48:51], a[236:239], v[76:79]
  s_barrier
  v_mfma_f32_16x16x32_bf16 v[76:79], v[52:55], a[252:255], v[76:79]
  v_mul_f32 v158, v142, v158
  ds_read_b64_tr_b16 v[44:45], v12 offset:28672
  v_mfma_f32_16x16x32_bf16 v[80:83], v[56:59], a[224:227], v[80:83]
  ds_read_b64_tr_b16 v[46:47], v12 offset:29184
  s_waitcnt lgkmcnt(4)
  v_mfma_f32_16x16x32_bf16 v[80:83], v[60:63], a[240:243], v[80:83]
  v_exp_f32 v143, v143
  v_mfma_f32_16x16x32_bf16 v[84:87], v[56:59], a[228:231], v[84:87]
  ds_read_b64_tr_b16 v[48:49], v9 offset:32768
  s_add_u32 m0, s74, 131072
  v_mfma_f32_16x16x32_bf16 v[84:87], v[60:63], a[244:247], v[84:87]
  v_add_f32 v143, 1.0, v143
  ds_read_b64_tr_b16 v[50:51], v9 offset:33280
  v_mfma_f32_16x16x32_bf16 v[88:91], v[56:59], a[232:235], v[88:91]
  ds_read_b64_tr_b16 v[52:53], v9 offset:40960
  v_mul_f32 v172, s77, v172
  v_mfma_f32_16x16x32_bf16 v[88:91], v[60:63], a[248:251], v[88:91]
  v_rcp_f32 v143, v143
  v_mfma_f32_16x16x32_bf16 v[92:95], v[56:59], a[236:239], v[92:95]
  ds_read_b64_tr_b16 v[54:55], v9 offset:41472
  v_mul_f32 v159, v143, v159
  v_mfma_f32_16x16x32_bf16 v[92:95], v[60:63], a[252:255], v[92:95]
  buffer_load_dwordx4 v13, s[40:43], s73 offen lds
  v_mfma_f32_16x16x32_bf16 v[96:99], v[32:35], a[224:227], v[96:99]
  ds_read_b64_tr_b16 v[56:57], v9 offset:36864
  v_mul_f32 v189, v173, v189
  v_mfma_f32_16x16x32_bf16 v[96:99], v[36:39], a[240:243], v[96:99]
  buffer_load_dwordx4 v14, s[40:43], s73 offen offset:1024 lds
  v_exp_f32 v172, v172
  v_mfma_f32_16x16x32_bf16 v[100:103], v[32:35], a[228:231], v[100:103]
  ds_read_b64_tr_b16 v[58:59], v9 offset:37376
  v_add_f32 v172, 1.0, v172
  v_mfma_f32_16x16x32_bf16 v[100:103], v[36:39], a[244:247], v[100:103]
  ds_read_b64_tr_b16 v[60:61], v9 offset:45056
  v_mul_f32 v173, s77, v173
  v_mfma_f32_16x16x32_bf16 v[104:107], v[32:35], a[232:235], v[104:107]
  buffer_load_dwordx4 v15, s[40:43], s73 offen offset:2048 lds
  v_mfma_f32_16x16x32_bf16 v[104:107], v[36:39], a[248:251], v[104:107]
  v_rcp_f32 v172, v172
  v_mfma_f32_16x16x32_bf16 v[108:111], v[32:35], a[236:239], v[108:111]
  ds_read_b64_tr_b16 v[62:63], v9 offset:45568
  v_mul_f32 v188, v172, v188
  v_mfma_f32_16x16x32_bf16 v[108:111], v[36:39], a[252:255], v[108:111]
  ds_read_b64_tr_b16 v[32:33], v10 offset:32768
  s_waitcnt lgkmcnt(5)
  v_mfma_f32_16x16x32_bf16 v[112:115], v[40:43], a[224:227], v[112:115]
  buffer_load_dwordx4 v16, s[40:43], s73 offen offset:3072 lds
  v_mfma_f32_16x16x32_bf16 v[112:115], v[44:47], a[240:243], v[112:115]
  v_exp_f32 v173, v173
  v_mfma_f32_16x16x32_bf16 v[116:119], v[40:43], a[228:231], v[116:119]
  ds_read_b64_tr_b16 v[34:35], v10 offset:33280
  v_add_f32 v173, 1.0, v173
  v_mfma_f32_16x16x32_bf16 v[116:119], v[44:47], a[244:247], v[116:119]
  ds_read_b64_tr_b16 v[36:37], v10 offset:40960
  v_mul_f32 v190, v174, v190
  v_mfma_f32_16x16x32_bf16 v[120:123], v[40:43], a[232:235], v[120:123]
  v_rcp_f32 v173, v173
  v_mfma_f32_16x16x32_bf16 v[120:123], v[44:47], a[248:251], v[120:123]
  ds_read_b64_tr_b16 v[38:39], v10 offset:41472
  v_mul_f32 v189, v173, v189
  v_mfma_f32_16x16x32_bf16 v[124:127], v[40:43], a[236:239], v[124:127]
  v_mul_f32 v174, s77, v174
  v_mul_f32 v191, v175, v191
  v_mfma_f32_16x16x32_bf16 v[124:127], v[44:47], a[252:255], v[124:127]
  ds_read_b64_tr_b16 v[40:41], v10 offset:36864
  v_mul_f32 v175, s77, v175
  v_mfma_f32_16x16x32_bf16 v[64:67], v[48:51], v[192:195], v[64:67]
  v_exp_f32 v174, v174
  v_mfma_f32_16x16x32_bf16 v[64:67], v[52:55], v[208:211], v[64:67]
  ds_read_b64_tr_b16 v[42:43], v10 offset:37376
  v_add_f32 v174, 1.0, v174
  v_mfma_f32_16x16x32_bf16 v[68:71], v[48:51], v[196:199], v[68:71]
  v_rcp_f32 v174, v174
  v_mfma_f32_16x16x32_bf16 v[68:71], v[52:55], v[212:215], v[68:71]
  ds_read_b64_tr_b16 v[44:45], v10 offset:45056
  v_mul_f32 v190, v174, v190
  v_mfma_f32_16x16x32_bf16 v[72:75], v[48:51], v[200:203], v[72:75]
  v_exp_f32 v175, v175
  v_mfma_f32_16x16x32_bf16 v[72:75], v[52:55], v[216:219], v[72:75]
  ds_read_b64_tr_b16 v[46:47], v10 offset:45568
  v_add_f32 v175, 1.0, v175
  v_mfma_f32_16x16x32_bf16 v[76:79], v[48:51], v[204:207], v[76:79]
  s_barrier
  v_mfma_f32_16x16x32_bf16 v[76:79], v[52:55], v[220:223], v[76:79]
  ds_read_b64_tr_b16 v[48:49], v24 offset:0
  s_waitcnt lgkmcnt(5)
  v_mfma_f32_16x16x32_bf16 v[80:83], v[56:59], v[192:195], v[80:83]
  v_rcp_f32 v175, v175
  v_mfma_f32_16x16x32_bf16 v[80:83], v[60:63], v[208:211], v[80:83]
  ds_read_b64_tr_b16 v[50:51], v24 offset:256
  v_readlane_b32 s73, v31, 0
  v_mfma_f32_16x16x32_bf16 v[84:87], v[56:59], v[196:199], v[84:87]
  s_add_u32 m0, s74, 147456
  v_mul_f32 v191, v175, v191
  v_mfma_f32_16x16x32_bf16 v[84:87], v[60:63], v[212:215], v[84:87]
  ds_read_b64_tr_b16 v[52:53], v24 offset:2048
  v_cvt_pk_bf16_f32 v140, v156, v157
  v_mfma_f32_16x16x32_bf16 v[88:91], v[56:59], v[200:203], v[88:91]
  buffer_load_dwordx4 v17, s[44:47], s73 offen lds
  v_mfma_f32_16x16x32_bf16 v[88:91], v[60:63], v[216:219], v[88:91]
  ds_read_b64_tr_b16 v[54:55], v24 offset:2304
  v_cvt_pk_bf16_f32 v141, v158, v159
  v_mfma_f32_16x16x32_bf16 v[92:95], v[56:59], v[204:207], v[92:95]
  buffer_load_dwordx4 v18, s[44:47], s73 offen offset:1024 lds
  v_mfma_f32_16x16x32_bf16 v[92:95], v[60:63], v[220:223], v[92:95]
  ds_read_b64_tr_b16 v[56:57], v24 offset:4096
  v_cvt_pk_bf16_f32 v142, v188, v189
  v_mfma_f32_16x16x32_bf16 v[96:99], v[32:35], v[192:195], v[96:99]
  buffer_load_dwordx4 v19, s[44:47], s73 offen offset:2048 lds
  v_mfma_f32_16x16x32_bf16 v[96:99], v[36:39], v[208:211], v[96:99]
  ds_read_b64_tr_b16 v[58:59], v24 offset:4352
  v_cvt_pk_bf16_f32 v143, v190, v191
  v_mfma_f32_16x16x32_bf16 v[100:103], v[32:35], v[196:199], v[100:103]
  ds_write_b128 v28, v[140:143] offset:3072
  v_mfma_f32_16x16x32_bf16 v[100:103], v[36:39], v[212:215], v[100:103]
  ds_read_b64_tr_b16 v[60:61], v24 offset:6144
  v_mfma_f32_16x16x32_bf16 v[104:107], v[32:35], v[200:203], v[104:107]
  buffer_store_dwordx4 v[140:143], v26, s[48:51], s24 offen offset:3072 sc1
  v_mfma_f32_16x16x32_bf16 v[104:107], v[36:39], v[216:219], v[104:107]
  ds_read_b64_tr_b16 v[62:63], v24 offset:6400
  v_mfma_f32_16x16x32_bf16 v[108:111], v[32:35], v[204:207], v[108:111]
  buffer_load_dwordx4 v20, s[44:47], s73 offen offset:3072 lds
  v_mfma_f32_16x16x32_bf16 v[108:111], v[36:39], v[220:223], v[108:111]
  ds_read_b64_tr_b16 v[32:33], v24 offset:8192
  s_waitcnt lgkmcnt(6)
  v_mfma_f32_16x16x32_bf16 v[112:115], v[40:43], v[192:195], v[112:115]
  s_waitcnt vmcnt(10)
  v_readfirstlane_b32 s71, v241
  s_nop 3
  s_cmp_lt_u32 s71, 2
  s_cbranch_scc1 k1_kernel_gs2
k1_kernel_gr2:
  v_mfma_f32_16x16x32_bf16 v[112:115], v[44:47], v[208:211], v[112:115]
  ds_read_b64_tr_b16 v[34:35], v24 offset:8448
  v_mfma_f32_16x16x32_bf16 v[116:119], v[40:43], v[196:199], v[116:119]
k1_pg6:
  s_cbranch_execz k1_pg10
  v_readlane_b32 s73, v31, 1
  v_add_u32 v0, 131072, v0
  v_mfma_f32_16x16x32_bf16 v[116:119], v[44:47], v[212:215], v[116:119]
  ds_read_b64_tr_b16 v[36:37], v24 offset:10240
  v_mfma_f32_16x16x32_bf16 v[120:123], v[40:43], v[200:203], v[120:123]
  v_mfma_f32_16x16x32_bf16 v[120:123], v[44:47], v[216:219], v[120:123]
  ds_read_b64_tr_b16 v[38:39], v24 offset:10496
  v_mfma_f32_16x16x32_bf16 v[124:127], v[40:43], v[204:207], v[124:127]
  v_mfma_f32_16x16x32_bf16 v[124:127], v[44:47], v[220:223], v[124:127]
  ds_read_b64_tr_b16 v[40:41], v24 offset:12288
  v_mfma_f32_16x16x32_bf16 v[128:131], v[48:51], a[0:3], 0
  v_add_u32 v29, 32768, v27
  v_mfma_f32_16x16x32_bf16 v[128:131], v[52:55], a[16:19], v[128:131]
  ds_read_b64_tr_b16 v[42:43], v24 offset:12544
  v_mfma_f32_16x16x32_bf16 v[132:135], v[48:51], a[4:7], 0
  v_mul_f32 v80, v64, v80
  v_mul_f32 v81, v65, v81
  v_mfma_f32_16x16x32_bf16 v[132:135], v[52:55], a[20:23], v[132:135]
  ds_read_b64_tr_b16 v[44:45], v24 offset:14336
  v_mul_f32 v64, s77, v64
  v_mfma_f32_16x16x32_bf16 v[136:139], v[48:51], a[8:11], 0
  v_exp_f32 v64, v64
  v_mfma_f32_16x16x32_bf16 v[136:139], v[52:55], a[24:27], v[136:139]
  ds_read_b64_tr_b16 v[46:47], v24 offset:14592
  v_add_f32 v64, 1.0, v64
  v_mfma_f32_16x16x32_bf16 v[140:143], v[48:51], a[12:15], 0
  s_waitcnt lgkmcnt(10)
  s_barrier
  v_mfma_f32_16x16x32_bf16 v[140:143], v[52:55], a[28:31], v[140:143]
  ds_read_b64_tr_b16 v[48:49], v24 offset:49152
  v_mul_f32 v65, s77, v65
  v_mfma_f32_16x16x32_bf16 v[144:147], v[56:59], a[0:3], 0
  v_mul_f32 v82, v66, v82
  s_waitcnt lgkmcnt(3)
  v_mfma_f32_16x16x32_bf16 v[144:147], v[60:63], a[16:19], v[144:147]
  ds_read_b64_tr_b16 v[50:51], v24 offset:49408
  v_mul_f32 v66, s77, v66
  v_mfma_f32_16x16x32_bf16 v[148:151], v[56:59], a[4:7], 0
  v_rcp_f32 v64, v64
  v_mfma_f32_16x16x32_bf16 v[148:151], v[60:63], a[20:23], v[148:151]
  ds_read_b64_tr_b16 v[52:53], v24 offset:51200
  v_mul_f32 v80, v64, v80
  v_mfma_f32_16x16x32_bf16 v[152:155], v[56:59], a[8:11], 0
  v_exp_f32 v65, v65
  v_mfma_f32_16x16x32_bf16 v[152:155], v[60:63], a[24:27], v[152:155]
  ds_read_b64_tr_b16 v[54:55], v24 offset:51456
  v_add_f32 v65, 1.0, v65
  v_mfma_f32_16x16x32_bf16 v[156:159], v[56:59], a[12:15], 0
  v_rcp_f32 v65, v65
  v_mfma_f32_16x16x32_bf16 v[156:159], v[60:63], a[28:31], v[156:159]
  ds_read_b64_tr_b16 v[56:57], v24 offset:53248
  v_mul_f32 v81, v65, v81
  v_mfma_f32_16x16x32_bf16 v[128:131], v[32:35], a[32:35], v[128:131]
  ds_read_b128 a[0:3], v29 offset:0
  v_mfma_f32_16x16x32_bf16 v[128:131], v[36:39], a[48:51], v[128:131]
  ds_read_b64_tr_b16 v[58:59], v24 offset:53504
  v_mul_f32 v83, v67, v83
  v_mfma_f32_16x16x32_bf16 v[132:135], v[32:35], a[36:39], v[132:135]
  ds_read_b128 a[4:7], v29 offset:1024
  v_mfma_f32_16x16x32_bf16 v[132:135], v[36:39], a[52:55], v[132:135]
  ds_read_b64_tr_b16 v[60:61], v24 offset:55296
  v_mul_f32 v67, s77, v67
  v_mfma_f32_16x16x32_bf16 v[136:139], v[32:35], a[40:43], v[136:139]
  ds_read_b128 a[8:11], v29 offset:2048
  v_mfma_f32_16x16x32_bf16 v[136:139], v[36:39], a[56:59], v[136:139]
  v_exp_f32 v66, v66
  v_mfma_f32_16x16x32_bf16 v[140:143], v[32:35], a[44:47], v[140:143]
  ds_read_b64_tr_b16 v[62:63], v24 offset:55552
  v_add_f32 v66, 1.0, v66
  v_mfma_f32_16x16x32_bf16 v[140:143], v[36:39], a[60:63], v[140:143]
  ds_read_b64_tr_b16 v[32:33], v24 offset:57344
  v_mul_f32 v112, v96, v112
  v_mfma_f32_16x16x32_bf16 v[144:147], v[40:43], a[32:35], v[144:147]
  v_exp_f32 v67, v67
  s_waitcnt lgkmcnt(5)
  v_mfma_f32_16x16x32_bf16 v[144:147], v[44:47], a[48:51], v[144:147]
  v_rcp_f32 v66, v66
  v_mfma_f32_16x16x32_bf16 v[148:151], v[40:43], a[36:39], v[148:151]
  v_add_f32 v67, 1.0, v67
  v_mul_f32 v96, s77, v96
  v_mfma_f32_16x16x32_bf16 v[148:151], v[44:47], a[52:55], v[148:151]
  v_mul_f32 v82, v66, v82
  ds_read_b64_tr_b16 v[34:35], v24 offset:57600
  v_mfma_f32_16x16x32_bf16 v[152:155], v[40:43], a[40:43], v[152:155]
  v_rcp_f32 v67, v67
  v_exp_f32 v96, v96
  v_mul_f32 v113, v97, v113
  v_mfma_f32_16x16x32_bf16 v[152:155], v[44:47], a[56:59], v[152:155]
  ds_read_b64_tr_b16 v[36:37], v24 offset:59392
  v_mul_f32 v83, v67, v83
  v_mfma_f32_16x16x32_bf16 v[156:159], v[40:43], a[44:47], v[156:159]
  v_add_f32 v96, 1.0, v96
  v_mul_f32 v97, s77, v97
  v_mfma_f32_16x16x32_bf16 v[156:159], v[44:47], a[60:63], v[156:159]
  v_mul_f32 v114, v98, v114
  ds_read_b64_tr_b16 v[38:39], v24 offset:59648
  v_mfma_f32_16x16x32_bf16 v[128:131], v[48:51], a[64:67], v[128:131]
  v_rcp_f32 v96, v96
  v_exp_f32 v97, v97
  v_mfma_f32_16x16x32_bf16 v[128:131], v[52:55], a[80:83], v[128:131]
  v_mul_f32 v98, s77, v98
  ds_read_b64_tr_b16 v[40:41], v24 offset:61440
  v_mfma_f32_16x16x32_bf16 v[132:135], v[48:51], a[68:71], v[132:135]
  v_mul_f32 v112, v96, v112
  v_add_f32 v97, 1.0, v97
  v_mfma_f32_16x16x32_bf16 v[132:135], v[52:55], a[84:87], v[132:135]
  v_exp_f32 v98, v98
  v_mul_f32 v115, v99, v115
  v_mfma_f32_16x16x32_bf16 v[136:139], v[48:51], a[72:75], v[136:139]
  v_rcp_f32 v97, v97
  v_mfma_f32_16x16x32_bf16 v[136:139], v[52:55], a[88:91], v[136:139]
  v_add_f32 v98, 1.0, v98
  v_mul_f32 v99, s77, v99
  v_mfma_f32_16x16x32_bf16 v[140:143], v[48:51], a[76:79], v[140:143]
  v_mul_f32 v113, v97, v113
  ds_read_b64_tr_b16 v[42:43], v24 offset:61696
  v_mfma_f32_16x16x32_bf16 v[140:143], v[52:55], a[92:95], v[140:143]
  v_rcp_f32 v98, v98
  v_exp_f32 v99, v99
  v_mul_f32 v84, v68, v84
  v_mfma_f32_16x16x32_bf16 v[144:147], v[56:59], a[64:67], v[144:147]
  s_barrier
  s_waitcnt lgkmcnt(4)
  v_mfma_f32_16x16x32_bf16 v[144:147], v[60:63], a[80:83], v[144:147]
  v_mul_f32 v114, v98, v114
  v_add_f32 v99, 1.0, v99
  v_mul_f32 v68, s77, v68
  v_mfma_f32_16x16x32_bf16 v[148:151], v[56:59], a[68:71], v[148:151]
  v_mul_f32 v85, v69, v85
  ds_read_b64_tr_b16 v[44:45], v24 offset:63488
  v_mfma_f32_16x16x32_bf16 v[148:151], v[60:63], a[84:87], v[148:151]
  v_rcp_f32 v99, v99
  v_exp_f32 v68, v68
  v_mfma_f32_16x16x32_bf16 v[152:155], v[56:59], a[72:75], v[152:155]
  ds_read_b64_tr_b16 v[46:47], v24 offset:63744
  v_mul_f32 v69, s77, v69
  v_mfma_f32_16x16x32_bf16 v[152:155], v[60:63], a[88:91], v[152:155]
  v_mul_f32 v115, v99, v115
  v_add_f32 v68, 1.0, v68
  v_mfma_f32_16x16x32_bf16 v[156:159], v[56:59], a[76:79], v[156:159]
  v_exp_f32 v69, v69
  v_mul_f32 v86, v70, v86
  v_mfma_f32_16x16x32_bf16 v[156:159], v[60:63], a[92:95], v[156:159]
  s_add_u32 m0, s74, 65536
  s_nop 0
  buffer_load_dwordx4 v17, s[44:47], s73 offen lds
  v_cvt_pk_bf16_f32 v64, v80, v81
  v_rcp_f32 v68, v68
  v_mfma_f32_16x16x32_bf16 v[128:131], v[32:35], a[96:99], v[128:131]
  ds_read_b64_tr_b16 v[48:49], v23 offset:0
  ds_read_b64_tr_b16 v[50:51], v23 offset:256
  v_cvt_pk_bf16_f32 v65, v82, v83
  v_add_f32 v69, 1.0, v69
  v_mul_f32 v70, s77, v70
  s_waitcnt lgkmcnt(4)
  v_mfma_f32_16x16x32_bf16 v[128:131], v[36:39], a[112:115], v[128:131]
  buffer_load_dwordx4 v18, s[44:47], s73 offen offset:1024 lds
  v_cvt_pk_bf16_f32 v66, v112, v113
  v_mul_f32 v84, v68, v84
  v_mfma_f32_16x16x32_bf16 v[132:135], v[32:35], a[100:103], v[132:135]
  v_cvt_pk_bf16_f32 v67, v114, v115
  v_rcp_f32 v69, v69
  v_exp_f32 v70, v70
  v_mul_f32 v87, v71, v87
  v_mfma_f32_16x16x32_bf16 v[132:135], v[36:39], a[116:119], v[132:135]
  ds_read_b64_tr_b16 v[52:53], v23 offset:2048
  v_add_u32 v28, 98304, v26
  v_mfma_f32_16x16x32_bf16 v[136:139], v[32:35], a[104:107], v[136:139]
  ds_read_b64_tr_b16 v[54:55], v23 offset:2304
  v_mul_f32 v85, v69, v85
  v_add_f32 v70, 1.0, v70
  v_mul_f32 v71, s77, v71
  v_mfma_f32_16x16x32_bf16 v[136:139], v[36:39], a[120:123], v[136:139]
  ds_write_b128 v28, v[64:67] offset:0
  v_mul_f32 v116, v100, v116
  v_mfma_f32_16x16x32_bf16 v[140:143], v[32:35], a[108:111], v[140:143]
  buffer_load_dwordx4 v19, s[44:47], s73 offen offset:2048 lds
  ds_read_b128 a[12:15], v29 offset:3072
  v_rcp_f32 v70, v70
  v_exp_f32 v71, v71
  v_mfma_f32_16x16x32_bf16 v[140:143], v[36:39], a[124:127], v[140:143]
  s_add_u32 s24, s24, 16384
  buffer_store_dwordx4 v[64:67], v26, s[48:51], s24 offen offset:0 sc1
  v_mul_f32 v100, s77, v100
  v_mfma_f32_16x16x32_bf16 v[144:147], v[40:43], a[96:99], v[144:147]
  ds_read_b64_tr_b16 v[56:57], v23 offset:4096
  ds_read_b64_tr_b16 v[58:59], v23 offset:4352
  v_mul_f32 v86, v70, v86
  v_add_f32 v71, 1.0, v71
  s_waitcnt lgkmcnt(6)
  v_mfma_f32_16x16x32_bf16 v[144:147], v[44:47], a[112:115], v[144:147]
  ds_read_b128 a[16:19], v29 offset:4096
  v_exp_f32 v100, v100
  v_mul_f32 v117, v101, v117
  v_mfma_f32_16x16x32_bf16 v[148:151], v[40:43], a[100:103], v[148:151]
  v_rcp_f32 v71, v71
  v_mfma_f32_16x16x32_bf16 v[148:151], v[44:47], a[116:119], v[148:151]
  buffer_load_dwordx4 v20, s[44:47], s73 offen offset:3072 lds
  v_add_f32 v100, 1.0, v100
  v_mul_f32 v101, s77, v101
  v_mfma_f32_16x16x32_bf16 v[152:155], v[40:43], a[104:107], v[152:155]
  ds_read_b64_tr_b16 v[60:61], v23 offset:6144
  ds_read_b64_tr_b16 v[62:63], v23 offset:6400
  ds_read_b128 a[20:23], v29 offset:5120
  v_mul_f32 v87, v71, v87
  v_mfma_f32_16x16x32_bf16 v[152:155], v[44:47], a[120:123], v[152:155]
  v_rcp_f32 v100, v100
  v_exp_f32 v101, v101
  v_mul_f32 v118, v102, v118
  v_mfma_f32_16x16x32_bf16 v[156:159], v[40:43], a[108:111], v[156:159]
  ds_read_b64_tr_b16 v[32:33], v23 offset:8192
  v_readlane_b32 s73, v31, 2
  v_mfma_f32_16x16x32_bf16 v[156:159], v[44:47], a[124:127], v[156:159]
  ds_read_b128 a[24:27], v29 offset:6144
  v_mul_f32 v116, v100, v116
  v_add_f32 v101, 1.0, v101
  v_mul_f32 v102, s77, v102
  v_mfma_f32_16x16x32_bf16 v[128:131], v[48:51], a[128:131], v[128:131]
  ds_read_b64_tr_b16 v[34:35], v23 offset:8448
  s_waitcnt lgkmcnt(7)
  v_mfma_f32_16x16x32_bf16 v[128:131], v[52:55], a[144:147], v[128:131]
  v_rcp_f32 v101, v101
  v_exp_f32 v102, v102
  v_mul_f32 v119, v103, v119
  v_mfma_f32_16x16x32_bf16 v[132:135], v[48:51], a[132:135], v[132:135]
  ds_read_b128 a[28:31], v29 offset:7168
  v_mfma_f32_16x16x32_bf16 v[132:135], v[52:55], a[148:151], v[132:135]
  v_mul_f32 v117, v101, v117
  v_add_f32 v102, 1.0, v102
  v_mul_f32 v103, s77, v103
  v_mfma_f32_16x16x32_bf16 v[136:139], v[48:51], a[136:139], v[136:139]
  ds_read_b64_tr_b16 v[36:37], v23 offset:10240
  ds_read_b64_tr_b16 v[38:39], v23 offset:10496
  v_mul_f32 v88, v72, v88
  v_mfma_f32_16x16x32_bf16 v[136:139], v[52:55], a[152:155], v[136:139]
  v_rcp_f32 v102, v102
  v_exp_f32 v103, v103
  v_mfma_f32_16x16x32_bf16 v[140:143], v[48:51], a[140:143], v[140:143]
  v_mul_f32 v72, s77, v72
  ds_read_b64_tr_b16 v[40:41], v23 offset:12288
  v_mfma_f32_16x16x32_bf16 v[140:143], v[52:55], a[156:159], v[140:143]
  v_mul_f32 v118, v102, v118
  v_add_f32 v103, 1.0, v103
  v_mfma_f32_16x16x32_bf16 v[144:147], v[56:59], a[128:131], v[144:147]
  s_waitcnt vmcnt(14) lgkmcnt(3)
  s_barrier
  ds_read_b64_tr_b16 v[42:43], v23 offset:12544
  v_exp_f32 v72, v72
  v_mul_f32 v89, v73, v89
  v_mfma_f32_16x16x32_bf16 v[144:147], v[60:63], a[144:147], v[144:147]
  v_rcp_f32 v103, v103
  v_mfma_f32_16x16x32_bf16 v[148:151], v[56:59], a[132:135], v[148:151]
  v_add_f32 v72, 1.0, v72
  v_mul_f32 v73, s77, v73
  v_mfma_f32_16x16x32_bf16 v[148:151], v[60:63], a[148:151], v[148:151]
  v_mul_f32 v119, v103, v119
  ds_read_b64_tr_b16 v[44:45], v23 offset:14336
  v_mfma_f32_16x16x32_bf16 v[152:155], v[56:59], a[136:139], v[152:155]
  ds_read_b64_tr_b16 v[46:47], v23 offset:14592
  v_rcp_f32 v72, v72
  v_exp_f32 v73, v73
  v_mul_f32 v90, v74, v90
  v_mfma_f32_16x16x32_bf16 v[152:155], v[60:63], a[152:155], v[152:155]
  v_add_u32 v29, 81920, v27
  ds_read_b128 a[32:35], v29 offset:0
  v_cvt_pk_bf16_f32 v68, v84, v85
  v_mfma_f32_16x16x32_bf16 v[156:159], v[56:59], a[140:143], v[156:159]
  v_cvt_pk_bf16_f32 v69, v86, v87
  v_mul_f32 v88, v72, v88
  v_add_f32 v73, 1.0, v73
  v_mul_f32 v74, s77, v74
  v_mfma_f32_16x16x32_bf16 v[156:159], v[60:63], a[156:159], v[156:159]
  s_add_u32 m0, s74, 32768
  s_nop 0
  buffer_load_dwordx4 v21, s[48:51], s25 offen offset:0 sc1 lds
  v_cvt_pk_bf16_f32 v70, v116, v117
  v_mul_f32 v91, v75, v91
  v_mfma_f32_16x16x32_bf16 v[128:131], v[32:35], a[160:163], v[128:131]
  ds_read_b64_tr_b16 v[48:49], v23 offset:16384
  ds_read_b64_tr_b16 v[50:51], v23 offset:16640
  buffer_load_dwordx4 v21, s[48:51], s25 offen offset:1024 sc1 lds
  ds_read_b128 a[36:39], v29 offset:1024
  v_cvt_pk_bf16_f32 v71, v118, v119
  v_rcp_f32 v73, v73
  v_exp_f32 v74, v74
  s_waitcnt lgkmcnt(6)
  v_mfma_f32_16x16x32_bf16 v[128:131], v[36:39], a[176:179], v[128:131]
  v_mul_f32 v75, s77, v75
  ds_read_b64_tr_b16 v[52:53], v23 offset:18432
  v_mfma_f32_16x16x32_bf16 v[132:135], v[32:35], a[164:167], v[132:135]
  v_mul_f32 v89, v73, v89
  v_add_f32 v74, 1.0, v74
  v_mfma_f32_16x16x32_bf16 v[132:135], v[36:39], a[180:183], v[132:135]
  ds_read_b128 a[40:43], v29 offset:2048
  ds_write_b128 v28, v[68:71] offset:1024
  v_exp_f32 v75, v75
  v_mul_f32 v120, v104, v120
  v_mfma_f32_16x16x32_bf16 v[136:139], v[32:35], a[168:171], v[136:139]
  ds_read_b64_tr_b16 v[54:55], v23 offset:18688
  buffer_load_dwordx4 v21, s[48:51], s25 offen offset:2048 sc1 lds
  v_rcp_f32 v74, v74
  v_mfma_f32_16x16x32_bf16 v[136:139], v[36:39], a[184:187], v[136:139]
  buffer_store_dwordx4 v[68:71], v26, s[48:51], s24 offen offset:1024 sc1
  v_add_f32 v75, 1.0, v75
  v_mul_f32 v104, s77, v104
  v_mfma_f32_16x16x32_bf16 v[140:143], v[32:35], a[172:175], v[140:143]
  ds_read_b128 a[44:47], v29 offset:3072
  v_mul_f32 v90, v74, v90
  v_mfma_f32_16x16x32_bf16 v[140:143], v[36:39], a[188:191], v[140:143]
  v_rcp_f32 v75, v75
  v_exp_f32 v104, v104
  v_mul_f32 v121, v105, v121
  v_mfma_f32_16x16x32_bf16 v[144:147], v[40:43], a[160:163], v[144:147]
  ds_read_b64_tr_b16 v[56:57], v23 offset:20480
  ds_read_b64_tr_b16 v[58:59], v23 offset:20736
  buffer_load_dwordx4 v21, s[48:51], s25 offen offset:3072 sc1 lds
  s_waitcnt lgkmcnt(8)
  v_mfma_f32_16x16x32_bf16 v[144:147], v[44:47], a[176:179], v[144:147]
  ds_read_b128 a[48:51], v29 offset:4096
  v_mul_f32 v91, v75, v91
  v_add_f32 v104, 1.0, v104
  v_mul_f32 v105, s77, v105
  v_mfma_f32_16x16x32_bf16 v[148:151], v[40:43], a[164:167], v[148:151]
  v_mul_f32 v122, v106, v122
  ds_read_b64_tr_b16 v[60:61], v23 offset:22528
  v_mfma_f32_16x16x32_bf16 v[148:151], v[44:47], a[180:183], v[148:151]
  v_rcp_f32 v104, v104
  v_exp_f32 v105, v105
  v_mfma_f32_16x16x32_bf16 v[152:155], v[40:43], a[168:171], v[152:155]
  ds_read_b64_tr_b16 v[62:63], v23 offset:22784
  s_add_u32 s25, s25, 16384
  s_add_u32 m0, s74, 114688
  s_nop 0
  buffer_load_dwordx4 v17, s[44:47], s73 offen lds
  ds_read_b128 a[52:55], v29 offset:5120
  v_mul_f32 v106, s77, v106
  v_mfma_f32_16x16x32_bf16 v[152:155], v[44:47], a[184:187], v[152:155]
  ds_read_b128 a[56:59], v29 offset:6144
  ds_read_b128 a[60:63], v29 offset:7168
  v_add_u32 v29, 49152, v27
  ds_read_b128 a[64:67], v29 offset:0
  v_mul_f32 v120, v104, v120
  v_add_f32 v105, 1.0, v105
  v_mfma_f32_16x16x32_bf16 v[156:159], v[40:43], a[172:175], v[156:159]
  v_exp_f32 v106, v106
  v_mul_f32 v123, v107, v123
  v_mfma_f32_16x16x32_bf16 v[156:159], v[44:47], a[188:191], v[156:159]
  v_rcp_f32 v105, v105
  v_mfma_f32_16x16x32_bf16 v[128:131], v[48:51], a[192:195], v[128:131]
  ds_read_b64_tr_b16 v[32:33], v23 offset:24576
  ds_read_b64_tr_b16 v[34:35], v23 offset:24832
  buffer_load_dwordx4 v18, s[44:47], s73 offen offset:1024 lds
  ds_read_b128 a[68:71], v29 offset:1024
  v_add_f32 v106, 1.0, v106
  v_mul_f32 v107, s77, v107
  s_waitcnt lgkmcnt(10)
  v_mfma_f32_16x16x32_bf16 v[128:131], v[52:55], a[208:211], v[128:131]
  v_mul_f32 v121, v105, v121
  ds_read_b64_tr_b16 v[36:37], v23 offset:26624
  v_mfma_f32_16x16x32_bf16 v[132:135], v[48:51], a[196:199], v[132:135]
  v_rcp_f32 v106, v106
  v_exp_f32 v107, v107
  v_mul_f32 v92, v76, v92
  v_mfma_f32_16x16x32_bf16 v[132:135], v[52:55], a[212:215], v[132:135]
  ds_read_b128 a[72:75], v29 offset:2048
  v_mfma_f32_16x16x32_bf16 v[136:139], v[48:51], a[200:203], v[136:139]
  ds_read_b64_tr_b16 v[38:39], v23 offset:26880
  v_mul_f32 v122, v106, v122
  v_add_f32 v107, 1.0, v107
  v_mul_f32 v76, s77, v76
  v_mfma_f32_16x16x32_bf16 v[136:139], v[52:55], a[216:219], v[136:139]
  buffer_load_dwordx4 v19, s[44:47], s73 offen offset:2048 lds
  v_mul_f32 v93, v77, v93
  v_mfma_f32_16x16x32_bf16 v[140:143], v[48:51], a[204:207], v[140:143]
  ds_read_b128 a[76:79], v29 offset:3072
  v_rcp_f32 v107, v107
  v_exp_f32 v76, v76
  v_mfma_f32_16x16x32_bf16 v[140:143], v[52:55], a[220:223], v[140:143]
  v_mul_f32 v77, s77, v77
  ds_read_b64_tr_b16 v[40:41], v23 offset:28672
  v_mfma_f32_16x16x32_bf16 v[144:147], v[56:59], a[192:195], v[144:147]
  s_waitcnt vmcnt(18) lgkmcnt(9)
  s_barrier
  ds_read_b64_tr_b16 v[42:43], v23 offset:28928
  v_mul_f32 v123, v107, v123
  v_add_f32 v76, 1.0, v76
  v_mfma_f32_16x16x32_bf16 v[144:147], v[60:63], a[208:211], v[144:147]
  ds_read_b128 a[80:83], v29 offset:4096
  v_exp_f32 v77, v77
  v_mul_f32 v94, v78, v94
  v_mfma_f32_16x16x32_bf16 v[148:151], v[56:59], a[196:199], v[148:151]
  buffer_load_dwordx4 v20, s[44:47], s73 offen offset:3072 lds
  v_cvt_pk_bf16_f32 v72, v88, v89
  v_rcp_f32 v76, v76
  v_mfma_f32_16x16x32_bf16 v[148:151], v[60:63], a[212:215], v[148:151]
  v_cvt_pk_bf16_f32 v73, v90, v91
  v_add_f32 v77, 1.0, v77
  v_mul_f32 v78, s77, v78
  v_mfma_f32_16x16x32_bf16 v[152:155], v[56:59], a[200:203], v[152:155]
  ds_read_b64_tr_b16 v[44:45], v23 offset:30720
  ds_read_b64_tr_b16 v[46:47], v23 offset:30976
  ds_read_b128 a[84:87], v29 offset:5120
  v_cvt_pk_bf16_f32 v74, v120, v121
  v_mul_f32 v92, v76, v92
  v_mfma_f32_16x16x32_bf16 v[152:155], v[60:63], a[216:219], v[152:155]
  v_cvt_pk_bf16_f32 v75, v122, v123
  v_rcp_f32 v77, v77
  v_exp_f32 v78, v78
  v_mul_f32 v95, v79, v95
  v_mfma_f32_16x16x32_bf16 v[156:159], v[56:59], a[204:207], v[156:159]
  ds_read_b64_tr_b16 v[48:49], v25 offset:0
  v_readlane_b32 s73, v31, 3
  v_mfma_f32_16x16x32_bf16 v[156:159], v[60:63], a[220:223], v[156:159]
  s_add_u32 m0, s74, 81920
  s_nop 0
  buffer_load_dwordx4 v21, s[48:51], s25 offen offset:0 sc1 lds
  ds_read_b128 a[88:91], v29 offset:6144
  v_mul_f32 v93, v77, v93
  v_add_f32 v78, 1.0, v78
  v_mul_f32 v79, s77, v79
  s_waitcnt lgkmcnt(6)
  v_mfma_f32_16x16x32_bf16 v[128:131], v[32:35], a[224:227], v[128:131]
  ds_read_b64_tr_b16 v[50:51], v25 offset:256
  ds_write_b128 v28, v[72:75] offset:2048
  v_mul_f32 v124, v108, v124
  v_mfma_f32_16x16x32_bf16 v[128:131], v[36:39], a[240:243], v[128:131]
  v_rcp_f32 v78, v78
  v_exp_f32 v79, v79
  v_mfma_f32_16x16x32_bf16 v[132:135], v[32:35], a[228:231], v[132:135]
  buffer_load_dwordx4 v21, s[48:51], s25 offen offset:1024 sc1 lds
  ds_read_b128 a[92:95], v29 offset:7168
  buffer_store_dwordx4 v[72:75], v26, s[48:51], s24 offen offset:2048 sc1
  v_mul_f32 v108, s77, v108
  v_mfma_f32_16x16x32_bf16 v[132:135], v[36:39], a[244:247], v[132:135]
  v_mul_f32 v94, v78, v94
  v_add_f32 v79, 1.0, v79
  v_mfma_f32_16x16x32_bf16 v[136:139], v[32:35], a[232:235], v[136:139]
  ds_read_b64_tr_b16 v[52:53], v25 offset:2048
  ds_read_b64_tr_b16 v[54:55], v25 offset:2304
  v_exp_f32 v108, v108
  v_mul_f32 v125, v109, v125
  v_mfma_f32_16x16x32_bf16 v[136:139], v[36:39], a[248:251], v[136:139]
  v_rcp_f32 v79, v79
  v_mfma_f32_16x16x32_bf16 v[140:143], v[32:35], a[236:239], v[140:143]
  buffer_load_dwordx4 v21, s[48:51], s25 offen offset:2048 sc1 lds
  v_add_f32 v108, 1.0, v108
  v_mul_f32 v109, s77, v109
  v_mfma_f32_16x16x32_bf16 v[140:143], v[36:39], a[252:255], v[140:143]
  v_mul_f32 v95, v79, v95
  ds_read_b64_tr_b16 v[56:57], v25 offset:4096
  v_mfma_f32_16x16x32_bf16 v[144:147], v[40:43], a[224:227], v[144:147]
  s_waitcnt vmcnt(18) lgkmcnt(3)
  s_barrier
  ds_read_b64_tr_b16 v[58:59], v25 offset:4352
  v_rcp_f32 v108, v108
  v_exp_f32 v109, v109
  v_mul_f32 v126, v110, v126
  v_mfma_f32_16x16x32_bf16 v[144:147], v[44:47], a[240:243], v[144:147]
  ds_read_b64_tr_b16 v[60:61], v25 offset:6144
  v_mul_f32 v124, v108, v124
  v_mfma_f32_16x16x32_bf16 v[148:151], v[40:43], a[228:231], v[148:151]
  buffer_load_dwordx4 v21, s[48:51], s25 offen offset:3072 sc1 lds
  v_add_f32 v109, 1.0, v109
  v_mul_f32 v110, s77, v110
  v_mfma_f32_16x16x32_bf16 v[148:151], v[44:47], a[244:247], v[148:151]
  ds_read_b64_tr_b16 v[62:63], v25 offset:6400
  s_add_u32 s25, s25, 16384
  v_mfma_f32_16x16x32_bf16 v[152:155], v[40:43], a[232:235], v[152:155]
  v_rcp_f32 v109, v109
  v_exp_f32 v110, v110
  v_mul_f32 v127, v111, v127
  v_mfma_f32_16x16x32_bf16 v[152:155], v[44:47], a[248:251], v[152:155]
  s_add_u32 m0, s74, 0
  s_nop 0
  buffer_load_dwordx4 v17, s[44:47], s73 offen lds
  v_mfma_f32_16x16x32_bf16 v[156:159], v[40:43], a[236:239], v[156:159]
  v_mul_f32 v125, v109, v125
  v_add_f32 v110, 1.0, v110
  v_mul_f32 v111, s77, v111
  v_mfma_f32_16x16x32_bf16 v[156:159], v[44:47], a[252:255], v[156:159]
  ds_read_b64_tr_b16 v[32:33], v5 offset:16384
  v_cvt_pk_bf16_f32 v76, v92, v93
  v_mfma_f32_16x16x32_bf16 v[128:131], v[48:51], v[192:195], v[128:131]
  ds_read_b64_tr_b16 v[34:35], v5 offset:18432
  v_rcp_f32 v110, v110
  v_exp_f32 v111, v111
  s_waitcnt lgkmcnt(4)
  v_mfma_f32_16x16x32_bf16 v[128:131], v[52:55], v[208:211], v[128:131]
  ds_read_b64_tr_b16 v[36:37], v5 offset:20480
  v_mul_f32 v126, v110, v126
  v_mfma_f32_16x16x32_bf16 v[132:135], v[48:51], v[196:199], v[132:135]
  buffer_load_dwordx4 v18, s[44:47], s73 offen offset:1024 lds
  v_add_f32 v111, 1.0, v111
  v_mfma_f32_16x16x32_bf16 v[132:135], v[52:55], v[212:215], v[132:135]
  ds_read_b64_tr_b16 v[38:39], v5 offset:22528
  v_cvt_pk_bf16_f32 v77, v94, v95
  v_mfma_f32_16x16x32_bf16 v[136:139], v[48:51], v[200:203], v[136:139]
  v_rcp_f32 v111, v111
  v_mfma_f32_16x16x32_bf16 v[136:139], v[52:55], v[216:219], v[136:139]
  ds_read_b64_tr_b16 v[40:41], v6 offset:16384
  v_mul_f32 v127, v111, v127
  v_mfma_f32_16x16x32_bf16 v[140:143], v[48:51], v[204:207], v[140:143]
  ds_read_b64_tr_b16 v[42:43], v6 offset:18432
  v_cvt_pk_bf16_f32 v78, v124, v125
  v_mfma_f32_16x16x32_bf16 v[140:143], v[52:55], v[220:223], v[140:143]
  buffer_load_dwordx4 v19, s[44:47], s73 offen offset:2048 lds
  v_mfma_f32_16x16x32_bf16 v[144:147], v[56:59], v[192:195], v[144:147]
  ds_read_b64_tr_b16 v[44:45], v6 offset:20480
  s_waitcnt lgkmcnt(3)
  v_mfma_f32_16x16x32_bf16 v[144:147], v[60:63], v[208:211], v[144:147]
  ds_read_b64_tr_b16 v[46:47], v6 offset:22528
  v_cvt_pk_bf16_f32 v79, v126, v127
  v_mfma_f32_16x16x32_bf16 v[148:151], v[56:59], v[196:199], v[148:151]
  ds_read_b64_tr_b16 v[48:49], v5 offset:24576
  v_mfma_f32_16x16x32_bf16 v[148:151], v[60:63], v[212:215], v[148:151]
  ds_read_b64_tr_b16 v[50:51], v5 offset:26624
  v_mfma_f32_16x16x32_bf16 v[152:155], v[56:59], v[200:203], v[152:155]
  buffer_load_dwordx4 v20, s[44:47], s73 offen offset:3072 lds
  v_mfma_f32_16x16x32_bf16 v[152:155], v[60:63], v[216:219], v[152:155]
  ds_read_b64_tr_b16 v[52:53], v5 offset:28672
  v_readlane_b32 s73, v31, 4
  v_mfma_f32_16x16x32_bf16 v[156:159], v[56:59], v[204:207], v[156:159]
  ds_write_b128 v28, v[76:79] offset:3072
  v_mfma_f32_16x16x32_bf16 v[156:159], v[60:63], v[220:223], v[156:159]
  ds_read_b64_tr_b16 v[54:55], v5 offset:30720
  s_add_u32 m0, s74, 49152
  v_mfma_f32_16x16x32_bf16 v[160:163], v[32:35], a[0:3], 0
  buffer_load_dwordx4 v17, s[44:47], s73 offen lds
  buffer_store_dwordx4 v[76:79], v26, s[48:51], s24 offen offset:3072 sc1
  v_mfma_f32_16x16x32_bf16 v[160:163], v[36:39], a[16:19], v[160:163]
  ds_read_b64_tr_b16 v[56:57], v6 offset:24576
  v_mfma_f32_16x16x32_bf16 v[164:167], v[32:35], a[4:7], 0
  ds_read_b64_tr_b16 v[58:59], v6 offset:26624
  v_mul_f32 v144, v128, v144
  v_mfma_f32_16x16x32_bf16 v[164:167], v[36:39], a[20:23], v[164:167]
  ds_read_b64_tr_b16 v[60:61], v6 offset:28672
  v_mul_f32 v128, s77, v128
  v_mfma_f32_16x16x32_bf16 v[168:171], v[32:35], a[8:11], 0
  buffer_load_dwordx4 v18, s[44:47], s73 offen offset:1024 lds
  v_mfma_f32_16x16x32_bf16 v[168:171], v[36:39], a[24:27], v[168:171]
  ds_read_b64_tr_b16 v[62:63], v6 offset:30720
  v_xor_b32 v25, s29, v5
  v_mfma_f32_16x16x32_bf16 v[172:175], v[32:35], a[12:15], 0
  s_waitcnt vmcnt(16) lgkmcnt(5)
  s_barrier
  v_mfma_f32_16x16x32_bf16 v[172:175], v[36:39], a[28:31], v[172:175]
  ds_read_b64_tr_b16 v[32:33], v3 offset:0
  v_xor_b32 v24, s29, v3
  v_mfma_f32_16x16x32_bf16 v[176:179], v[40:43], a[0:3], 0
  buffer_load_dwordx4 v19, s[44:47], s73 offen offset:2048 lds
  v_mfma_f32_16x16x32_bf16 v[176:179], v[44:47], a[16:19], v[176:179]
  ds_read_b64_tr_b16 v[34:35], v3 offset:2048
  v_xor_b32 v23, s29, v1
  v_mfma_f32_16x16x32_bf16 v[180:183], v[40:43], a[4:7], 0
  buffer_load_dwordx4 v20, s[44:47], s73 offen offset:3072 lds
  v_mfma_f32_16x16x32_bf16 v[180:183], v[44:47], a[20:23], v[180:183]
  ds_read_b64_tr_b16 v[36:37], v3 offset:4096
  v_mul_f32 v145, v129, v145
  v_mfma_f32_16x16x32_bf16 v[184:187], v[40:43], a[8:11], 0
  v_exp_f32 v128, v128
  v_mfma_f32_16x16x32_bf16 v[184:187], v[44:47], a[24:27], v[184:187]
  v_add_u32 v29, 32768, v27
  ds_read_b128 a[96:99], v29 offset:0
  ds_read_b128 a[100:103], v29 offset:1024
  ds_read_b128 a[104:107], v29 offset:2048
  ds_read_b128 a[108:111], v29 offset:3072
  ds_read_b128 a[112:115], v29 offset:4096
  ds_read_b128 a[116:119], v29 offset:5120
  ds_read_b128 a[120:123], v29 offset:6144
  ds_read_b128 a[124:127], v29 offset:7168
  v_add_u32 v29, 98304, v27
  ds_read_b128 a[128:131], v29 offset:0
  v_mfma_f32_16x16x32_bf16 v[188:191], v[40:43], a[12:15], 0
  ds_read_b64_tr_b16 v[38:39], v3 offset:6144
  v_readlane_b32 s73, v31, 5
  v_mfma_f32_16x16x32_bf16 v[188:191], v[44:47], a[28:31], v[188:191]
  ds_read_b64_tr_b16 v[40:41], v4 offset:0
  s_add_u32 m0, s74, 131072
  v_mfma_f32_16x16x32_bf16 v[160:163], v[48:51], a[32:35], v[160:163]
  ds_read_b128 a[132:135], v29 offset:1024
  s_waitcnt lgkmcnt(13)
  v_mfma_f32_16x16x32_bf16 v[160:163], v[52:55], a[48:51], v[160:163]
  ds_read_b64_tr_b16 v[42:43], v4 offset:2048
  v_add_f32 v128, 1.0, v128
  v_mfma_f32_16x16x32_bf16 v[164:167], v[48:51], a[36:39], v[164:167]
  buffer_load_dwordx4 v17, s[44:47], s73 offen lds
  v_mfma_f32_16x16x32_bf16 v[164:167], v[52:55], a[52:55], v[164:167]
  ds_read_b128 a[136:139], v29 offset:2048
  v_mfma_f32_16x16x32_bf16 v[168:171], v[48:51], a[40:43], v[168:171]
  v_rcp_f32 v128, v128
  v_mul_f32 v129, s77, v129
  v_mfma_f32_16x16x32_bf16 v[168:171], v[52:55], a[56:59], v[168:171]
  ds_read_b64_tr_b16 v[44:45], v4 offset:4096
  v_mul_f32 v144, v128, v144
  v_mfma_f32_16x16x32_bf16 v[172:175], v[48:51], a[44:47], v[172:175]
  ds_read_b128 a[140:143], v29 offset:3072
  v_exp_f32 v129, v129
  v_mfma_f32_16x16x32_bf16 v[172:175], v[52:55], a[60:63], v[172:175]
  ds_read_b64_tr_b16 v[46:47], v4 offset:6144
  v_add_f32 v129, 1.0, v129
  v_mfma_f32_16x16x32_bf16 v[176:179], v[56:59], a[32:35], v[176:179]
  buffer_load_dwordx4 v18, s[44:47], s73 offen offset:1024 lds
  v_mfma_f32_16x16x32_bf16 v[176:179], v[60:63], a[48:51], v[176:179]
  ds_read_b128 a[144:147], v29 offset:4096
  v_mul_f32 v146, v130, v146
  v_mfma_f32_16x16x32_bf16 v[180:183], v[56:59], a[36:39], v[180:183]
  v_rcp_f32 v129, v129
  v_mfma_f32_16x16x32_bf16 v[180:183], v[60:63], a[52:55], v[180:183]
  v_mul_f32 v130, s77, v130
  ds_read_b64_tr_b16 v[48:49], v3 offset:8192
  v_mfma_f32_16x16x32_bf16 v[184:187], v[56:59], a[40:43], v[184:187]
  ds_read_b128 a[148:151], v29 offset:5120
  v_mul_f32 v145, v129, v145
  v_mfma_f32_16x16x32_bf16 v[184:187], v[60:63], a[56:59], v[184:187]
  buffer_load_dwordx4 v19, s[44:47], s73 offen offset:2048 lds
  v_exp_f32 v130, v130
  v_mfma_f32_16x16x32_bf16 v[188:191], v[56:59], a[44:47], v[188:191]
  ds_read_b64_tr_b16 v[50:51], v3 offset:10240
  v_add_f32 v130, 1.0, v130
  v_mfma_f32_16x16x32_bf16 v[188:191], v[60:63], a[60:63], v[188:191]
  ds_read_b128 a[152:155], v29 offset:6144
  v_mul_f32 v147, v131, v147
  v_mfma_f32_16x16x32_bf16 v[160:163], v[32:35], a[64:67], v[160:163]
  ds_read_b64_tr_b16 v[52:53], v3 offset:12288
  s_waitcnt lgkmcnt(6)
  v_mfma_f32_16x16x32_bf16 v[160:163], v[36:39], a[80:83], v[160:163]
  v_rcp_f32 v130, v130
  v_mul_f32 v131, s77, v131
  v_mfma_f32_16x16x32_bf16 v[164:167], v[32:35], a[68:71], v[164:167]
  buffer_load_dwordx4 v20, s[44:47], s73 offen offset:3072 lds
  ds_read_b128 a[156:159], v29 offset:7168
  v_mfma_f32_16x16x32_bf16 v[164:167], v[36:39], a[84:87], v[164:167]
  v_mul_f32 v146, v130, v146
  v_exp_f32 v131, v131
  v_mfma_f32_16x16x32_bf16 v[168:171], v[32:35], a[72:75], v[168:171]
k1_pg7:
  s_cbranch_execz k1_wback
  ds_read_b64_tr_b16 v[54:55], v3 offset:14336
  v_readlane_b32 s73, v31, 6
  v_mfma_f32_16x16x32_bf16 v[168:171], v[36:39], a[88:91], v[168:171]
  v_add_f32 v131, 1.0, v131
  v_mul_f32 v148, v132, v148
  v_mfma_f32_16x16x32_bf16 v[172:175], v[32:35], a[76:79], v[172:175]
  s_waitcnt vmcnt(13) lgkmcnt(1)
  s_barrier
  v_mfma_f32_16x16x32_bf16 v[172:175], v[36:39], a[92:95], v[172:175]
  v_rcp_f32 v131, v131
  v_mul_f32 v132, s77, v132
  v_mfma_f32_16x16x32_bf16 v[176:179], v[40:43], a[64:67], v[176:179]
  ds_read_b64_tr_b16 v[56:57], v4 offset:8192
  ds_read_b64_tr_b16 v[58:59], v4 offset:10240
  v_mfma_f32_16x16x32_bf16 v[176:179], v[44:47], a[80:83], v[176:179]
  v_mul_f32 v147, v131, v147
  v_exp_f32 v132, v132
  v_mfma_f32_16x16x32_bf16 v[180:183], v[40:43], a[68:71], v[180:183]
  ds_read_b64_tr_b16 v[60:61], v4 offset:12288
  s_add_u32 m0, s74, 147456
  v_mfma_f32_16x16x32_bf16 v[180:183], v[44:47], a[84:87], v[180:183]
  v_cvt_pk_bf16_f32 v128, v144, v145
  v_add_f32 v132, 1.0, v132
  v_mfma_f32_16x16x32_bf16 v[184:187], v[40:43], a[72:75], v[184:187]
  ds_read_b64_tr_b16 v[62:63], v4 offset:14336
  v_cvt_pk_bf16_f32 v129, v146, v147
  v_mul_f32 v149, v133, v149
  v_mfma_f32_16x16x32_bf16 v[184:187], v[44:47], a[88:91], v[184:187]
  v_add_u32 v29, 81920, v27
  ds_read_b128 v[192:195], v29 offset:0
  v_rcp_f32 v132, v132
  v_mfma_f32_16x16x32_bf16 v[188:191], v[40:43], a[76:79], v[188:191]
  v_mul_f32 v133, s77, v133
  ds_read_b64_tr_b16 v[32:33], v3 offset:49152
  v_mfma_f32_16x16x32_bf16 v[188:191], v[44:47], a[92:95], v[188:191]
  buffer_load_dwordx4 v17, s[44:47], s73 offen lds
  v_add_u32 v30, 16384, v27
  v_mul_f32 v148, v132, v148
  v_mfma_f32_16x16x32_bf16 v[224:227], v[48:51], a[0:3], 0
  ds_read_b64_tr_b16 v[34:35], v3 offset:51200
  ds_read_b128 v[196:199], v29 offset:1024
  v_add_u32 v30, s87, v30
  v_exp_f32 v133, v133
  s_waitcnt lgkmcnt(6)
  v_mfma_f32_16x16x32_bf16 v[224:227], v[52:55], a[16:19], v[224:227]
  buffer_load_dwordx4 v18, s[44:47], s73 offen offset:1024 lds
  ds_write_b64 v30, v[128:129] offset:0
  v_mfma_f32_16x16x32_bf16 v[228:231], v[48:51], a[4:7], 0
  v_add_f32 v133, 1.0, v133
  v_mul_f32 v150, v134, v150
  v_mfma_f32_16x16x32_bf16 v[228:231], v[52:55], a[20:23], v[228:231]
  ds_read_b128 v[200:203], v29 offset:2048
  v_mfma_f32_16x16x32_bf16 v[232:235], v[48:51], a[8:11], 0
  ds_read_b64_tr_b16 v[36:37], v3 offset:53248
  ds_read_b64_tr_b16 v[38:39], v3 offset:55296
  v_rcp_f32 v133, v133
  v_mul_f32 v134, s77, v134
  v_mfma_f32_16x16x32_bf16 v[232:235], v[52:55], a[24:27], v[232:235]
  ds_read_b64_tr_b16 v[40:41], v4 offset:49152
  v_mul_f32 v149, v133, v149
  v_mfma_f32_16x16x32_bf16 v[236:239], v[48:51], a[12:15], 0
  buffer_load_dwordx4 v19, s[44:47], s73 offen offset:2048 lds
  ds_read_b128 v[204:207], v29 offset:3072
  v_exp_f32 v134, v134
  v_mfma_f32_16x16x32_bf16 v[236:239], v[52:55], a[28:31], v[236:239]
  ds_read_b64_tr_b16 v[42:43], v4 offset:51200
  v_add_f32 v134, 1.0, v134
  v_mfma_f32_16x16x32_bf16 v[240:243], v[56:59], a[0:3], 0
  ds_read_b64_tr_b16 v[44:45], v4 offset:53248
  s_waitcnt lgkmcnt(4)
  v_mfma_f32_16x16x32_bf16 v[240:243], v[60:63], a[16:19], v[240:243]
  ds_read_b128 v[208:211], v29 offset:4096
  v_mul_f32 v151, v135, v151
  v_mfma_f32_16x16x32_bf16 v[244:247], v[56:59], a[4:7], 0
  v_rcp_f32 v134, v134
  v_mfma_f32_16x16x32_bf16 v[244:247], v[60:63], a[20:23], v[244:247]
  buffer_load_dwordx4 v20, s[44:47], s73 offen offset:3072 lds
  v_mul_f32 v135, s77, v135
  v_mfma_f32_16x16x32_bf16 v[248:251], v[56:59], a[8:11], 0
  ds_read_b64_tr_b16 v[46:47], v4 offset:55296
  ds_read_b128 v[212:215], v29 offset:5120
  v_mul_f32 v150, v134, v150
  v_mfma_f32_16x16x32_bf16 v[248:251], v[60:63], a[24:27], v[248:251]
  v_exp_f32 v135, v135
  v_mfma_f32_16x16x32_bf16 v[252:255], v[56:59], a[12:15], 0
  ds_read_b64_tr_b16 v[48:49], v3 offset:57344
  v_readlane_b32 s73, v31, 7
  v_mfma_f32_16x16x32_bf16 v[252:255], v[60:63], a[28:31], v[252:255]
  s_add_u32 m0, s74, 98304
  s_nop 2
  buffer_load_dwordx4 v17, s[44:47], s73 offen lds
  ds_read_b128 v[216:219], v29 offset:6144
  v_add_f32 v135, 1.0, v135
  v_mul_f32 v152, v136, v152
  v_mfma_f32_16x16x32_bf16 v[224:227], v[32:35], a[32:35], v[224:227]
  ds_read_b64_tr_b16 v[50:51], v3 offset:59392
  v_mov_b32 v14, 4
  v_mfma_f32_16x16x32_bf16 v[224:227], v[36:39], a[48:51], v[224:227]
  v_rcp_f32 v135, v135
  v_mul_f32 v136, s77, v136
  v_mfma_f32_16x16x32_bf16 v[228:231], v[32:35], a[36:39], v[228:231]
  ds_read_b128 v[220:223], v29 offset:7168
  v_mfma_f32_16x16x32_bf16 v[228:231], v[36:39], a[52:55], v[228:231]
  v_mul_f32 v151, v135, v151
  v_exp_f32 v136, v136
  v_mfma_f32_16x16x32_bf16 v[232:235], v[32:35], a[40:43], v[232:235]
  ds_read_b64_tr_b16 v[52:53], v3 offset:61440
  ds_read_b64_tr_b16 v[54:55], v3 offset:63488
  buffer_load_dwordx4 v18, s[44:47], s73 offen offset:1024 lds
  v_mfma_f32_16x16x32_bf16 v[232:235], v[36:39], a[56:59], v[232:235]
  v_cvt_pk_bf16_f32 v132, v148, v149
  v_add_f32 v136, 1.0, v136
  v_mul_f32 v153, v137, v153
  v_mfma_f32_16x16x32_bf16 v[236:239], v[32:35], a[44:47], v[236:239]
  v_cvt_pk_bf16_f32 v133, v150, v151
  ds_read_b64_tr_b16 v[56:57], v4 offset:57344
  v_mfma_f32_16x16x32_bf16 v[236:239], v[36:39], a[60:63], v[236:239]
  v_rcp_f32 v136, v136
  v_mul_f32 v137, s77, v137
  s_waitcnt lgkmcnt(4)
  v_mfma_f32_16x16x32_bf16 v[240:243], v[40:43], a[32:35], v[240:243]
  s_waitcnt vmcnt(13) lgkmcnt(3)
  s_barrier
  ds_read_b64_tr_b16 v[58:59], v4 offset:59392
  v_mfma_f32_16x16x32_bf16 v[240:243], v[44:47], a[48:51], v[240:243]
  buffer_load_dwordx4 v19, s[44:47], s73 offen offset:2048 lds
  v_mul_f32 v152, v136, v152
  v_exp_f32 v137, v137
  v_mfma_f32_16x16x32_bf16 v[244:247], v[40:43], a[36:39], v[244:247]
  ds_read_b64_tr_b16 v[60:61], v4 offset:61440
  v_add_f32 v137, 1.0, v137
  v_mfma_f32_16x16x32_bf16 v[244:247], v[44:47], a[52:55], v[244:247]
  buffer_store_dword v14, off, s[48:51], s26 sc1
  ds_write_b64 v30, v[132:133] offset:1024
  v_mfma_f32_16x16x32_bf16 v[248:251], v[40:43], a[40:43], v[248:251]
  ds_read_b64_tr_b16 v[62:63], v4 offset:63488
  v_mul_f32 v154, v138, v154
  v_mfma_f32_16x16x32_bf16 v[248:251], v[44:47], a[56:59], v[248:251]
  v_rcp_f32 v137, v137
  v_mfma_f32_16x16x32_bf16 v[252:255], v[40:43], a[44:47], v[252:255]
  buffer_load_dwordx4 v20, s[44:47], s73 offen offset:3072 lds
  v_mul_f32 v138, s77, v138
  v_mfma_f32_16x16x32_bf16 v[252:255], v[44:47], a[60:63], v[252:255]
  v_mul_f32 v153, v137, v153
  ds_read_b64_tr_b16 v[32:33], v1 offset:0
  v_mfma_f32_16x16x32_bf16 v[224:227], v[48:51], a[64:67], v[224:227]
  ds_read_b64_tr_b16 v[34:35], v1 offset:2048
  v_exp_f32 v138, v138
  s_waitcnt lgkmcnt(5)
  v_mfma_f32_16x16x32_bf16 v[224:227], v[52:55], a[80:83], v[224:227]
  ds_read_b64_tr_b16 v[36:37], v1 offset:4096
  v_readlane_b32 s73, v31, 8
  v_mfma_f32_16x16x32_bf16 v[228:231], v[48:51], a[68:71], v[228:231]
  s_add_u32 m0, s74, 32768
  s_nop 2
  buffer_load_dwordx4 v17, s[44:47], s73 offen lds
  v_add_f32 v138, 1.0, v138
  v_mul_f32 v155, v139, v155
  v_mfma_f32_16x16x32_bf16 v[228:231], v[52:55], a[84:87], v[228:231]
  ds_read_b64_tr_b16 v[38:39], v1 offset:6144
  v_mul_f32 v139, s77, v139
  v_mfma_f32_16x16x32_bf16 v[232:235], v[48:51], a[72:75], v[232:235]
  v_rcp_f32 v138, v138
  v_mfma_f32_16x16x32_bf16 v[232:235], v[52:55], a[88:91], v[232:235]
  ds_read_b64_tr_b16 v[40:41], v2 offset:0
  v_mul_f32 v154, v138, v154
  v_mfma_f32_16x16x32_bf16 v[236:239], v[48:51], a[76:79], v[236:239]
  v_exp_f32 v139, v139
  v_mfma_f32_16x16x32_bf16 v[236:239], v[52:55], a[92:95], v[236:239]
  buffer_load_dwordx4 v18, s[44:47], s73 offen offset:1024 lds
  v_mfma_f32_16x16x32_bf16 v[240:243], v[56:59], a[64:67], v[240:243]
  ds_read_b64_tr_b16 v[42:43], v2 offset:2048
  v_add_f32 v139, 1.0, v139
  v_mul_f32 v156, v140, v156
  s_waitcnt lgkmcnt(4)
  v_mfma_f32_16x16x32_bf16 v[240:243], v[60:63], a[80:83], v[240:243]
  ds_read_b64_tr_b16 v[44:45], v2 offset:4096
  v_mul_f32 v140, s77, v140
  v_mfma_f32_16x16x32_bf16 v[244:247], v[56:59], a[68:71], v[244:247]
  v_rcp_f32 v139, v139
  v_mfma_f32_16x16x32_bf16 v[244:247], v[60:63], a[84:87], v[244:247]
  ds_read_b64_tr_b16 v[46:47], v2 offset:6144
  v_mul_f32 v155, v139, v155
  v_mfma_f32_16x16x32_bf16 v[248:251], v[56:59], a[72:75], v[248:251]
  buffer_load_dwordx4 v19, s[44:47], s73 offen offset:2048 lds
  v_exp_f32 v140, v140
  v_mfma_f32_16x16x32_bf16 v[248:251], v[60:63], a[88:91], v[248:251]
  ds_read_b64_tr_b16 v[48:49], v1 offset:8192
  v_cvt_pk_bf16_f32 v136, v152, v153
  v_mfma_f32_16x16x32_bf16 v[252:255], v[56:59], a[76:79], v[252:255]
  v_add_f32 v140, 1.0, v140
  ds_read_b64_tr_b16 v[50:51], v1 offset:10240
  v_mfma_f32_16x16x32_bf16 v[252:255], v[60:63], a[92:95], v[252:255]
  v_cvt_pk_bf16_f32 v137, v154, v155
  v_mul_f32 v157, v141, v157
  v_mfma_f32_16x16x32_bf16 v[160:163], v[32:35], a[96:99], v[160:163]
  v_rcp_f32 v140, v140
  s_waitcnt lgkmcnt(4)
  v_mfma_f32_16x16x32_bf16 v[160:163], v[36:39], a[112:115], v[160:163]
  buffer_load_dwordx4 v20, s[44:47], s73 offen offset:3072 lds
  v_mul_f32 v141, s77, v141
  v_mfma_f32_16x16x32_bf16 v[164:167], v[32:35], a[100:103], v[164:167]
  v_mul_f32 v156, v140, v156
  ds_read_b64_tr_b16 v[52:53], v1 offset:12288
  v_mfma_f32_16x16x32_bf16 v[164:167], v[36:39], a[116:119], v[164:167]
  v_exp_f32 v141, v141
  v_mfma_f32_16x16x32_bf16 v[168:171], v[32:35], a[104:107], v[168:171]
  ds_read_b64_tr_b16 v[54:55], v1 offset:14336
  ds_write_b64 v30, v[136:137] offset:2048
  v_mfma_f32_16x16x32_bf16 v[168:171], v[36:39], a[120:123], v[168:171]
  v_add_f32 v141, 1.0, v141
  v_mul_f32 v158, v142, v158
  v_mfma_f32_16x16x32_bf16 v[172:175], v[32:35], a[108:111], v[172:175]
  v_readlane_b32 s73, v31, 9
  s_add_u32 m0, s74, 65536
  s_nop 3
  buffer_load_dwordx4 v17, s[44:47], s73 offen lds
  v_mfma_f32_16x16x32_bf16 v[172:175], v[36:39], a[124:127], v[172:175]
  v_rcp_f32 v141, v141
  v_mul_f32 v142, s77, v142
  v_mfma_f32_16x16x32_bf16 v[176:179], v[40:43], a[96:99], v[176:179]
  s_waitcnt vmcnt(18)
  s_barrier
  ds_read_b64_tr_b16 v[56:57], v2 offset:8192
  ds_read_b64_tr_b16 v[58:59], v2 offset:10240
  s_waitcnt lgkmcnt(5)
  v_mfma_f32_16x16x32_bf16 v[176:179], v[44:47], a[112:115], v[176:179]
  v_mul_f32 v157, v141, v157
  v_exp_f32 v142, v142
  v_mfma_f32_16x16x32_bf16 v[180:183], v[40:43], a[100:103], v[180:183]
  buffer_load_dwordx4 v18, s[44:47], s73 offen offset:1024 lds
  v_mfma_f32_16x16x32_bf16 v[180:183], v[44:47], a[116:119], v[180:183]
  v_add_f32 v142, 1.0, v142
  ds_read_b64_tr_b16 v[60:61], v2 offset:12288
  v_mfma_f32_16x16x32_bf16 v[184:187], v[40:43], a[104:107], v[184:187]
  ds_read_b64_tr_b16 v[62:63], v2 offset:14336
  v_mul_f32 v159, v143, v159
  v_mfma_f32_16x16x32_bf16 v[184:187], v[44:47], a[120:123], v[184:187]
  v_rcp_f32 v142, v142
  v_mfma_f32_16x16x32_bf16 v[188:191], v[40:43], a[108:111], v[188:191]
  v_mul_f32 v143, s77, v143
  ds_read_b64_tr_b16 v[32:33], v1 offset:49152
  v_mfma_f32_16x16x32_bf16 v[188:191], v[44:47], a[124:127], v[188:191]
  buffer_load_dwordx4 v19, s[44:47], s73 offen offset:2048 lds
  v_mul_f32 v158, v142, v158
  v_mfma_f32_16x16x32_bf16 v[160:163], v[48:51], v[192:195], v[160:163]
  ds_read_b64_tr_b16 v[34:35], v1 offset:51200
  v_exp_f32 v143, v143
  s_waitcnt lgkmcnt(4)
  v_mfma_f32_16x16x32_bf16 v[160:163], v[52:55], v[208:211], v[160:163]
  ds_read_b64_tr_b16 v[36:37], v1 offset:53248
  v_add_f32 v143, 1.0, v143
  v_mfma_f32_16x16x32_bf16 v[164:167], v[48:51], v[196:199], v[164:167]
  ds_read_b64_tr_b16 v[38:39], v1 offset:55296
  v_bfe_u32 v7, v21, 4, 4
  v_mfma_f32_16x16x32_bf16 v[164:167], v[52:55], v[212:215], v[164:167]
  ds_read_b64_tr_b16 v[40:41], v2 offset:49152
  v_lshrrev_b32 v8, 8, v21
  v_mfma_f32_16x16x32_bf16 v[168:171], v[48:51], v[200:203], v[168:171]
  buffer_load_dwordx4 v20, s[44:47], s73 offen offset:3072 lds
  v_rcp_f32 v143, v143
  v_mfma_f32_16x16x32_bf16 v[168:171], v[52:55], v[216:219], v[168:171]
  ds_read_b64_tr_b16 v[42:43], v2 offset:51200
  v_readlane_b32 s73, v31, 10
  v_mfma_f32_16x16x32_bf16 v[172:175], v[48:51], v[204:207], v[172:175]
  v_mul_f32 v159, v143, v159
  ds_read_b64_tr_b16 v[44:45], v2 offset:53248
  v_mfma_f32_16x16x32_bf16 v[172:175], v[52:55], v[220:223], v[172:175]
  ds_read_b64_tr_b16 v[46:47], v2 offset:55296
  s_add_u32 m0, s74, 81920
  v_mfma_f32_16x16x32_bf16 v[176:179], v[56:59], v[192:195], v[176:179]
  buffer_load_dwordx4 v17, s[44:47], s73 offen lds
  v_cvt_pk_bf16_f32 v140, v156, v157
  s_waitcnt lgkmcnt(4)
  v_mfma_f32_16x16x32_bf16 v[176:179], v[60:63], v[208:211], v[176:179]
  v_cvt_pk_bf16_f32 v141, v158, v159
  ds_read_b64_tr_b16 v[48:49], v1 offset:57344
  v_mfma_f32_16x16x32_bf16 v[180:183], v[56:59], v[196:199], v[180:183]
  ds_read_b64_tr_b16 v[50:51], v1 offset:59392
  v_lshlrev_b32 v8, 2, v8
  v_mfma_f32_16x16x32_bf16 v[180:183], v[60:63], v[212:215], v[180:183]
  ds_read_b64_tr_b16 v[52:53], v1 offset:61440
  v_lshl_add_u32 v9, s64, 4, v7
  v_mfma_f32_16x16x32_bf16 v[184:187], v[56:59], v[200:203], v[184:187]
  buffer_load_dwordx4 v18, s[44:47], s73 offen offset:1024 lds
  v_mfma_f32_16x16x32_bf16 v[184:187], v[60:63], v[216:219], v[184:187]
  ds_read_b64_tr_b16 v[54:55], v1 offset:63488
  v_and_b32 v10, 1, v7
  v_mfma_f32_16x16x32_bf16 v[188:191], v[56:59], v[204:207], v[188:191]
  ds_write_b64 v30, v[140:141] offset:3072
  v_mfma_f32_16x16x32_bf16 v[188:191], v[60:63], v[220:223], v[188:191]
  ds_read_b64_tr_b16 v[56:57], v2 offset:57344
  v_cmp_eq_u32 s[22:23], 1, v10
  v_mfma_f32_16x16x32_bf16 v[224:227], v[32:35], a[96:99], v[224:227]
  buffer_load_dwordx4 v19, s[44:47], s73 offen offset:2048 lds
  v_mfma_f32_16x16x32_bf16 v[224:227], v[36:39], a[112:115], v[224:227]
  ds_read_b64_tr_b16 v[58:59], v2 offset:59392
  v_mul_u32_u24 v10, 0x10001, v10
  v_mfma_f32_16x16x32_bf16 v[228:231], v[32:35], a[100:103], v[228:231]
  buffer_load_dwordx4 v20, s[44:47], s73 offen offset:3072 lds
  v_mfma_f32_16x16x32_bf16 v[228:231], v[36:39], a[116:119], v[228:231]
  ds_read_b64_tr_b16 v[60:61], v2 offset:61440
  v_lshlrev_b32 v10, 15, v10
  v_mfma_f32_16x16x32_bf16 v[232:235], v[32:35], a[104:107], v[232:235]
  buffer_load_dword v15, off, s[48:51], s27 sc1
  v_mfma_f32_16x16x32_bf16 v[232:235], v[36:39], a[120:123], v[232:235]
  ds_read_b64_tr_b16 v[62:63], v2 offset:63488
  v_bfe_u32 v11, v7, 1, 1
  v_mfma_f32_16x16x32_bf16 v[236:239], v[32:35], a[108:111], v[236:239]
  s_waitcnt vmcnt(22) lgkmcnt(4)
  s_barrier
  v_mfma_f32_16x16x32_bf16 v[236:239], v[36:39], a[124:127], v[236:239]
  ds_read_b64_tr_b16 v[32:33], v5 offset:0
  v_readlane_b32 s73, v31, 11
  v_mfma_f32_16x16x32_bf16 v[240:243], v[40:43], a[96:99], v[240:243]
  s_add_u32 m0, s74, 114688
  v_add_u32 v29, 16384, v27
  v_mfma_f32_16x16x32_bf16 v[240:243], v[44:47], a[112:115], v[240:243]
  ds_read_b64_tr_b16 v[34:35], v5 offset:2048
  v_mul_u32_u24 v11, 0x10001, v11
  v_mfma_f32_16x16x32_bf16 v[244:247], v[40:43], a[100:103], v[244:247]
  buffer_load_dwordx4 v17, s[44:47], s73 offen lds
  v_mfma_f32_16x16x32_bf16 v[244:247], v[44:47], a[116:119], v[244:247]
  ds_read_b128 a[160:163], v29 offset:0
  v_mfma_f32_16x16x32_bf16 v[248:251], v[40:43], a[104:107], v[248:251]
  ds_read_b64_tr_b16 v[36:37], v5 offset:4096
  v_lshlrev_b32 v11, 15, v11
  v_mfma_f32_16x16x32_bf16 v[248:251], v[44:47], a[120:123], v[248:251]
  ds_read_b64_tr_b16 v[38:39], v5 offset:6144
  v_xor_b32 v12, v11, v10
  v_mfma_f32_16x16x32_bf16 v[252:255], v[40:43], a[108:111], v[252:255]
  ds_read_b128 a[164:167], v29 offset:1024
  v_mfma_f32_16x16x32_bf16 v[252:255], v[44:47], a[124:127], v[252:255]
  ds_read_b64_tr_b16 v[40:41], v6 offset:0
  v_cvt_f32_u32 v148, v9
  v_mfma_f32_16x16x32_bf16 v[224:227], v[48:51], v[192:195], v[224:227]
  buffer_load_dwordx4 v18, s[44:47], s73 offen offset:1024 lds
  v_mfma_f32_16x16x32_bf16 v[224:227], v[52:55], v[208:211], v[224:227]
  ds_read_b128 a[168:171], v29 offset:2048
  v_mfma_f32_16x16x32_bf16 v[228:231], v[48:51], v[196:199], v[228:231]
  ds_read_b64_tr_b16 v[42:43], v6 offset:2048
  v_cvt_f32_u32 v144, v8
  v_mfma_f32_16x16x32_bf16 v[228:231], v[52:55], v[212:215], v[228:231]
  ds_read_b64_tr_b16 v[44:45], v6 offset:4096
  v_mul_f32 v148, 0x3a000000, v148
  v_mfma_f32_16x16x32_bf16 v[232:235], v[48:51], v[200:203], v[232:235]
  ds_read_b128 a[172:175], v29 offset:3072
  v_mfma_f32_16x16x32_bf16 v[232:235], v[52:55], v[216:219], v[232:235]
  buffer_load_dwordx4 v19, s[44:47], s73 offen offset:2048 lds
  v_mfma_f32_16x16x32_bf16 v[236:239], v[48:51], v[204:207], v[236:239]
  ds_read_b64_tr_b16 v[46:47], v6 offset:6144
  v_mul_f32 v144, v144, v148
  v_mfma_f32_16x16x32_bf16 v[236:239], v[52:55], v[220:223], v[236:239]
  ds_read_b64_tr_b16 v[48:49], v5 offset:8192
  s_waitcnt lgkmcnt(8)
  v_mfma_f32_16x16x32_bf16 v[240:243], v[56:59], v[192:195], v[240:243]
  buffer_load_dwordx4 v20, s[44:47], s73 offen offset:3072 lds
  v_mfma_f32_16x16x32_bf16 v[240:243], v[60:63], v[208:211], v[240:243]
  s_add_u32 s24, s24, 16384
  s_cmp_eq_u32 s66, 0
  s_cselect_b32 s84, s24, 2147418112
  s_cselect_b32 s85, 2147418112, s24
  v_mfma_f32_16x16x32_bf16 v[244:247], v[56:59], v[196:199], v[244:247]
  ds_read_b64_tr_b16 v[50:51], v5 offset:10240
  v_readlane_b32 s73, v31, 12
  v_mfma_f32_16x16x32_bf16 v[244:247], v[60:63], v[212:215], v[244:247]
  ds_read_b64_tr_b16 v[52:53], v5 offset:12288
  s_add_u32 m0, s74, 0
  v_mfma_f32_16x16x32_bf16 v[248:251], v[56:59], v[200:203], v[248:251]
  s_waitcnt lgkmcnt(4)
  buffer_store_dwordx4 a[160:163], v27, s[48:51], s84 offen offset:0 sc1
  v_mfma_f32_16x16x32_bf16 v[248:251], v[60:63], v[216:219], v[248:251]
  ds_read_b64_tr_b16 v[54:55], v5 offset:14336
  v_add_f32 v145, v144, v148
  v_mfma_f32_16x16x32_bf16 v[252:255], v[56:59], v[204:207], v[252:255]
  buffer_load_dwordx4 v17, s[44:47], s73 offen lds
  buffer_store_dwordx4 a[168:171], v27, s[48:51], s85 offen offset:2048 sc1
  v_mfma_f32_16x16x32_bf16 v[252:255], v[60:63], v[220:223], v[252:255]
  ds_read_b64_tr_b16 v[56:57], v6 offset:8192
  v_fma_f32 v146, 2.0, v148, v144
  v_mfma_f32_16x16x32_bf16 v[64:67], v[32:35], a[0:3], 0
  buffer_store_dwordx4 a[164:167], v27, s[48:51], s84 offen offset:1024 sc1
  v_mfma_f32_16x16x32_bf16 v[64:67], v[36:39], a[16:19], v[64:67]
  ds_read_b64_tr_b16 v[58:59], v6 offset:10240
  v_fma_f32 v147, 2.0, v148, v145
  v_mfma_f32_16x16x32_bf16 v[68:71], v[32:35], a[4:7], 0
  buffer_store_dwordx4 a[172:175], v27, s[48:51], s85 offen offset:3072 sc1
  v_mfma_f32_16x16x32_bf16 v[68:71], v[36:39], a[20:23], v[68:71]
  buffer_load_dwordx4 v18, s[44:47], s73 offen offset:1024 lds
  v_mfma_f32_16x16x32_bf16 v[72:75], v[32:35], a[8:11], 0
  ds_read_b64_tr_b16 v[60:61], v6 offset:12288
  v_mul_f32 v148, 0x41800000, v148
  v_mfma_f32_16x16x32_bf16 v[72:75], v[36:39], a[24:27], v[72:75]
  ds_read_b64_tr_b16 v[62:63], v6 offset:14336
  v_add_f32 v152, v144, v148
  v_mfma_f32_16x16x32_bf16 v[76:79], v[32:35], a[12:15], 0
  s_waitcnt vmcnt(28)
  s_barrier
  v_mfma_f32_16x16x32_bf16 v[76:79], v[36:39], a[28:31], v[76:79]
  ds_read_b64_tr_b16 v[32:33], v5 offset:16384
  v_add_f32 v153, v145, v148
  v_mfma_f32_16x16x32_bf16 v[80:83], v[40:43], a[0:3], 0
  buffer_load_dwordx4 v19, s[44:47], s73 offen offset:2048 lds
  s_waitcnt lgkmcnt(3)
  v_mfma_f32_16x16x32_bf16 v[80:83], v[44:47], a[16:19], v[80:83]
  ds_read_b64_tr_b16 v[34:35], v5 offset:18432
  v_add_f32 v154, v146, v148
  v_mfma_f32_16x16x32_bf16 v[84:87], v[40:43], a[4:7], 0
  buffer_load_dwordx4 v20, s[44:47], s73 offen offset:3072 lds
  v_mfma_f32_16x16x32_bf16 v[84:87], v[44:47], a[20:23], v[84:87]
  ds_read_b64_tr_b16 v[36:37], v5 offset:20480
  v_add_f32 v155, v147, v148
  v_mfma_f32_16x16x32_bf16 v[88:91], v[40:43], a[8:11], 0
  v_sin_f32 v148, v144
  v_mfma_f32_16x16x32_bf16 v[88:91], v[44:47], a[24:27], v[88:91]
  ds_read_b64_tr_b16 v[38:39], v5 offset:22528
  v_readlane_b32 s73, v31, 13
  v_mfma_f32_16x16x32_bf16 v[92:95], v[40:43], a[12:15], 0
  v_cos_f32 v144, v144
  v_mfma_f32_16x16x32_bf16 v[92:95], v[44:47], a[28:31], v[92:95]
  ds_read_b64_tr_b16 v[40:41], v6 offset:16384
  s_add_u32 m0, s74, 49152
  v_mfma_f32_16x16x32_bf16 v[64:67], v[48:51], a[32:35], v[64:67]
  buffer_load_dwordx4 v17, s[44:47], s73 offen lds
  v_mfma_f32_16x16x32_bf16 v[64:67], v[52:55], a[48:51], v[64:67]
  ds_read_b64_tr_b16 v[42:43], v6 offset:18432
  v_mfma_f32_16x16x32_bf16 v[68:71], v[48:51], a[36:39], v[68:71]
  buffer_load_dwordx4 v18, s[44:47], s73 offen offset:1024 lds
  v_mfma_f32_16x16x32_bf16 v[68:71], v[52:55], a[52:55], v[68:71]
  ds_read_b64_tr_b16 v[44:45], v6 offset:20480
  v_mfma_f32_16x16x32_bf16 v[72:75], v[48:51], a[40:43], v[72:75]
  v_sin_f32 v149, v145
  v_mfma_f32_16x16x32_bf16 v[72:75], v[52:55], a[56:59], v[72:75]
  ds_read_b64_tr_b16 v[46:47], v6 offset:22528
  v_mfma_f32_16x16x32_bf16 v[76:79], v[48:51], a[44:47], v[76:79]
  buffer_load_dwordx4 v19, s[44:47], s73 offen offset:2048 lds
  v_mfma_f32_16x16x32_bf16 v[76:79], v[52:55], a[60:63], v[76:79]
  ds_read_b64_tr_b16 v[48:49], v5 offset:24576
  v_mfma_f32_16x16x32_bf16 v[80:83], v[56:59], a[32:35], v[80:83]
  s_waitcnt lgkmcnt(3)
  v_mfma_f32_16x16x32_bf16 v[80:83], v[60:63], a[48:51], v[80:83]
  s_waitcnt vmcnt(15)
  v_readfirstlane_b32 s71, v15
  s_nop 3
  s_cmp_lt_u32 s71, 4
  s_cbranch_scc1 k1_kernel_gs4
k1_kernel_gr4:
  v_mfma_f32_16x16x32_bf16 v[84:87], v[56:59], a[36:39], v[84:87]
  ds_read_b64_tr_b16 v[50:51], v5 offset:26624
  v_mfma_f32_16x16x32_bf16 v[84:87], v[60:63], a[52:55], v[84:87]
  ds_read_b64_tr_b16 v[52:53], v5 offset:28672
  v_mfma_f32_16x16x32_bf16 v[88:91], v[56:59], a[40:43], v[88:91]
  buffer_load_dwordx4 v20, s[44:47], s73 offen offset:3072 lds
  v_mfma_f32_16x16x32_bf16 v[88:91], v[60:63], a[56:59], v[88:91]
  ds_read_b64_tr_b16 v[54:55], v5 offset:30720
  v_mfma_f32_16x16x32_bf16 v[92:95], v[56:59], a[44:47], v[92:95]
  v_cos_f32 v145, v145
  v_mfma_f32_16x16x32_bf16 v[92:95], v[60:63], a[60:63], v[92:95]
  ds_read_b64_tr_b16 v[56:57], v6 offset:24576
  v_readlane_b32 s73, v31, 14
  v_mfma_f32_16x16x32_bf16 v[64:67], v[32:35], a[64:67], v[64:67]
  v_sin_f32 v150, v146
  v_mfma_f32_16x16x32_bf16 v[64:67], v[36:39], a[80:83], v[64:67]
  ds_read_b64_tr_b16 v[58:59], v6 offset:26624
  v_mfma_f32_16x16x32_bf16 v[68:71], v[32:35], a[68:71], v[68:71]
  v_cos_f32 v146, v146
  v_mfma_f32_16x16x32_bf16 v[68:71], v[36:39], a[84:87], v[68:71]
  ds_read_b64_tr_b16 v[60:61], v6 offset:28672
  v_mfma_f32_16x16x32_bf16 v[72:75], v[32:35], a[72:75], v[72:75]
  v_sin_f32 v151, v147
  v_mfma_f32_16x16x32_bf16 v[72:75], v[36:39], a[88:91], v[72:75]
  ds_read_b64_tr_b16 v[62:63], v6 offset:30720
  v_mfma_f32_16x16x32_bf16 v[76:79], v[32:35], a[76:79], v[76:79]
  s_barrier
  v_mfma_f32_16x16x32_bf16 v[76:79], v[36:39], a[92:95], v[76:79]
  ds_read_b64_tr_b16 v[32:33], v3 offset:32768
  s_add_u32 m0, s74, 16384
  v_mfma_f32_16x16x32_bf16 v[80:83], v[40:43], a[64:67], v[80:83]
  s_waitcnt lgkmcnt(3)
  v_mfma_f32_16x16x32_bf16 v[80:83], v[44:47], a[80:83], v[80:83]
  ds_read_b64_tr_b16 v[34:35], v3 offset:34816
  v_mfma_f32_16x16x32_bf16 v[84:87], v[40:43], a[68:71], v[84:87]
  buffer_load_dwordx4 v21, s[48:51], s25 offen offset:0 sc1 lds
  v_mfma_f32_16x16x32_bf16 v[84:87], v[44:47], a[84:87], v[84:87]
  ds_read_b64_tr_b16 v[36:37], v3 offset:36864
  v_mfma_f32_16x16x32_bf16 v[88:91], v[40:43], a[72:75], v[88:91]
  buffer_load_dwordx4 v21, s[48:51], s25 offen offset:1024 sc1 lds
  v_mfma_f32_16x16x32_bf16 v[88:91], v[44:47], a[88:91], v[88:91]
  ds_read_b64_tr_b16 v[38:39], v3 offset:38912
  v_mfma_f32_16x16x32_bf16 v[92:95], v[40:43], a[76:79], v[92:95]
  buffer_load_dwordx4 v21, s[48:51], s25 offen offset:2048 sc1 lds
  v_mfma_f32_16x16x32_bf16 v[92:95], v[44:47], a[92:95], v[92:95]
  ds_read_b64_tr_b16 v[40:41], v4 offset:32768
  v_mfma_f32_16x16x32_bf16 v[64:67], v[48:51], a[96:99], v[64:67]
  v_cos_f32 v147, v147
  v_mfma_f32_16x16x32_bf16 v[64:67], v[52:55], a[112:115], v[64:67]
  ds_read_b64_tr_b16 v[42:43], v4 offset:34816
  v_mfma_f32_16x16x32_bf16 v[68:71], v[48:51], a[100:103], v[68:71]
  buffer_load_dwordx4 v21, s[48:51], s25 offen offset:3072 sc1 lds
  v_mfma_f32_16x16x32_bf16 v[68:71], v[52:55], a[116:119], v[68:71]
  ds_read_b64_tr_b16 v[44:45], v4 offset:36864
  v_mfma_f32_16x16x32_bf16 v[72:75], v[48:51], a[104:107], v[72:75]
  v_sin_f32 v156, v152
  v_mfma_f32_16x16x32_bf16 v[72:75], v[52:55], a[120:123], v[72:75]
  ds_read_b64_tr_b16 v[46:47], v4 offset:38912
  v_mfma_f32_16x16x32_bf16 v[76:79], v[48:51], a[108:111], v[76:79]
  v_cos_f32 v152, v152
  v_mfma_f32_16x16x32_bf16 v[76:79], v[52:55], a[124:127], v[76:79]
  ds_read_b64_tr_b16 v[48:49], v3 offset:40960
  s_add_u32 s25, s25, 16384
  v_mfma_f32_16x16x32_bf16 v[80:83], v[56:59], a[96:99], v[80:83]
  s_add_u32 m0, s74, 131072
  s_waitcnt lgkmcnt(3)
  v_mfma_f32_16x16x32_bf16 v[80:83], v[60:63], a[112:115], v[80:83]
  ds_read_b64_tr_b16 v[50:51], v3 offset:43008
  v_mfma_f32_16x16x32_bf16 v[84:87], v[56:59], a[100:103], v[84:87]
  buffer_load_dwordx4 v21, s[48:51], s16 offen offset:0 sc1 lds
  v_mfma_f32_16x16x32_bf16 v[84:87], v[60:63], a[116:119], v[84:87]
  ds_read_b64_tr_b16 v[52:53], v3 offset:45056
  v_mfma_f32_16x16x32_bf16 v[88:91], v[56:59], a[104:107], v[88:91]
  buffer_load_dwordx4 v21, s[48:51], s16 offen offset:1024 sc1 lds
  v_mfma_f32_16x16x32_bf16 v[88:91], v[60:63], a[120:123], v[88:91]
  ds_read_b64_tr_b16 v[54:55], v3 offset:47104
  v_mov_b32 v14, 5
  v_mfma_f32_16x16x32_bf16 v[92:95], v[56:59], a[108:111], v[92:95]
  buffer_load_dwordx4 v21, s[48:51], s16 offen offset:2048 sc1 lds
  v_mfma_f32_16x16x32_bf16 v[92:95], v[60:63], a[124:127], v[92:95]
  ds_read_b64_tr_b16 v[56:57], v4 offset:40960
  v_mfma_f32_16x16x32_bf16 v[64:67], v[32:35], v[192:195], v[64:67]
  v_sin_f32 v157, v153
  v_mfma_f32_16x16x32_bf16 v[64:67], v[36:39], v[208:211], v[64:67]
  ds_read_b64_tr_b16 v[58:59], v4 offset:43008
  v_mfma_f32_16x16x32_bf16 v[68:71], v[32:35], v[196:199], v[68:71]
  buffer_load_dwordx4 v21, s[48:51], s16 offen offset:3072 sc1 lds
  v_mfma_f32_16x16x32_bf16 v[68:71], v[36:39], v[212:215], v[68:71]
  ds_read_b64_tr_b16 v[60:61], v4 offset:45056
  v_mfma_f32_16x16x32_bf16 v[72:75], v[32:35], v[200:203], v[72:75]
  v_cos_f32 v153, v153
  v_mfma_f32_16x16x32_bf16 v[72:75], v[36:39], v[216:219], v[72:75]
  ds_read_b64_tr_b16 v[62:63], v4 offset:47104
  v_mfma_f32_16x16x32_bf16 v[76:79], v[32:35], v[204:207], v[76:79]
  s_waitcnt vmcnt(15)
  s_barrier
  v_mfma_f32_16x16x32_bf16 v[76:79], v[36:39], v[220:223], v[76:79]
  ds_read_b64_tr_b16 v[32:33], v23 offset:32768
  s_add_u32 m0, s74, 147456
  v_mfma_f32_16x16x32_bf16 v[80:83], v[40:43], v[192:195], v[80:83]
  s_waitcnt lgkmcnt(3)
  v_mfma_f32_16x16x32_bf16 v[80:83], v[44:47], v[208:211], v[80:83]
  ds_read_b64_tr_b16 v[34:35], v23 offset:34816
  v_mfma_f32_16x16x32_bf16 v[84:87], v[40:43], v[196:199], v[84:87]
  buffer_load_dwordx4 v21, s[48:51], s25 offen offset:0 sc1 lds
  v_mfma_f32_16x16x32_bf16 v[84:87], v[44:47], v[212:215], v[84:87]
  buffer_store_dword v14, off, s[48:51], s26 sc1
  v_mfma_f32_16x16x32_bf16 v[88:91], v[40:43], v[200:203], v[88:91]
  ds_read_b64_tr_b16 v[36:37], v23 offset:36864
  v_mfma_f32_16x16x32_bf16 v[88:91], v[44:47], v[216:219], v[88:91]
  ds_read_b64_tr_b16 v[38:39], v23 offset:38912
  v_mfma_f32_16x16x32_bf16 v[92:95], v[40:43], v[204:207], v[92:95]
  v_sin_f32 v158, v154
  v_cos_f32 v154, v154
  v_sin_f32 v159, v155
  v_cos_f32 v155, v155
  v_mfma_f32_16x16x32_bf16 v[92:95], v[44:47], v[220:223], v[92:95]
  ds_read_b64_tr_b16 v[40:41], v1 offset:40960
  v_mfma_f32_16x16x32_bf16 v[96:99], v[48:51], a[0:3], 0
  buffer_load_dwordx4 v21, s[48:51], s25 offen offset:1024 sc1 lds
  v_mfma_f32_16x16x32_bf16 v[96:99], v[52:55], a[16:19], v[96:99]
  ds_read_b64_tr_b16 v[42:43], v1 offset:43008
  v_mfma_f32_16x16x32_bf16 v[100:103], v[48:51], a[4:7], 0
  buffer_load_dwordx4 v21, s[48:51], s25 offen offset:2048 sc1 lds
  v_mfma_f32_16x16x32_bf16 v[100:103], v[52:55], a[20:23], v[100:103]
  ds_read_b64_tr_b16 v[44:45], v1 offset:45056
  v_mfma_f32_16x16x32_bf16 v[104:107], v[48:51], a[8:11], 0
  buffer_load_dwordx4 v21, s[48:51], s25 offen offset:3072 sc1 lds
  v_mfma_f32_16x16x32_bf16 v[104:107], v[52:55], a[24:27], v[104:107]
  ds_read_b64_tr_b16 v[46:47], v1 offset:47104
  v_mfma_f32_16x16x32_bf16 v[108:111], v[48:51], a[12:15], 0
  s_add_u32 s25, s25, 16384
  s_cmp_eq_u32 s65, 0
  s_cselect_b32 s25, s25, 2147418112
  v_mfma_f32_16x16x32_bf16 v[108:111], v[52:55], a[28:31], v[108:111]
  ds_read_b64_tr_b16 v[48:49], v2 offset:40960
  v_mfma_f32_16x16x32_bf16 v[112:115], v[56:59], a[0:3], 0
  s_waitcnt lgkmcnt(3)
  v_mfma_f32_16x16x32_bf16 v[112:115], v[60:63], a[16:19], v[112:115]
  ds_read_b64_tr_b16 v[50:51], v2 offset:43008
k1_pg8:
  s_cbranch_execz k1_wback
  v_mfma_f32_16x16x32_bf16 v[116:119], v[56:59], a[4:7], 0
  v_mfma_f32_16x16x32_bf16 v[116:119], v[60:63], a[20:23], v[116:119]
  ds_read_b64_tr_b16 v[52:53], v2 offset:45056
  v_mfma_f32_16x16x32_bf16 v[120:123], v[56:59], a[8:11], 0
  v_mfma_f32_16x16x32_bf16 v[120:123], v[60:63], a[24:27], v[120:123]
  ds_read_b64_tr_b16 v[54:55], v2 offset:47104
  v_mfma_f32_16x16x32_bf16 v[124:127], v[56:59], a[12:15], 0
  s_barrier
  v_mfma_f32_16x16x32_bf16 v[124:127], v[60:63], a[28:31], v[124:127]
  ds_read_b64_tr_b16 v[56:57], v24 offset:0
  s_add_u32 m0, s74, 98304
  v_mfma_f32_16x16x32_bf16 v[128:131], v[32:35], a[0:3], 0
  buffer_load_dwordx4 v17, s[44:47], s73 offen lds
  v_mfma_f32_16x16x32_bf16 v[128:131], v[36:39], a[16:19], v[128:131]
  ds_read_b64_tr_b16 v[58:59], v24 offset:2048
  v_mfma_f32_16x16x32_bf16 v[132:135], v[32:35], a[4:7], 0
  v_mfma_f32_16x16x32_bf16 v[132:135], v[36:39], a[20:23], v[132:135]
  ds_read_b64_tr_b16 v[60:61], v24 offset:4096
  v_mfma_f32_16x16x32_bf16 v[136:139], v[32:35], a[8:11], 0
  buffer_load_dwordx4 v18, s[44:47], s73 offen offset:1024 lds
  v_mfma_f32_16x16x32_bf16 v[136:139], v[36:39], a[24:27], v[136:139]
  ds_read_b64_tr_b16 v[62:63], v24 offset:6144
  v_mfma_f32_16x16x32_bf16 v[140:143], v[32:35], a[12:15], 0
  v_mfma_f32_16x16x32_bf16 v[140:143], v[36:39], a[28:31], v[140:143]
  ds_read_b64_tr_b16 v[32:33], v3 offset:8192
  v_mfma_f32_16x16x32_bf16 v[96:99], v[40:43], a[32:35], v[96:99]
  s_waitcnt lgkmcnt(3)
  v_mfma_f32_16x16x32_bf16 v[96:99], v[44:47], a[48:51], v[96:99]
  ds_read_b64_tr_b16 v[34:35], v3 offset:10240
  v_mfma_f32_16x16x32_bf16 v[100:103], v[40:43], a[36:39], v[100:103]
  buffer_load_dwordx4 v19, s[44:47], s73 offen offset:2048 lds
  v_mfma_f32_16x16x32_bf16 v[100:103], v[44:47], a[52:55], v[100:103]
  ds_read_b64_tr_b16 v[36:37], v3 offset:12288
  v_mfma_f32_16x16x32_bf16 v[104:107], v[40:43], a[40:43], v[104:107]
  v_mfma_f32_16x16x32_bf16 v[104:107], v[44:47], a[56:59], v[104:107]
  ds_read_b64_tr_b16 v[38:39], v3 offset:14336
  v_mfma_f32_16x16x32_bf16 v[108:111], v[40:43], a[44:47], v[108:111]
  buffer_load_dwordx4 v20, s[44:47], s73 offen offset:3072 lds
  v_mfma_f32_16x16x32_bf16 v[108:111], v[44:47], a[60:63], v[108:111]
  ds_read_b64_tr_b16 v[40:41], v4 offset:8192
  v_mfma_f32_16x16x32_bf16 v[112:115], v[48:51], a[32:35], v[112:115]
  v_add_u32 v29, 16384, v27
  v_mfma_f32_16x16x32_bf16 v[112:115], v[52:55], a[48:51], v[112:115]
  ds_read_b64_tr_b16 v[42:43], v4 offset:10240
  v_mfma_f32_16x16x32_bf16 v[116:119], v[48:51], a[36:39], v[116:119]
  v_readlane_b32 s73, v31, 15
  v_mfma_f32_16x16x32_bf16 v[116:119], v[52:55], a[52:55], v[116:119]
  ds_read_b64_tr_b16 v[44:45], v4 offset:12288
  v_mfma_f32_16x16x32_bf16 v[120:123], v[48:51], a[40:43], v[120:123]
  v_mfma_f32_16x16x32_bf16 v[120:123], v[52:55], a[56:59], v[120:123]
  ds_read_b64_tr_b16 v[46:47], v4 offset:14336
  v_mfma_f32_16x16x32_bf16 v[124:127], v[48:51], a[44:47], v[124:127]
  s_waitcnt vmcnt(9)
  s_barrier
  v_mfma_f32_16x16x32_bf16 v[124:127], v[52:55], a[60:63], v[124:127]
  ds_read_b64_tr_b16 v[48:49], v24 offset:16384
  s_add_u32 m0, s74, 32768
  v_mfma_f32_16x16x32_bf16 v[128:131], v[56:59], a[32:35], v[128:131]
  s_waitcnt lgkmcnt(3)
  v_mfma_f32_16x16x32_bf16 v[128:131], v[60:63], a[48:51], v[128:131]
  ds_read_b64_tr_b16 v[50:51], v24 offset:18432
  v_mfma_f32_16x16x32_bf16 v[132:135], v[56:59], a[36:39], v[132:135]
  buffer_load_dwordx4 v17, s[44:47], s73 offen lds
  v_mfma_f32_16x16x32_bf16 v[132:135], v[60:63], a[52:55], v[132:135]
  ds_read_b64_tr_b16 v[52:53], v24 offset:20480
  v_mfma_f32_16x16x32_bf16 v[136:139], v[56:59], a[40:43], v[136:139]
  buffer_load_dwordx4 v18, s[44:47], s73 offen offset:1024 lds
  v_mfma_f32_16x16x32_bf16 v[136:139], v[60:63], a[56:59], v[136:139]
  ds_read_b64_tr_b16 v[54:55], v24 offset:22528
  v_mfma_f32_16x16x32_bf16 v[140:143], v[56:59], a[44:47], v[140:143]
  ds_read_b128 a[176:179], v29 offset:0
  v_mfma_f32_16x16x32_bf16 v[140:143], v[60:63], a[60:63], v[140:143]
  ds_read_b64_tr_b16 v[56:57], v3 offset:24576
  v_mfma_f32_16x16x32_bf16 v[96:99], v[32:35], a[64:67], v[96:99]
  buffer_load_dwordx4 v19, s[44:47], s73 offen offset:2048 lds
  v_mfma_f32_16x16x32_bf16 v[96:99], v[36:39], a[80:83], v[96:99]
  ds_read_b64_tr_b16 v[58:59], v3 offset:26624
  v_mfma_f32_16x16x32_bf16 v[100:103], v[32:35], a[68:71], v[100:103]
  ds_read_b128 a[180:183], v29 offset:1024
  v_mfma_f32_16x16x32_bf16 v[100:103], v[36:39], a[84:87], v[100:103]
  ds_read_b64_tr_b16 v[60:61], v3 offset:28672
  v_mfma_f32_16x16x32_bf16 v[104:107], v[32:35], a[72:75], v[104:107]
  ds_read_b128 a[184:187], v29 offset:2048
  v_mfma_f32_16x16x32_bf16 v[104:107], v[36:39], a[88:91], v[104:107]
  ds_read_b64_tr_b16 v[62:63], v3 offset:30720
  v_mfma_f32_16x16x32_bf16 v[108:111], v[32:35], a[76:79], v[108:111]
  buffer_load_dword v15, off, s[48:51], s27 sc1
  v_mfma_f32_16x16x32_bf16 v[108:111], v[36:39], a[92:95], v[108:111]
  ds_read_b64_tr_b16 v[32:33], v4 offset:24576
  v_mfma_f32_16x16x32_bf16 v[112:115], v[40:43], a[64:67], v[112:115]
  s_waitcnt lgkmcnt(5)
  v_mfma_f32_16x16x32_bf16 v[112:115], v[44:47], a[80:83], v[112:115]
  ds_read_b64_tr_b16 v[34:35], v4 offset:26624
  v_mfma_f32_16x16x32_bf16 v[116:119], v[40:43], a[68:71], v[116:119]
  buffer_load_dwordx4 v20, s[44:47], s73 offen offset:3072 lds
  v_mfma_f32_16x16x32_bf16 v[116:119], v[44:47], a[84:87], v[116:119]
  ds_read_b64_tr_b16 v[36:37], v4 offset:28672
  v_readlane_b32 s73, v31, 16
  v_mfma_f32_16x16x32_bf16 v[120:123], v[40:43], a[72:75], v[120:123]
  ds_read_b128 a[188:191], v29 offset:3072
  v_mfma_f32_16x16x32_bf16 v[120:123], v[44:47], a[88:91], v[120:123]
  ds_read_b64_tr_b16 v[38:39], v4 offset:30720
  v_mfma_f32_16x16x32_bf16 v[124:127], v[40:43], a[76:79], v[124:127]
  s_barrier
  v_mfma_f32_16x16x32_bf16 v[124:127], v[44:47], a[92:95], v[124:127]
  ds_read_b64_tr_b16 v[40:41], v24 offset:49152
  s_add_u32 m0, s74, 65536
  v_mfma_f32_16x16x32_bf16 v[128:131], v[48:51], a[64:67], v[128:131]
  buffer_load_dwordx4 v17, s[44:47], s73 offen lds
  v_mfma_f32_16x16x32_bf16 v[128:131], v[52:55], a[80:83], v[128:131]
  ds_read_b64_tr_b16 v[42:43], v24 offset:51200
  v_mfma_f32_16x16x32_bf16 v[132:135], v[48:51], a[68:71], v[132:135]
  ds_read_b128 a[192:195], v29 offset:4096
  v_mfma_f32_16x16x32_bf16 v[132:135], v[52:55], a[84:87], v[132:135]
  ds_read_b64_tr_b16 v[44:45], v24 offset:53248
  v_mfma_f32_16x16x32_bf16 v[136:139], v[48:51], a[72:75], v[136:139]
  buffer_load_dwordx4 v18, s[44:47], s73 offen offset:1024 lds
  v_mfma_f32_16x16x32_bf16 v[136:139], v[52:55], a[88:91], v[136:139]
  ds_read_b64_tr_b16 v[46:47], v24 offset:55296
  v_mfma_f32_16x16x32_bf16 v[140:143], v[48:51], a[76:79], v[140:143]
  ds_read_b128 a[196:199], v29 offset:5120
  v_mfma_f32_16x16x32_bf16 v[140:143], v[52:55], a[92:95], v[140:143]
  ds_read_b64_tr_b16 v[48:49], v3 offset:57344
  v_mfma_f32_16x16x32_bf16 v[96:99], v[56:59], a[96:99], v[96:99]
  s_waitcnt lgkmcnt(5)
  v_mfma_f32_16x16x32_bf16 v[96:99], v[60:63], a[112:115], v[96:99]
  ds_read_b64_tr_b16 v[50:51], v3 offset:59392
  v_mfma_f32_16x16x32_bf16 v[100:103], v[56:59], a[100:103], v[100:103]
  buffer_load_dwordx4 v19, s[44:47], s73 offen offset:2048 lds
  v_mfma_f32_16x16x32_bf16 v[100:103], v[60:63], a[116:119], v[100:103]
  ds_read_b64_tr_b16 v[52:53], v3 offset:61440
  v_mfma_f32_16x16x32_bf16 v[104:107], v[56:59], a[104:107], v[104:107]
  ds_read_b128 a[200:203], v29 offset:6144
  v_mfma_f32_16x16x32_bf16 v[104:107], v[60:63], a[120:123], v[104:107]
  ds_read_b64_tr_b16 v[54:55], v3 offset:63488
  v_mfma_f32_16x16x32_bf16 v[108:111], v[56:59], a[108:111], v[108:111]
  buffer_load_dwordx4 v20, s[44:47], s73 offen offset:3072 lds
  v_mfma_f32_16x16x32_bf16 v[108:111], v[60:63], a[124:127], v[108:111]
  ds_read_b64_tr_b16 v[56:57], v4 offset:57344
  v_mfma_f32_16x16x32_bf16 v[112:115], v[32:35], a[96:99], v[112:115]
  ds_read_b128 a[204:207], v29 offset:7168
  v_mfma_f32_16x16x32_bf16 v[112:115], v[36:39], a[112:115], v[112:115]
  ds_read_b64_tr_b16 v[58:59], v4 offset:59392
  v_mfma_f32_16x16x32_bf16 v[116:119], v[32:35], a[100:103], v[116:119]
  ds_read_b128 a[0:3], v0 offset:0
  v_mfma_f32_16x16x32_bf16 v[116:119], v[36:39], a[116:119], v[116:119]
  ds_read_b64_tr_b16 v[60:61], v4 offset:61440
  v_readlane_b32 s73, v31, 17
  v_mfma_f32_16x16x32_bf16 v[120:123], v[32:35], a[104:107], v[120:123]
  ds_read_b128 a[4:7], v0 offset:2048
  v_mfma_f32_16x16x32_bf16 v[120:123], v[36:39], a[120:123], v[120:123]
  ds_read_b64_tr_b16 v[62:63], v4 offset:63488
  v_mfma_f32_16x16x32_bf16 v[124:127], v[32:35], a[108:111], v[124:127]
  s_waitcnt vmcnt(13) lgkmcnt(5)
  s_barrier
  v_mfma_f32_16x16x32_bf16 v[124:127], v[36:39], a[124:127], v[124:127]
  ds_read_b64_tr_b16 v[32:33], v23 offset:0
  s_add_u32 m0, s74, 81920
  v_mfma_f32_16x16x32_bf16 v[128:131], v[40:43], a[96:99], v[128:131]
  buffer_load_dwordx4 v17, s[44:47], s73 offen lds
  v_mfma_f32_16x16x32_bf16 v[128:131], v[44:47], a[112:115], v[128:131]
  ds_read_b64_tr_b16 v[34:35], v23 offset:2048
  v_mfma_f32_16x16x32_bf16 v[132:135], v[40:43], a[100:103], v[132:135]
  ds_read_b128 a[8:11], v0 offset:4096
  v_mfma_f32_16x16x32_bf16 v[132:135], v[44:47], a[116:119], v[132:135]
  ds_read_b64_tr_b16 v[36:37], v23 offset:4096
  v_mfma_f32_16x16x32_bf16 v[136:139], v[40:43], a[104:107], v[136:139]
  buffer_load_dwordx4 v18, s[44:47], s73 offen offset:1024 lds
  v_mfma_f32_16x16x32_bf16 v[136:139], v[44:47], a[120:123], v[136:139]
  ds_read_b64_tr_b16 v[38:39], v23 offset:6144
  v_mfma_f32_16x16x32_bf16 v[140:143], v[40:43], a[108:111], v[140:143]
  ds_read_b128 a[12:15], v0 offset:6144
  v_mfma_f32_16x16x32_bf16 v[140:143], v[44:47], a[124:127], v[140:143]
  ds_read_b64_tr_b16 v[40:41], v1 offset:8192
  v_mfma_f32_16x16x32_bf16 v[96:99], v[48:51], v[192:195], v[96:99]
  buffer_load_dwordx4 v19, s[44:47], s73 offen offset:2048 lds
  v_mfma_f32_16x16x32_bf16 v[96:99], v[52:55], v[208:211], v[96:99]
  ds_read_b64_tr_b16 v[42:43], v1 offset:10240
  v_mfma_f32_16x16x32_bf16 v[100:103], v[48:51], v[196:199], v[100:103]
  buffer_load_dwordx4 a[64:67], v22, s[48:51], s18 offen sc1
  v_mfma_f32_16x16x32_bf16 v[100:103], v[52:55], v[212:215], v[100:103]
  ds_read_b64_tr_b16 v[44:45], v1 offset:12288
  s_add_u32 s18, s18, 4096
  v_mfma_f32_16x16x32_bf16 v[104:107], v[48:51], v[200:203], v[104:107]
  buffer_load_dwordx4 a[68:71], v22, s[48:51], s18 offen sc1
  v_mfma_f32_16x16x32_bf16 v[104:107], v[52:55], v[216:219], v[104:107]
  ds_read_b64_tr_b16 v[46:47], v1 offset:14336
  v_mfma_f32_16x16x32_bf16 v[108:111], v[48:51], v[204:207], v[108:111]
  buffer_load_dwordx4 v20, s[44:47], s73 offen offset:3072 lds
  v_mfma_f32_16x16x32_bf16 v[108:111], v[52:55], v[220:223], v[108:111]
  ds_read_b64_tr_b16 v[48:49], v2 offset:8192
  s_waitcnt lgkmcnt(6)
  v_mfma_f32_16x16x32_bf16 v[112:115], v[56:59], v[192:195], v[112:115]
  ds_read_b128 a[16:19], v0 offset:256
  v_mfma_f32_16x16x32_bf16 v[112:115], v[60:63], v[208:211], v[112:115]
  s_waitcnt vmcnt(11)
  v_readfirstlane_b32 s71, v15
  s_nop 3
  s_cmp_lt_u32 s71, 5
  s_cbranch_scc1 k1_kernel_gs5
k1_kernel_gr5:
  v_mfma_f32_16x16x32_bf16 v[116:119], v[56:59], v[196:199], v[116:119]
  ds_read_b64_tr_b16 v[50:51], v2 offset:10240
  v_readlane_b32 s73, v31, 18
  v_mfma_f32_16x16x32_bf16 v[116:119], v[60:63], v[212:215], v[116:119]
  ds_read_b64_tr_b16 v[52:53], v2 offset:12288
  s_add_u32 m0, s74, 16384
  v_mfma_f32_16x16x32_bf16 v[120:123], v[56:59], v[200:203], v[120:123]
  ds_read_b128 a[20:23], v0 offset:2304
  v_mfma_f32_16x16x32_bf16 v[120:123], v[60:63], v[216:219], v[120:123]
  ds_read_b64_tr_b16 v[54:55], v2 offset:14336
  v_mfma_f32_16x16x32_bf16 v[124:127], v[56:59], v[204:207], v[124:127]
  s_barrier
  v_mfma_f32_16x16x32_bf16 v[124:127], v[60:63], v[220:223], v[124:127]
  buffer_load_dwordx4 v17, s[44:47], s73 offen lds
  ds_read_b128 a[24:27], v0 offset:4352
  v_mfma_f32_16x16x32_bf16 v[128:131], v[32:35], v[192:195], v[128:131]
  ds_read_b64_tr_b16 v[56:57], v1 offset:49152
  v_mfma_f32_16x16x32_bf16 v[128:131], v[36:39], v[208:211], v[128:131]
  ds_read_b64_tr_b16 v[58:59], v1 offset:51200
  v_mfma_f32_16x16x32_bf16 v[132:135], v[32:35], v[196:199], v[132:135]
  ds_read_b128 a[28:31], v0 offset:6400
  v_mfma_f32_16x16x32_bf16 v[132:135], v[36:39], v[212:215], v[132:135]
  ds_read_b64_tr_b16 v[60:61], v1 offset:53248
  v_mfma_f32_16x16x32_bf16 v[136:139], v[32:35], v[200:203], v[136:139]
  buffer_load_dwordx4 v18, s[44:47], s73 offen offset:1024 lds
  v_mfma_f32_16x16x32_bf16 v[136:139], v[36:39], v[216:219], v[136:139]
  v_add_u32 v29, 147456, v27
  ds_read_b128 a[208:211], v29 offset:0
  buffer_load_dwordx4 a[72:75], v22, s[48:51], s19 offen sc1
  s_add_u32 s19, s19, 4096
  ds_read_b128 a[32:35], v0 offset:8192
  v_mfma_f32_16x16x32_bf16 v[140:143], v[32:35], v[204:207], v[140:143]
  ds_read_b64_tr_b16 v[62:63], v1 offset:55296
  v_mfma_f32_16x16x32_bf16 v[140:143], v[36:39], v[220:223], v[140:143]
  ds_read_b64_tr_b16 v[32:33], v2 offset:49152
  s_waitcnt lgkmcnt(9)
  v_mfma_f32_16x16x32_bf16 v[160:163], v[40:43], a[128:131], v[160:163]
  ds_read_b128 a[212:215], v29 offset:1024
  ds_read_b128 a[36:39], v0 offset:10240
  v_mfma_f32_16x16x32_bf16 v[160:163], v[44:47], a[144:147], v[160:163]
  buffer_load_dwordx4 v19, s[44:47], s73 offen offset:2048 lds
  v_mfma_f32_16x16x32_bf16 v[164:167], v[40:43], a[132:135], v[164:167]
  buffer_load_dwordx4 a[76:79], v22, s[48:51], s19 offen sc1
  v_mfma_f32_16x16x32_bf16 v[164:167], v[44:47], a[148:151], v[164:167]
  ds_read_b128 a[216:219], v29 offset:2048
  ds_read_b128 a[40:43], v0 offset:12288
  v_mfma_f32_16x16x32_bf16 v[168:171], v[40:43], a[136:139], v[168:171]
  ds_read_b64_tr_b16 v[34:35], v2 offset:51200
  v_add_u32 v204, 0, v8
  v_mfma_f32_16x16x32_bf16 v[168:171], v[44:47], a[152:155], v[168:171]
  ds_read_b64_tr_b16 v[36:37], v2 offset:53248
  v_mul_u32_u24 v204, v7, v204
  v_mfma_f32_16x16x32_bf16 v[172:175], v[40:43], a[140:143], v[172:175]
  buffer_load_dwordx4 v20, s[44:47], s73 offen offset:3072 lds
  ds_read_b128 a[220:223], v29 offset:3072
  ds_read_b128 a[44:47], v0 offset:14336
  v_mfma_f32_16x16x32_bf16 v[172:175], v[44:47], a[156:159], v[172:175]
  ds_read_b64_tr_b16 v[38:39], v2 offset:55296
  v_readlane_b32 s73, v31, 19
  v_mfma_f32_16x16x32_bf16 v[176:179], v[48:51], a[128:131], v[176:179]
  ds_read_b64_tr_b16 v[40:41], v1 offset:57344
  s_add_u32 m0, s74, 114688
  v_mfma_f32_16x16x32_bf16 v[176:179], v[52:55], a[144:147], v[176:179]
  ds_read_b128 a[224:227], v29 offset:4096
  ds_read_b128 a[48:51], v0 offset:8448
  v_mfma_f32_16x16x32_bf16 v[180:183], v[48:51], a[132:135], v[180:183]
  buffer_load_dwordx4 v21, s[48:51], s25 offen offset:0 sc1 lds
  v_mfma_f32_16x16x32_bf16 v[180:183], v[52:55], a[148:151], v[180:183]
  ds_read_b64_tr_b16 v[42:43], v1 offset:59392
  v_cvt_f32_u32 v204, v204
  v_mfma_f32_16x16x32_bf16 v[184:187], v[48:51], a[136:139], v[184:187]
  ds_read_b128 a[228:231], v29 offset:5120
  ds_read_b128 a[52:55], v0 offset:10496
  v_mfma_f32_16x16x32_bf16 v[184:187], v[52:55], a[152:155], v[184:187]
  ds_read_b64_tr_b16 v[44:45], v1 offset:61440
  v_mul_f32 v204, 0x3d000000, v204
  v_mfma_f32_16x16x32_bf16 v[188:191], v[48:51], a[140:143], v[188:191]
  buffer_load_dwordx4 v21, s[48:51], s25 offen offset:1024 sc1 lds
  v_mfma_f32_16x16x32_bf16 v[188:191], v[52:55], a[156:159], v[188:191]
  ds_read_b128 a[232:235], v29 offset:6144
  ds_read_b128 a[56:59], v0 offset:12544
  s_waitcnt lgkmcnt(9)
  v_mfma_f32_16x16x32_bf16 v[224:227], v[56:59], a[128:131], v[224:227]
  ds_read_b64_tr_b16 v[46:47], v1 offset:63488
  v_add_u32 v205, 1, v8
  v_mfma_f32_16x16x32_bf16 v[224:227], v[60:63], a[144:147], v[224:227]
  ds_read_b64_tr_b16 v[48:49], v2 offset:57344
  v_mul_u32_u24 v205, v7, v205
  v_mfma_f32_16x16x32_bf16 v[228:231], v[56:59], a[132:135], v[228:231]
  buffer_load_dwordx4 v21, s[48:51], s25 offen offset:2048 sc1 lds
  ds_read_b128 a[236:239], v29 offset:7168
  ds_read_b128 a[60:63], v0 offset:14592
  v_mfma_f32_16x16x32_bf16 v[228:231], v[60:63], a[148:151], v[228:231]
  ds_read_b64_tr_b16 v[50:51], v2 offset:59392
  v_cvt_f32_u32 v205, v205
  v_mfma_f32_16x16x32_bf16 v[232:235], v[56:59], a[136:139], v[232:235]
  ds_read_b64_tr_b16 v[52:53], v2 offset:61440
  v_mul_f32 v205, 0x3d000000, v205
  v_mfma_f32_16x16x32_bf16 v[232:235], v[60:63], a[152:155], v[232:235]
  ds_read_b64_tr_b16 v[54:55], v2 offset:63488
  v_add_u32 v206, 2, v8
  v_mfma_f32_16x16x32_bf16 v[236:239], v[56:59], a[140:143], v[236:239]
  buffer_load_dwordx4 v21, s[48:51], s25 offen offset:3072 sc1 lds
  v_mfma_f32_16x16x32_bf16 v[236:239], v[60:63], a[156:159], v[236:239]
  s_waitcnt lgkmcnt(3)
  s_barrier
  v_mfma_f32_16x16x32_bf16 v[240:243], v[32:35], a[128:131], v[240:243]
  ds_read_b64_tr_b16 v[56:57], v3 offset:32768
  s_add_u32 m0, s74, 0
  v_mfma_f32_16x16x32_bf16 v[240:243], v[36:39], a[144:147], v[240:243]
  ds_read_b64_tr_b16 v[58:59], v3 offset:34816
  v_mul_u32_u24 v206, v7, v206
  v_mfma_f32_16x16x32_bf16 v[244:247], v[32:35], a[132:135], v[244:247]
  buffer_load_dwordx4 v17, s[44:47], s73 offen lds
  v_mfma_f32_16x16x32_bf16 v[244:247], v[36:39], a[148:151], v[244:247]
  ds_read_b64_tr_b16 v[60:61], v3 offset:36864
  v_cvt_f32_u32 v206, v206
  v_mfma_f32_16x16x32_bf16 v[248:251], v[32:35], a[136:139], v[248:251]
  buffer_load_dwordx4 v18, s[44:47], s73 offen offset:1024 lds
  v_mfma_f32_16x16x32_bf16 v[248:251], v[36:39], a[152:155], v[248:251]
  ds_read_b64_tr_b16 v[62:63], v3 offset:38912
  v_mul_f32 v206, 0x3d000000, v206
  v_mfma_f32_16x16x32_bf16 v[252:255], v[32:35], a[140:143], v[252:255]
  v_sin_f32 v220, v204
  v_mfma_f32_16x16x32_bf16 v[252:255], v[36:39], a[156:159], v[252:255]
  ds_read_b64_tr_b16 v[32:33], v4 offset:32768
  v_add_u32 v207, 3, v8
  v_mfma_f32_16x16x32_bf16 v[64:67], v[40:43], a[128:131], v[64:67]
  buffer_load_dwordx4 v19, s[44:47], s73 offen offset:2048 lds
  v_mfma_f32_16x16x32_bf16 v[64:67], v[44:47], a[144:147], v[64:67]
  ds_read_b64_tr_b16 v[34:35], v4 offset:34816
  v_mul_u32_u24 v207, v7, v207
  v_mfma_f32_16x16x32_bf16 v[68:71], v[40:43], a[132:135], v[68:71]
  v_cos_f32 v204, v204
  v_mfma_f32_16x16x32_bf16 v[68:71], v[44:47], a[148:151], v[68:71]
  ds_read_b64_tr_b16 v[36:37], v4 offset:36864
  v_cvt_pk_bf16_f32 v192, v204, v220
  v_mfma_f32_16x16x32_bf16 v[72:75], v[40:43], a[136:139], v[72:75]
  v_sin_f32 v221, v205
  v_mfma_f32_16x16x32_bf16 v[72:75], v[44:47], a[152:155], v[72:75]
  ds_read_b64_tr_b16 v[38:39], v4 offset:38912
  v_cvt_pk_bf16_f32 v208, -v220, v204
  v_mfma_f32_16x16x32_bf16 v[76:79], v[40:43], a[140:143], v[76:79]
  buffer_load_dwordx4 v20, s[44:47], s73 offen offset:3072 lds
  v_mfma_f32_16x16x32_bf16 v[76:79], v[44:47], a[156:159], v[76:79]
  ds_read_b64_tr_b16 v[40:41], v24 offset:40960
  s_waitcnt lgkmcnt(5)
  v_mfma_f32_16x16x32_bf16 v[80:83], v[48:51], a[128:131], v[80:83]
  v_cos_f32 v205, v205
  v_mfma_f32_16x16x32_bf16 v[80:83], v[52:55], a[144:147], v[80:83]
  ds_read_b64_tr_b16 v[42:43], v24 offset:43008
  v_xor_b32 v196, v192, v10
  v_mfma_f32_16x16x32_bf16 v[84:87], v[48:51], a[132:135], v[84:87]
  v_sin_f32 v222, v206
  v_mfma_f32_16x16x32_bf16 v[84:87], v[52:55], a[148:151], v[84:87]
  ds_read_b64_tr_b16 v[44:45], v24 offset:45056
  v_readlane_b32 s73, v31, 20
  v_mfma_f32_16x16x32_bf16 v[88:91], v[48:51], a[136:139], v[88:91]
  v_cos_f32 v206, v206
  v_mfma_f32_16x16x32_bf16 v[88:91], v[52:55], a[152:155], v[88:91]
  ds_read_b64_tr_b16 v[46:47], v24 offset:47104
  s_add_u32 m0, s74, 131072
  v_mfma_f32_16x16x32_bf16 v[92:95], v[48:51], a[140:143], v[92:95]
  s_waitcnt vmcnt(24)
  s_barrier
  v_mfma_f32_16x16x32_bf16 v[92:95], v[52:55], a[156:159], v[92:95]
  buffer_load_dwordx4 v17, s[44:47], s73 offen lds
  v_mfma_f32_16x16x32_bf16 v[96:99], v[56:59], a[128:131], v[96:99]
  ds_read_b64_tr_b16 v[48:49], v1 offset:32768
  v_xor_b32 v212, v208, v10
  v_mfma_f32_16x16x32_bf16 v[96:99], v[60:63], a[144:147], v[96:99]
  ds_read_b64_tr_b16 v[50:51], v1 offset:34816
  v_mov_b32 v200, v192
  v_mfma_f32_16x16x32_bf16 v[100:103], v[56:59], a[132:135], v[100:103]
  buffer_load_dwordx4 v18, s[44:47], s73 offen offset:1024 lds
  v_mfma_f32_16x16x32_bf16 v[100:103], v[60:63], a[148:151], v[100:103]
  v_cvt_f32_u32 v207, v207
  ds_read_b64_tr_b16 v[52:53], v1 offset:36864
  v_mfma_f32_16x16x32_bf16 v[104:107], v[56:59], a[136:139], v[104:107]
  buffer_load_dwordx4 v19, s[44:47], s73 offen offset:2048 lds
  v_mfma_f32_16x16x32_bf16 v[104:107], v[60:63], a[152:155], v[104:107]
  ds_read_b64_tr_b16 v[54:55], v1 offset:38912
  v_mov_b32 v216, v208
  v_mfma_f32_16x16x32_bf16 v[108:111], v[56:59], a[140:143], v[108:111]
  v_mov_b32 v204, v196
  v_cvt_pk_bf16_f32 v193, v205, v221
  v_mfma_f32_16x16x32_bf16 v[108:111], v[60:63], a[156:159], v[108:111]
  ds_read_b64_tr_b16 v[56:57], v2 offset:32768
  s_waitcnt lgkmcnt(5)
  v_mfma_f32_16x16x32_bf16 v[112:115], v[32:35], a[128:131], v[112:115]
  buffer_load_dwordx4 v20, s[44:47], s73 offen offset:3072 lds
  v_mfma_f32_16x16x32_bf16 v[112:115], v[36:39], a[144:147], v[112:115]
  v_mul_f32 v207, 0x3d000000, v207
  ds_read_b64_tr_b16 v[58:59], v2 offset:34816
  v_mfma_f32_16x16x32_bf16 v[116:119], v[32:35], a[132:135], v[116:119]
  v_sin_f32 v223, v207
  v_mfma_f32_16x16x32_bf16 v[116:119], v[36:39], a[148:151], v[116:119]
  ds_read_b64_tr_b16 v[60:61], v2 offset:36864
  v_mov_b32 v220, v212
  v_mfma_f32_16x16x32_bf16 v[120:123], v[32:35], a[136:139], v[120:123]
  v_cos_f32 v207, v207
  v_mfma_f32_16x16x32_bf16 v[120:123], v[36:39], a[152:155], v[120:123]
  ds_read_b64_tr_b16 v[62:63], v2 offset:38912
  v_readlane_b32 s73, v31, 21
  v_mfma_f32_16x16x32_bf16 v[124:127], v[32:35], a[140:143], v[124:127]
  s_add_u32 m0, s74, 147456
  v_accvgpr_write_b32 a80, v192
  v_mfma_f32_16x16x32_bf16 v[124:127], v[36:39], a[156:159], v[124:127]
  ds_read_b64_tr_b16 v[32:33], v1 offset:40960
  v_accvgpr_write_b32 a84, v196
  v_mfma_f32_16x16x32_bf16 v[128:131], v[40:43], a[128:131], v[128:131]
  buffer_load_dwordx4 v17, s[44:47], s73 offen lds
  v_mfma_f32_16x16x32_bf16 v[128:131], v[44:47], a[144:147], v[128:131]
  ds_read_b64_tr_b16 v[34:35], v1 offset:43008
  v_accvgpr_write_b32 a88, v200
  v_mfma_f32_16x16x32_bf16 v[132:135], v[40:43], a[132:135], v[132:135]
  buffer_load_dwordx4 v18, s[44:47], s73 offen offset:1024 lds
  v_mfma_f32_16x16x32_bf16 v[132:135], v[44:47], a[148:151], v[132:135]
  ds_read_b64_tr_b16 v[36:37], v1 offset:45056
  v_accvgpr_write_b32 a92, v204
  v_mfma_f32_16x16x32_bf16 v[136:139], v[40:43], a[136:139], v[136:139]
  v_accvgpr_write_b32 a96, v208
  v_cvt_pk_bf16_f32 v209, -v221, v205
  v_mfma_f32_16x16x32_bf16 v[136:139], v[44:47], a[152:155], v[136:139]
  ds_read_b64_tr_b16 v[38:39], v1 offset:47104
  v_accvgpr_write_b32 a100, v212
  v_mfma_f32_16x16x32_bf16 v[140:143], v[40:43], a[140:143], v[140:143]
  buffer_load_dwordx4 v19, s[44:47], s73 offen offset:2048 lds
  v_mfma_f32_16x16x32_bf16 v[140:143], v[44:47], a[156:159], v[140:143]
  ds_read_b64_tr_b16 v[40:41], v2 offset:40960
  s_waitcnt lgkmcnt(5)
  v_mfma_f32_16x16x32_bf16 v[160:163], v[48:51], a[160:163], v[160:163]
  v_add_u32 v29, 114688, v27
  v_accvgpr_write_b32 a104, v216
  v_mfma_f32_16x16x32_bf16 v[160:163], v[52:55], a[176:179], v[160:163]
  ds_read_b64_tr_b16 v[42:43], v2 offset:43008
  v_accvgpr_write_b32 a108, v220
  v_mfma_f32_16x16x32_bf16 v[164:167], v[48:51], a[164:167], v[164:167]
  v_add_u32 v204, 0, v8
  v_xor_b32 v197, v193, v10
  v_mfma_f32_16x16x32_bf16 v[164:167], v[52:55], a[180:183], v[164:167]
  ds_read_b64_tr_b16 v[44:45], v2 offset:45056
  v_mul_u32_u24 v204, v9, v204
  v_mfma_f32_16x16x32_bf16 v[168:171], v[48:51], a[168:171], v[168:171]
  v_cvt_pk_bf16_f32 v194, v206, v222
  v_cvt_pk_bf16_f32 v195, v207, v223
  v_mfma_f32_16x16x32_bf16 v[168:171], v[52:55], a[184:187], v[168:171]
  ds_read_b64_tr_b16 v[46:47], v2 offset:47104
  v_cvt_f32_u32 v204, v204
  v_mfma_f32_16x16x32_bf16 v[172:175], v[48:51], a[172:175], v[172:175]
  s_waitcnt vmcnt(11)
  s_barrier
  v_mfma_f32_16x16x32_bf16 v[172:175], v[52:55], a[188:191], v[172:175]
  ds_read_b64_tr_b16 v[48:49], v3 offset:0
  v_mul_f32 v204, 0x3c800000, v204
  v_mfma_f32_16x16x32_bf16 v[176:179], v[56:59], a[160:163], v[176:179]
  buffer_load_dwordx4 v20, s[44:47], s73 offen offset:3072 lds
  v_mfma_f32_16x16x32_bf16 v[176:179], v[60:63], a[176:179], v[176:179]
  ds_read_b64_tr_b16 v[50:51], v3 offset:2048
  v_readlane_b32 s73, v31, 22
  v_mfma_f32_16x16x32_bf16 v[180:183], v[56:59], a[164:167], v[180:183]
  v_cvt_pk_bf16_f32 v210, -v222, v206
  v_cvt_pk_bf16_f32 v211, -v223, v207
  v_mfma_f32_16x16x32_bf16 v[180:183], v[60:63], a[180:183], v[180:183]
  ds_read_b64_tr_b16 v[52:53], v3 offset:4096
  s_add_u32 m0, s74, 49152
  v_mfma_f32_16x16x32_bf16 v[184:187], v[56:59], a[168:171], v[184:187]
  buffer_load_dwordx4 v17, s[44:47], s73 offen lds
  v_mfma_f32_16x16x32_bf16 v[184:187], v[60:63], a[184:187], v[184:187]
  ds_read_b64_tr_b16 v[54:55], v3 offset:6144
  v_xor_b32 v213, v209, v10
  v_mfma_f32_16x16x32_bf16 v[188:191], v[56:59], a[172:175], v[188:191]
  buffer_load_dwordx4 v18, s[44:47], s73 offen offset:1024 lds
  v_mfma_f32_16x16x32_bf16 v[188:191], v[60:63], a[188:191], v[188:191]
  ds_read_b64_tr_b16 v[56:57], v4 offset:0
  s_waitcnt lgkmcnt(5)
  v_mfma_f32_16x16x32_bf16 v[224:227], v[32:35], a[160:163], v[224:227]
  ds_read_b128 a[240:243], v29 offset:0
  v_mfma_f32_16x16x32_bf16 v[224:227], v[36:39], a[176:179], v[224:227]
  v_xor_b32 v198, v194, v10
  v_xor_b32 v199, v195, v10
  v_mfma_f32_16x16x32_bf16 v[228:231], v[32:35], a[164:167], v[228:231]
  ds_read_b64_tr_b16 v[58:59], v4 offset:2048
  v_xor_b32 v201, 0x80008000, v193
  v_mfma_f32_16x16x32_bf16 v[228:231], v[36:39], a[180:183], v[228:231]
  ds_read_b64_tr_b16 v[60:61], v4 offset:4096
  v_xor_b32 v217, 0x80008000, v209
  v_mfma_f32_16x16x32_bf16 v[232:235], v[32:35], a[168:171], v[232:235]
  buffer_load_dwordx4 v19, s[44:47], s73 offen offset:2048 lds
  v_mfma_f32_16x16x32_bf16 v[232:235], v[36:39], a[184:187], v[232:235]
  ds_read_b64_tr_b16 v[62:63], v4 offset:6144
  v_xor_b32 v205, 0x80008000, v197
  v_mfma_f32_16x16x32_bf16 v[236:239], v[32:35], a[172:175], v[236:239]
  buffer_load_dwordx4 v20, s[44:47], s73 offen offset:3072 lds
  v_mfma_f32_16x16x32_bf16 v[236:239], v[36:39], a[188:191], v[236:239]
  v_xor_b32 v214, v210, v10
  v_xor_b32 v215, v211, v10
  v_mfma_f32_16x16x32_bf16 v[240:243], v[40:43], a[160:163], v[240:243]
  ds_read_b64_tr_b16 v[32:33], v3 offset:8192
  v_xor_b32 v221, 0x80008000, v213
  v_mfma_f32_16x16x32_bf16 v[240:243], v[44:47], a[176:179], v[240:243]
  ds_read_b64_tr_b16 v[34:35], v3 offset:10240
  v_accvgpr_write_b32 a81, v193
  v_mfma_f32_16x16x32_bf16 v[244:247], v[40:43], a[164:167], v[244:247]
  ds_read_b128 a[244:247], v29 offset:1024
  v_mfma_f32_16x16x32_bf16 v[244:247], v[44:47], a[180:183], v[244:247]
  ds_read_b64_tr_b16 v[36:37], v3 offset:12288
  v_accvgpr_write_b32 a85, v197
  v_mfma_f32_16x16x32_bf16 v[248:251], v[40:43], a[168:171], v[248:251]
  ds_read_b128 a[248:251], v29 offset:2048
  v_mfma_f32_16x16x32_bf16 v[248:251], v[44:47], a[184:187], v[248:251]
  ds_read_b64_tr_b16 v[38:39], v3 offset:14336
  v_accvgpr_write_b32 a89, v201
  v_mfma_f32_16x16x32_bf16 v[252:255], v[40:43], a[172:175], v[252:255]
  v_mov_b32 v202, v194
  v_xor_b32 v203, 0x80008000, v195
  v_mfma_f32_16x16x32_bf16 v[252:255], v[44:47], a[188:191], v[252:255]
  ds_read_b64_tr_b16 v[40:41], v4 offset:8192
  s_waitcnt lgkmcnt(7)
  v_mfma_f32_16x16x32_bf16 v[160:163], v[48:51], a[192:195], v[160:163]
  ds_read_b128 a[252:255], v29 offset:3072
  v_mfma_f32_16x16x32_bf16 v[160:163], v[52:55], a[208:211], v[160:163]
  ds_read_b64_tr_b16 v[42:43], v4 offset:10240
  v_accvgpr_write_b32 a93, v205
  v_mfma_f32_16x16x32_bf16 v[164:167], v[48:51], a[196:199], v[164:167]
  v_sin_f32 v220, v204
  v_mfma_f32_16x16x32_bf16 v[164:167], v[52:55], a[212:215], v[164:167]
  ds_read_b64_tr_b16 v[44:45], v4 offset:12288
  v_accvgpr_write_b32 a97, v209
  v_mfma_f32_16x16x32_bf16 v[168:171], v[48:51], a[200:203], v[168:171]
  v_mov_b32 v218, v210
  v_xor_b32 v219, 0x80008000, v211
  v_mfma_f32_16x16x32_bf16 v[168:171], v[52:55], a[216:219], v[168:171]
  ds_read_b64_tr_b16 v[46:47], v4 offset:14336
  v_accvgpr_write_b32 a101, v213
  v_mfma_f32_16x16x32_bf16 v[172:175], v[48:51], a[204:207], v[172:175]
  s_waitcnt lgkmcnt(3)
  s_barrier
  v_mfma_f32_16x16x32_bf16 v[172:175], v[52:55], a[220:223], v[172:175]
  ds_read_b64_tr_b16 v[48:49], v3 offset:16384
  v_accvgpr_write_b32 a105, v217
  v_mfma_f32_16x16x32_bf16 v[176:179], v[56:59], a[192:195], v[176:179]
  v_cos_f32 v204, v204
  v_mfma_f32_16x16x32_bf16 v[176:179], v[60:63], a[208:211], v[176:179]
  ds_read_b64_tr_b16 v[50:51], v3 offset:18432
  v_cvt_pk_bf16_f32 v192, v204, v220
  v_mfma_f32_16x16x32_bf16 v[180:183], v[56:59], a[196:199], v[180:183]
k1_pg9:
  s_cbranch_execz k1_wback
  v_mov_b32 v206, v198
  v_xor_b32 v207, 0x80008000, v199
  v_mfma_f32_16x16x32_bf16 v[180:183], v[60:63], a[212:215], v[180:183]
  ds_read_b64_tr_b16 v[52:53], v3 offset:20480
  v_cvt_pk_bf16_f32 v208, -v220, v204
  v_mfma_f32_16x16x32_bf16 v[184:187], v[56:59], a[200:203], v[184:187]
  v_xor_b32 v200, v192, v10
  v_accvgpr_write_b32 a109, v221
  v_mfma_f32_16x16x32_bf16 v[184:187], v[60:63], a[216:219], v[184:187]
  ds_read_b64_tr_b16 v[54:55], v3 offset:22528
  v_xor_b32 v216, v208, v10
  v_mfma_f32_16x16x32_bf16 v[188:191], v[56:59], a[204:207], v[188:191]
  v_cndmask_b32 v196, v192, v208, s[22:23]
  v_add_u32 v205, 1, v8
  v_mfma_f32_16x16x32_bf16 v[188:191], v[60:63], a[220:223], v[188:191]
  ds_read_b64_tr_b16 v[56:57], v4 offset:16384
  v_cndmask_b32 v212, v208, v192, s[22:23]
  v_mfma_f32_16x16x32_bf16 v[224:227], v[32:35], a[192:195], v[224:227]
  v_xor_b32 v196, v196, v11
  v_mul_u32_u24 v205, v9, v205
  v_mfma_f32_16x16x32_bf16 v[224:227], v[36:39], a[208:211], v[224:227]
  v_mov_b32 v222, v214
  v_xor_b32 v223, 0x80008000, v215
  v_mfma_f32_16x16x32_bf16 v[228:231], v[32:35], a[196:199], v[228:231]
  ds_read_b64_tr_b16 v[58:59], v4 offset:18432
  v_xor_b32 v212, v212, v12
  v_mfma_f32_16x16x32_bf16 v[228:231], v[36:39], a[212:215], v[228:231]
  ds_read_b64_tr_b16 v[60:61], v4 offset:20480
  v_xor_b32 v204, v196, v10
  v_mfma_f32_16x16x32_bf16 v[232:235], v[32:35], a[200:203], v[232:235]
  v_xor_b32 v220, v212, v10
  v_cvt_f32_u32 v205, v205
  v_mfma_f32_16x16x32_bf16 v[232:235], v[36:39], a[216:219], v[232:235]
  ds_read_b64_tr_b16 v[62:63], v4 offset:22528
  v_mul_f32 v205, 0x3c800000, v205
  v_mfma_f32_16x16x32_bf16 v[236:239], v[32:35], a[204:207], v[236:239]
  v_sin_f32 v221, v205
  v_mfma_f32_16x16x32_bf16 v[236:239], v[36:39], a[220:223], v[236:239]
  v_accvgpr_write_b32 a82, v194
  v_accvgpr_write_b32 a83, v195
  s_waitcnt lgkmcnt(4)
  v_mfma_f32_16x16x32_bf16 v[240:243], v[40:43], a[192:195], v[240:243]
  ds_read_b64_tr_b16 v[32:33], v3 offset:24576
  v_accvgpr_write_b32 a86, v198
  v_mfma_f32_16x16x32_bf16 v[240:243], v[44:47], a[208:211], v[240:243]
  ds_read_b64_tr_b16 v[34:35], v3 offset:26624
  v_accvgpr_write_b32 a90, v202
  v_mfma_f32_16x16x32_bf16 v[244:247], v[40:43], a[196:199], v[244:247]
  v_cos_f32 v205, v205
  v_mfma_f32_16x16x32_bf16 v[244:247], v[44:47], a[212:215], v[244:247]
  ds_read_b64_tr_b16 v[36:37], v3 offset:28672
  v_cvt_pk_bf16_f32 v193, v205, v221
  v_mfma_f32_16x16x32_bf16 v[248:251], v[40:43], a[200:203], v[248:251]
  v_cvt_pk_bf16_f32 v209, -v221, v205
  v_accvgpr_write_b32 a94, v206
  v_mfma_f32_16x16x32_bf16 v[248:251], v[44:47], a[216:219], v[248:251]
  v_accvgpr_write_b32 a87, v199
  ds_read_b64_tr_b16 v[38:39], v3 offset:30720
  v_mfma_f32_16x16x32_bf16 v[252:255], v[40:43], a[204:207], v[252:255]
  v_xor_b32 v201, v193, v10
  v_accvgpr_write_b32 a98, v210
  v_mfma_f32_16x16x32_bf16 v[252:255], v[44:47], a[220:223], v[252:255]
  ds_read_b64_tr_b16 v[40:41], v4 offset:24576
  v_xor_b32 v217, v209, v10
  v_mfma_f32_16x16x32_bf16 v[160:163], v[48:51], a[224:227], v[160:163]
  v_cndmask_b32 v197, v193, v209, s[22:23]
  v_accvgpr_write_b32 a102, v214
  v_mfma_f32_16x16x32_bf16 v[160:163], v[52:55], a[240:243], v[160:163]
  ds_read_b64_tr_b16 v[42:43], v4 offset:26624
  v_cndmask_b32 v213, v209, v193, s[22:23]
  v_mfma_f32_16x16x32_bf16 v[164:167], v[48:51], a[228:231], v[164:167]
  v_xor_b32 v197, v197, v11
  v_accvgpr_write_b32 a106, v218
  v_mfma_f32_16x16x32_bf16 v[164:167], v[52:55], a[244:247], v[164:167]
  ds_read_b64_tr_b16 v[44:45], v4 offset:28672
  v_xor_b32 v213, v213, v12
  v_mfma_f32_16x16x32_bf16 v[168:171], v[48:51], a[232:235], v[168:171]
  v_accvgpr_write_b32 a91, v203
  v_xor_b32 v205, v197, v10
  v_mfma_f32_16x16x32_bf16 v[168:171], v[52:55], a[248:251], v[168:171]
  ds_read_b64_tr_b16 v[46:47], v4 offset:30720
  v_xor_b32 v221, v213, v10
  v_mfma_f32_16x16x32_bf16 v[172:175], v[48:51], a[236:239], v[172:175]
  s_barrier
  v_mfma_f32_16x16x32_bf16 v[172:175], v[52:55], a[252:255], v[172:175]
  ds_read_b64_tr_b16 v[48:49], v1 offset:16384
  s_waitcnt lgkmcnt(5)
  v_mfma_f32_16x16x32_bf16 v[176:179], v[56:59], a[224:227], v[176:179]
  v_accvgpr_write_b32 a110, v222
  v_accvgpr_write_b32 a95, v207
  v_mfma_f32_16x16x32_bf16 v[176:179], v[60:63], a[240:243], v[176:179]
  ds_read_b64_tr_b16 v[50:51], v1 offset:18432
  v_add_u32 v206, 2, v8
  v_mfma_f32_16x16x32_bf16 v[180:183], v[56:59], a[228:231], v[180:183]
  v_mul_u32_u24 v206, v9, v206
  v_accvgpr_write_b32 a99, v211
  v_mfma_f32_16x16x32_bf16 v[180:183], v[60:63], a[244:247], v[180:183]
  ds_read_b64_tr_b16 v[52:53], v1 offset:20480
  v_cvt_f32_u32 v206, v206
  v_mfma_f32_16x16x32_bf16 v[184:187], v[56:59], a[232:235], v[184:187]
  v_mul_f32 v206, 0x3c800000, v206
  v_accvgpr_write_b32 a103, v215
  v_mfma_f32_16x16x32_bf16 v[184:187], v[60:63], a[248:251], v[184:187]
  ds_read_b64_tr_b16 v[54:55], v1 offset:22528
  v_accvgpr_write_b32 a107, v219
  v_mfma_f32_16x16x32_bf16 v[188:191], v[56:59], a[236:239], v[188:191]
  v_sin_f32 v222, v206
  v_mfma_f32_16x16x32_bf16 v[188:191], v[60:63], a[252:255], v[188:191]
  ds_read_b64_tr_b16 v[56:57], v2 offset:16384
  v_accvgpr_write_b32 a111, v223
  v_mfma_f32_16x16x32_bf16 v[224:227], v[32:35], a[224:227], v[224:227]
  v_cos_f32 v206, v206
  v_mfma_f32_16x16x32_bf16 v[224:227], v[36:39], a[240:243], v[224:227]
  ds_read_b64_tr_b16 v[58:59], v2 offset:18432
  v_cvt_pk_bf16_f32 v194, v206, v222
  v_mfma_f32_16x16x32_bf16 v[228:231], v[32:35], a[228:231], v[228:231]
  v_cvt_pk_bf16_f32 v160, v160, v161
  v_cvt_pk_bf16_f32 v210, -v222, v206
  v_mfma_f32_16x16x32_bf16 v[228:231], v[36:39], a[244:247], v[228:231]
  ds_read_b64_tr_b16 v[60:61], v2 offset:20480
  v_cvt_pk_bf16_f32 v161, v162, v163
  v_mfma_f32_16x16x32_bf16 v[232:235], v[32:35], a[232:235], v[232:235]
  v_cvt_pk_bf16_f32 v162, v164, v165
  v_xor_b32 v202, v194, v10
  v_mfma_f32_16x16x32_bf16 v[232:235], v[36:39], a[248:251], v[232:235]
  ds_read_b64_tr_b16 v[62:63], v2 offset:22528
  v_cvt_pk_bf16_f32 v163, v166, v167
  v_mfma_f32_16x16x32_bf16 v[236:239], v[32:35], a[236:239], v[236:239]
  v_xor_b32 v218, v210, v10
  v_add_u32 v207, 3, v8
  v_mfma_f32_16x16x32_bf16 v[236:239], v[36:39], a[252:255], v[236:239]
  ds_read_b64_tr_b16 v[32:33], v1 offset:24576
  s_waitcnt lgkmcnt(5)
  v_mfma_f32_16x16x32_bf16 v[240:243], v[40:43], a[224:227], v[240:243]
  buffer_store_dwordx4 v[160:163], v21, s[48:51], s81 offen offset:0 sc1
  v_mfma_f32_16x16x32_bf16 v[240:243], v[44:47], a[240:243], v[240:243]
  ds_read_b64_tr_b16 v[34:35], v1 offset:26624
  v_cvt_pk_bf16_f32 v164, v168, v169
  v_mfma_f32_16x16x32_bf16 v[244:247], v[40:43], a[228:231], v[244:247]
  v_cvt_pk_bf16_f32 v165, v170, v171
  v_cndmask_b32 v198, v194, v210, s[22:23]
  v_mfma_f32_16x16x32_bf16 v[244:247], v[44:47], a[244:247], v[244:247]
  ds_read_b64_tr_b16 v[36:37], v1 offset:28672
  v_cvt_pk_bf16_f32 v166, v172, v173
  v_mfma_f32_16x16x32_bf16 v[248:251], v[40:43], a[232:235], v[248:251]
  v_cvt_pk_bf16_f32 v167, v174, v175
  v_cndmask_b32 v214, v210, v194, s[22:23]
  v_mfma_f32_16x16x32_bf16 v[248:251], v[44:47], a[248:251], v[248:251]
  ds_read_b64_tr_b16 v[38:39], v1 offset:30720
  v_xor_b32 v198, v198, v11
  v_mfma_f32_16x16x32_bf16 v[252:255], v[40:43], a[236:239], v[252:255]
  v_cvt_pk_bf16_f32 v168, v176, v177
  v_xor_b32 v214, v214, v12
  v_mfma_f32_16x16x32_bf16 v[252:255], v[44:47], a[252:255], v[252:255]
  ds_read_b64_tr_b16 v[40:41], v2 offset:24576
  v_cvt_pk_bf16_f32 v169, v178, v179
  v_mfma_f32_16x16x32_bf16 v[64:67], v[48:51], a[160:163], v[64:67]
  v_cvt_pk_bf16_f32 v170, v180, v181
  v_xor_b32 v206, v198, v10
  v_mfma_f32_16x16x32_bf16 v[64:67], v[52:55], a[176:179], v[64:67]
  ds_read_b64_tr_b16 v[42:43], v2 offset:26624
  v_cvt_pk_bf16_f32 v171, v182, v183
  v_mfma_f32_16x16x32_bf16 v[68:71], v[48:51], a[164:167], v[68:71]
  v_xor_b32 v222, v214, v10
  v_mul_u32_u24 v207, v9, v207
  v_mfma_f32_16x16x32_bf16 v[68:71], v[52:55], a[180:183], v[68:71]
  ds_read_b64_tr_b16 v[44:45], v2 offset:28672
  v_cvt_pk_bf16_f32 v172, v184, v185
  v_mfma_f32_16x16x32_bf16 v[72:75], v[48:51], a[168:171], v[72:75]
  buffer_store_dwordx4 v[164:167], v21, s[48:51], s81 offen offset:1024 sc1
  v_mfma_f32_16x16x32_bf16 v[72:75], v[52:55], a[184:187], v[72:75]
  ds_read_b64_tr_b16 v[46:47], v2 offset:30720
  s_add_u32 s81, s81, 16384
  v_mfma_f32_16x16x32_bf16 v[76:79], v[48:51], a[172:175], v[76:79]
  s_waitcnt vmcnt(14)
  s_barrier
  v_mfma_f32_16x16x32_bf16 v[76:79], v[52:55], a[188:191], v[76:79]
  ds_read_b64_tr_b16 v[48:49], v1 offset:0
  s_waitcnt lgkmcnt(5)
  v_mfma_f32_16x16x32_bf16 v[80:83], v[56:59], a[160:163], v[80:83]
  v_cvt_pk_bf16_f32 v173, v186, v187
  v_cvt_f32_u32 v207, v207
  v_mfma_f32_16x16x32_bf16 v[80:83], v[60:63], a[176:179], v[80:83]
  ds_read_b64_tr_b16 v[50:51], v1 offset:2048
  v_cvt_pk_bf16_f32 v174, v188, v189
  v_mfma_f32_16x16x32_bf16 v[84:87], v[56:59], a[164:167], v[84:87]
  v_cvt_pk_bf16_f32 v175, v190, v191
  v_mul_f32 v207, 0x3c800000, v207
  v_mfma_f32_16x16x32_bf16 v[84:87], v[60:63], a[180:183], v[84:87]
  ds_read_b64_tr_b16 v[52:53], v1 offset:4096
  v_mfma_f32_16x16x32_bf16 v[88:91], v[56:59], a[168:171], v[88:91]
  v_sin_f32 v223, v207
  v_mfma_f32_16x16x32_bf16 v[88:91], v[60:63], a[184:187], v[88:91]
  ds_read_b64_tr_b16 v[54:55], v1 offset:6144
  v_cvt_pk_bf16_f32 v224, v224, v225
  v_mfma_f32_16x16x32_bf16 v[92:95], v[56:59], a[172:175], v[92:95]
  buffer_store_dwordx4 v[168:171], v21, s[48:51], s81 offen offset:0 sc1
  v_mfma_f32_16x16x32_bf16 v[92:95], v[60:63], a[188:191], v[92:95]
  ds_read_b64_tr_b16 v[56:57], v2 offset:0
  v_cvt_pk_bf16_f32 v225, v226, v227
  v_mfma_f32_16x16x32_bf16 v[64:67], v[32:35], a[192:195], v[64:67]
  v_cos_f32 v207, v207
  v_mfma_f32_16x16x32_bf16 v[64:67], v[36:39], a[208:211], v[64:67]
  ds_read_b64_tr_b16 v[58:59], v2 offset:2048
  v_cvt_pk_bf16_f32 v226, v228, v229
  v_mfma_f32_16x16x32_bf16 v[68:71], v[32:35], a[196:199], v[68:71]
  v_cvt_pk_bf16_f32 v227, v230, v231
  v_cvt_pk_bf16_f32 v195, v207, v223
  v_mfma_f32_16x16x32_bf16 v[68:71], v[36:39], a[212:215], v[68:71]
  ds_read_b64_tr_b16 v[60:61], v2 offset:4096
  v_cvt_pk_bf16_f32 v211, -v223, v207
  v_mfma_f32_16x16x32_bf16 v[72:75], v[32:35], a[200:203], v[72:75]
  v_cvt_pk_bf16_f32 v228, v232, v233
  v_add_u32 v180, 0, v7
  v_mfma_f32_16x16x32_bf16 v[72:75], v[36:39], a[216:219], v[72:75]
  ds_read_b64_tr_b16 v[62:63], v2 offset:6144
  v_cvt_pk_bf16_f32 v229, v234, v235
  v_mfma_f32_16x16x32_bf16 v[76:79], v[32:35], a[204:207], v[76:79]
  v_cvt_pk_bf16_f32 v230, v236, v237
  v_lshl_add_u32 v176, s64, 4, v8
  v_mfma_f32_16x16x32_bf16 v[76:79], v[36:39], a[220:223], v[76:79]
  ds_read_b64_tr_b16 v[32:33], v23 offset:8192
  s_waitcnt lgkmcnt(5)
  v_mfma_f32_16x16x32_bf16 v[80:83], v[40:43], a[192:195], v[80:83]
  v_cvt_pk_bf16_f32 v231, v238, v239
  v_cvt_f32_u32 v180, v180
  v_mfma_f32_16x16x32_bf16 v[80:83], v[44:47], a[208:211], v[80:83]
  ds_read_b64_tr_b16 v[34:35], v23 offset:10240
  v_cvt_f32_u32 v176, v176
  v_mfma_f32_16x16x32_bf16 v[84:87], v[40:43], a[196:199], v[84:87]
  buffer_store_dwordx4 v[172:175], v21, s[48:51], s81 offen offset:1024 sc1
  v_mfma_f32_16x16x32_bf16 v[84:87], v[44:47], a[212:215], v[84:87]
  ds_read_b64_tr_b16 v[36:37], v23 offset:12288
  s_add_u32 s81, s81, 49152
  v_mfma_f32_16x16x32_bf16 v[88:91], v[40:43], a[200:203], v[88:91]
  v_cvt_pk_bf16_f32 v232, v240, v241
  v_mul_f32 v180, 0x3a000000, v180
  v_mfma_f32_16x16x32_bf16 v[88:91], v[44:47], a[216:219], v[88:91]
  ds_read_b64_tr_b16 v[38:39], v23 offset:14336
  v_cvt_pk_bf16_f32 v233, v242, v243
  v_mfma_f32_16x16x32_bf16 v[92:95], v[40:43], a[204:207], v[92:95]
  s_waitcnt vmcnt(12)
  s_barrier
  v_mfma_f32_16x16x32_bf16 v[92:95], v[44:47], a[220:223], v[92:95]
  ds_read_b64_tr_b16 v[40:41], v5 offset:0
  v_cvt_pk_bf16_f32 v234, v244, v245
  v_mfma_f32_16x16x32_bf16 v[64:67], v[48:51], a[224:227], v[64:67]
  v_cvt_pk_bf16_f32 v235, v246, v247
  v_cvt_pk_bf16_f32 v236, v248, v249
  v_cvt_pk_bf16_f32 v237, v250, v251
  v_cvt_pk_bf16_f32 v238, v252, v253
  v_cvt_pk_bf16_f32 v239, v254, v255
  v_mfma_f32_16x16x32_bf16 v[64:67], v[52:55], a[240:243], v[64:67]
  ds_read_b64_tr_b16 v[42:43], v5 offset:2048
  v_mul_f32 v176, v176, v180
  v_mfma_f32_16x16x32_bf16 v[68:71], v[48:51], a[228:231], v[68:71]
  v_add_f32 v177, v176, v180
  v_add_u32 v188, 16, v7
  v_mfma_f32_16x16x32_bf16 v[68:71], v[52:55], a[244:247], v[68:71]
  ds_read_b64_tr_b16 v[44:45], v5 offset:4096
  v_fma_f32 v178, 2.0, v180, v176
  v_mfma_f32_16x16x32_bf16 v[72:75], v[48:51], a[232:235], v[72:75]
  buffer_store_dwordx4 v[224:227], v21, s[48:51], s81 offen offset:0 sc1
  v_mfma_f32_16x16x32_bf16 v[72:75], v[52:55], a[248:251], v[72:75]
  ds_read_b64_tr_b16 v[46:47], v5 offset:6144
  v_fma_f32 v179, 2.0, v180, v177
  v_mfma_f32_16x16x32_bf16 v[76:79], v[48:51], a[236:239], v[76:79]
  v_sin_f32 v180, v176
  v_mfma_f32_16x16x32_bf16 v[76:79], v[52:55], a[252:255], v[76:79]
  ds_read_b64_tr_b16 v[48:49], v6 offset:0
  s_waitcnt lgkmcnt(5)
  v_mfma_f32_16x16x32_bf16 v[80:83], v[56:59], a[224:227], v[80:83]
  v_cos_f32 v176, v176
  v_mfma_f32_16x16x32_bf16 v[80:83], v[60:63], a[240:243], v[80:83]
  ds_read_b64_tr_b16 v[50:51], v6 offset:2048
  v_lshl_add_u32 v184, s64, 4, v8
  v_mfma_f32_16x16x32_bf16 v[84:87], v[56:59], a[228:231], v[84:87]
  v_sin_f32 v181, v177
  v_mfma_f32_16x16x32_bf16 v[84:87], v[60:63], a[244:247], v[84:87]
  ds_read_b64_tr_b16 v[52:53], v6 offset:4096
  v_cvt_f32_u32 v188, v188
  v_mfma_f32_16x16x32_bf16 v[88:91], v[56:59], a[232:235], v[88:91]
  v_cos_f32 v177, v177
  v_mfma_f32_16x16x32_bf16 v[88:91], v[60:63], a[248:251], v[88:91]
  ds_read_b64_tr_b16 v[54:55], v6 offset:6144
  v_cvt_f32_u32 v184, v184
  v_mfma_f32_16x16x32_bf16 v[92:95], v[56:59], a[236:239], v[92:95]
  v_sin_f32 v182, v178
  v_mfma_f32_16x16x32_bf16 v[92:95], v[60:63], a[252:255], v[92:95]
  ds_read_b64_tr_b16 v[56:57], v25 offset:8192
  v_mul_f32 v188, 0x3a000000, v188
  v_mfma_f32_16x16x32_bf16 v[128:131], v[32:35], a[160:163], v[128:131]
  buffer_store_dwordx4 v[228:231], v21, s[48:51], s81 offen offset:1024 sc1
  v_mfma_f32_16x16x32_bf16 v[128:131], v[36:39], a[176:179], v[128:131]
  ds_read_b64_tr_b16 v[58:59], v25 offset:10240
  s_add_u32 s81, s81, 16384
  v_mfma_f32_16x16x32_bf16 v[132:135], v[32:35], a[164:167], v[132:135]
  v_cos_f32 v178, v178
  v_mfma_f32_16x16x32_bf16 v[132:135], v[36:39], a[180:183], v[132:135]
  ds_read_b64_tr_b16 v[60:61], v25 offset:12288
  v_cvt_pk_bf16_f32 v64, v64, v65
  v_mfma_f32_16x16x32_bf16 v[136:139], v[32:35], a[168:171], v[136:139]
  v_sin_f32 v183, v179
  v_mfma_f32_16x16x32_bf16 v[136:139], v[36:39], a[184:187], v[136:139]
  ds_read_b64_tr_b16 v[62:63], v25 offset:14336
  v_cvt_pk_bf16_f32 v65, v66, v67
  v_mfma_f32_16x16x32_bf16 v[140:143], v[32:35], a[172:175], v[140:143]
  s_waitcnt vmcnt(10)
  s_barrier
  v_mfma_f32_16x16x32_bf16 v[140:143], v[36:39], a[188:191], v[140:143]
  ds_read_b64_tr_b16 v[32:33], v5 offset:16384
  s_waitcnt lgkmcnt(5)
  v_mfma_f32_16x16x32_bf16 v[96:99], v[40:43], a[160:163], v[96:99]
  v_cos_f32 v179, v179
  v_mfma_f32_16x16x32_bf16 v[96:99], v[44:47], a[176:179], v[96:99]
  ds_read_b64_tr_b16 v[34:35], v5 offset:18432
  v_cvt_pk_bf16_f32 v66, v68, v69
  v_mfma_f32_16x16x32_bf16 v[100:103], v[40:43], a[164:167], v[100:103]
  buffer_store_dwordx4 v[232:235], v21, s[48:51], s81 offen offset:0 sc1
  v_mfma_f32_16x16x32_bf16 v[100:103], v[44:47], a[180:183], v[100:103]
  ds_read_b64_tr_b16 v[36:37], v5 offset:20480
  v_cvt_pk_bf16_f32 v67, v70, v71
  v_mfma_f32_16x16x32_bf16 v[104:107], v[40:43], a[168:171], v[104:107]
  v_mul_f32 v184, v184, v188
  v_add_f32 v185, v184, v188
  v_fma_f32 v186, 2.0, v188, v184
  v_fma_f32 v187, 2.0, v188, v185
  v_sin_f32 v188, v184
  v_cos_f32 v184, v184
  v_sin_f32 v189, v185
  v_cos_f32 v185, v185
  v_sin_f32 v190, v186
  v_cos_f32 v186, v186
  v_sin_f32 v191, v187
  v_cos_f32 v187, v187
  v_mfma_f32_16x16x32_bf16 v[104:107], v[44:47], a[184:187], v[104:107]
  v_xor_b32 v203, v195, v10
  ds_read_b64_tr_b16 v[38:39], v5 offset:22528
  v_mfma_f32_16x16x32_bf16 v[108:111], v[40:43], a[172:175], v[108:111]
  v_xor_b32 v219, v211, v10
  v_accvgpr_read_b32 v160, a72
  v_mfma_f32_16x16x32_bf16 v[108:111], v[44:47], a[188:191], v[108:111]
  ds_read_b64_tr_b16 v[40:41], v6 offset:16384
  v_cvt_pk_bf16_f32 v68, v72, v73
  v_mfma_f32_16x16x32_bf16 v[112:115], v[48:51], a[160:163], v[112:115]
  v_cvt_pk_bf16_f32 v69, v74, v75
  v_cndmask_b32 v199, v195, v211, s[22:23]
  v_mfma_f32_16x16x32_bf16 v[112:115], v[52:55], a[176:179], v[112:115]
  ds_read_b64_tr_b16 v[42:43], v6 offset:18432
  v_cvt_pk_bf16_f32 v70, v76, v77
  v_mfma_f32_16x16x32_bf16 v[116:119], v[48:51], a[164:167], v[116:119]
  v_cvt_pk_bf16_f32 v71, v78, v79
  v_cndmask_b32 v215, v211, v195, s[22:23]
  v_mfma_f32_16x16x32_bf16 v[116:119], v[52:55], a[180:183], v[116:119]
  ds_read_b64_tr_b16 v[44:45], v6 offset:20480
  v_xor_b32 v199, v199, v11
  v_mfma_f32_16x16x32_bf16 v[120:123], v[48:51], a[168:171], v[120:123]
  v_cvt_pk_bf16_f32 v72, v80, v81
  v_xor_b32 v215, v215, v12
  v_mfma_f32_16x16x32_bf16 v[120:123], v[52:55], a[184:187], v[120:123]
  ds_read_b64_tr_b16 v[46:47], v6 offset:22528
  v_cvt_pk_bf16_f32 v73, v82, v83
  v_mfma_f32_16x16x32_bf16 v[124:127], v[48:51], a[172:175], v[124:127]
  buffer_store_dwordx4 v[236:239], v21, s[48:51], s81 offen offset:1024 sc1
  v_mfma_f32_16x16x32_bf16 v[124:127], v[52:55], a[188:191], v[124:127]
  ds_read_b64_tr_b16 v[48:49], v25 offset:24576
  s_waitcnt lgkmcnt(5)
  v_mfma_f32_16x16x32_bf16 v[128:131], v[56:59], a[192:195], v[128:131]
  s_add_u32 s81, s81, 49152
  v_cvt_pk_bf16_f32 v74, v84, v85
  v_mfma_f32_16x16x32_bf16 v[128:131], v[60:63], a[208:211], v[128:131]
  ds_read_b64_tr_b16 v[50:51], v25 offset:26624
  v_cvt_pk_bf16_f32 v75, v86, v87
  v_mfma_f32_16x16x32_bf16 v[132:135], v[56:59], a[196:199], v[132:135]
  v_xor_b32 v207, v199, v10
  v_and_b32 v168, 0xffff0000, v160
  v_mfma_f32_16x16x32_bf16 v[132:135], v[60:63], a[212:215], v[132:135]
  ds_read_b64_tr_b16 v[52:53], v25 offset:28672
  v_cvt_pk_bf16_f32 v76, v88, v89
  v_mfma_f32_16x16x32_bf16 v[136:139], v[56:59], a[200:203], v[136:139]
  v_cvt_pk_bf16_f32 v77, v90, v91
  v_xor_b32 v223, v215, v10
  v_mfma_f32_16x16x32_bf16 v[136:139], v[60:63], a[216:219], v[136:139]
  ds_read_b64_tr_b16 v[54:55], v25 offset:30720
  v_cvt_pk_bf16_f32 v78, v92, v93
  v_mfma_f32_16x16x32_bf16 v[140:143], v[56:59], a[204:207], v[140:143]
  s_waitcnt vmcnt(8)
  s_barrier
  v_mfma_f32_16x16x32_bf16 v[140:143], v[60:63], a[220:223], v[140:143]
  ds_read_b64_tr_b16 v[56:57], v1 offset:49152
  v_cvt_pk_bf16_f32 v79, v94, v95
  v_mfma_f32_16x16x32_bf16 v[96:99], v[32:35], a[192:195], v[96:99]
  buffer_store_dwordx4 v[64:67], v21, s[48:51], s81 offen offset:0 sc1
  v_mfma_f32_16x16x32_bf16 v[96:99], v[36:39], a[208:211], v[96:99]
  ds_read_b64_tr_b16 v[58:59], v1 offset:51200
  v_lshlrev_b32 v160, 16, v160
  v_mfma_f32_16x16x32_bf16 v[100:103], v[32:35], a[196:199], v[100:103]
  v_accvgpr_read_b32 v161, a73
  v_accvgpr_read_b32 v162, a74
  v_mfma_f32_16x16x32_bf16 v[100:103], v[36:39], a[212:215], v[100:103]
  ds_read_b64_tr_b16 v[60:61], v1 offset:53248
  v_and_b32 v169, 0xffff0000, v161
  v_mfma_f32_16x16x32_bf16 v[104:107], v[32:35], a[200:203], v[104:107]
  v_lshlrev_b32 v161, 16, v161
  v_and_b32 v170, 0xffff0000, v162
  v_mfma_f32_16x16x32_bf16 v[104:107], v[36:39], a[216:219], v[104:107]
  ds_read_b64_tr_b16 v[62:63], v1 offset:55296
  v_lshlrev_b32 v162, 16, v162
  v_mfma_f32_16x16x32_bf16 v[108:111], v[32:35], a[204:207], v[108:111]
  v_accvgpr_read_b32 v163, a75
  v_accvgpr_read_b32 v164, a76
  v_mfma_f32_16x16x32_bf16 v[108:111], v[36:39], a[220:223], v[108:111]
  ds_read_b64_tr_b16 v[32:33], v2 offset:49152
  s_waitcnt lgkmcnt(5)
  v_mfma_f32_16x16x32_bf16 v[112:115], v[40:43], a[192:195], v[112:115]
  v_and_b32 v171, 0xffff0000, v163
  v_and_b32 v172, 0xffff0000, v164
  v_mfma_f32_16x16x32_bf16 v[112:115], v[44:47], a[208:211], v[112:115]
  ds_read_b64_tr_b16 v[34:35], v2 offset:51200
  v_lshlrev_b32 v163, 16, v163
  v_mfma_f32_16x16x32_bf16 v[116:119], v[40:43], a[196:199], v[116:119]
  v_lshlrev_b32 v164, 16, v164
  v_accvgpr_read_b32 v165, a77
  v_mfma_f32_16x16x32_bf16 v[116:119], v[44:47], a[212:215], v[116:119]
  ds_read_b64_tr_b16 v[36:37], v2 offset:53248
  v_and_b32 v173, 0xffff0000, v165
  v_mfma_f32_16x16x32_bf16 v[120:123], v[40:43], a[200:203], v[120:123]
  buffer_store_dwordx4 v[68:71], v21, s[48:51], s81 offen offset:1024 sc1
  v_mfma_f32_16x16x32_bf16 v[120:123], v[44:47], a[216:219], v[120:123]
  ds_read_b64_tr_b16 v[38:39], v2 offset:55296
  s_add_u32 s81, s81, 16384
  v_mfma_f32_16x16x32_bf16 v[124:127], v[40:43], a[204:207], v[124:127]
  v_lshlrev_b32 v165, 16, v165
  v_accvgpr_read_b32 v166, a78
  v_mfma_f32_16x16x32_bf16 v[124:127], v[44:47], a[220:223], v[124:127]
  v_and_b32 v174, 0xffff0000, v166
  v_accvgpr_read_b32 v167, a79
  v_mfma_f32_16x16x32_bf16 v[128:131], v[48:51], a[224:227], v[128:131]
  v_lshlrev_b32 v166, 16, v166
  v_and_b32 v175, 0xffff0000, v167
  v_mfma_f32_16x16x32_bf16 v[128:131], v[52:55], a[240:243], v[128:131]
  v_lshlrev_b32 v167, 16, v167
  v_accvgpr_read_b32 v224, a64
  v_mfma_f32_16x16x32_bf16 v[132:135], v[48:51], a[228:231], v[132:135]
  v_and_b32 v232, 0xffff0000, v224
  v_accvgpr_read_b32 v225, a65
  v_mfma_f32_16x16x32_bf16 v[132:135], v[52:55], a[244:247], v[132:135]
  v_lshlrev_b32 v224, 16, v224
  v_and_b32 v233, 0xffff0000, v225
  v_mfma_f32_16x16x32_bf16 v[136:139], v[48:51], a[232:235], v[136:139]
  v_lshlrev_b32 v225, 16, v225
  v_accvgpr_read_b32 v226, a66
  v_mfma_f32_16x16x32_bf16 v[136:139], v[52:55], a[248:251], v[136:139]
  v_and_b32 v234, 0xffff0000, v226
  v_accvgpr_read_b32 v227, a67
  v_mfma_f32_16x16x32_bf16 v[140:143], v[48:51], a[236:239], v[140:143]
  buffer_store_dwordx4 v[72:75], v21, s[48:51], s81 offen offset:0 sc1
  v_mfma_f32_16x16x32_bf16 v[140:143], v[52:55], a[252:255], v[140:143]
  v_lshlrev_b32 v226, 16, v226
  s_waitcnt lgkmcnt(4)
  v_mfma_f32_16x16x32_bf16 v[96:99], v[56:59], a[224:227], v[96:99]
  v_and_b32 v235, 0xffff0000, v227
  v_accvgpr_read_b32 v228, a68
  v_mfma_f32_16x16x32_bf16 v[96:99], v[60:63], a[240:243], v[96:99]
  v_lshlrev_b32 v227, 16, v227
  v_and_b32 v236, 0xffff0000, v228
  v_mfma_f32_16x16x32_bf16 v[100:103], v[56:59], a[228:231], v[100:103]
  v_lshlrev_b32 v228, 16, v228
  v_accvgpr_read_b32 v229, a69
  v_mfma_f32_16x16x32_bf16 v[100:103], v[60:63], a[244:247], v[100:103]
  v_and_b32 v237, 0xffff0000, v229
  v_accvgpr_read_b32 v230, a70
  v_mfma_f32_16x16x32_bf16 v[104:107], v[56:59], a[232:235], v[104:107]
  v_lshlrev_b32 v229, 16, v229
  v_and_b32 v238, 0xffff0000, v230
  v_mfma_f32_16x16x32_bf16 v[104:107], v[60:63], a[248:251], v[104:107]
  v_lshlrev_b32 v230, 16, v230
  v_accvgpr_read_b32 v231, a71
  v_mfma_f32_16x16x32_bf16 v[108:111], v[56:59], a[236:239], v[108:111]
  v_and_b32 v239, 0xffff0000, v231
  v_mfma_f32_16x16x32_bf16 v[108:111], v[60:63], a[252:255], v[108:111]
  v_lshlrev_b32 v231, 16, v231
  s_waitcnt lgkmcnt(2)
  v_mfma_f32_16x16x32_bf16 v[112:115], v[32:35], a[224:227], v[112:115]
  s_waitcnt lgkmcnt(0)
  v_mfma_f32_16x16x32_bf16 v[112:115], v[36:39], a[240:243], v[112:115]
  buffer_store_dwordx4 v[76:79], v21, s[48:51], s81 offen offset:1024 sc1
  v_mfma_f32_16x16x32_bf16 v[116:119], v[32:35], a[228:231], v[116:119]
  s_add_u32 s81, s81, 49152
  v_mfma_f32_16x16x32_bf16 v[116:119], v[36:39], a[244:247], v[116:119]
  v_mfma_f32_16x16x32_bf16 v[120:123], v[32:35], a[232:235], v[120:123]
  v_mfma_f32_16x16x32_bf16 v[120:123], v[36:39], a[248:251], v[120:123]
  v_mfma_f32_16x16x32_bf16 v[124:127], v[32:35], a[236:239], v[124:127]
  v_mfma_f32_16x16x32_bf16 v[124:127], v[36:39], a[252:255], v[124:127]
  v_mfma_f32_16x16x32_bf16 v[48:51], a[32:35], v[192:195], 0
  v_add_u32 v2, 98304, v21
  s_lshl_b32 s86, s64, 11
  v_mfma_f32_16x16x32_bf16 v[52:55], a[32:35], v[208:211], 0
  v_add_u32 v1, s86, v2
  v_bfe_u32 v3, v21, 6, 2
  v_mfma_f32_16x16x32_bf16 v[56:59], a[48:51], v[192:195], 0
  v_mul_u32_u24 v3, 147456, v3
  v_lshrrev_b32 v4, 8, v21
  v_mfma_f32_16x16x32_bf16 v[60:63], a[48:51], v[208:211], 0
  v_lshl_add_u32 v3, v4, 5, v3
  v_and_b32 v4, 0x10, v21
  v_mfma_f32_16x16x32_bf16 v[48:51], a[36:39], v[196:199], v[48:51]
  v_add_u32 v3, v3, v4
  v_bfe_u32 v4, v21, 5, 1
  v_mfma_f32_16x16x32_bf16 v[52:55], a[36:39], v[212:215], v[52:55]
  v_mul_u32_u24 v4, 36864, v4
  v_add_u32 v3, v3, v4
  v_mfma_f32_16x16x32_bf16 v[56:59], a[52:55], v[196:199], v[56:59]
  s_add_u32 s85, s2, 255
  s_bfe_u32 s84, s85, 0x10002
  v_mfma_f32_16x16x32_bf16 v[60:63], a[52:55], v[212:215], v[60:63]
  s_lshl_b32 s84, s84, 4
  v_xor_b32 v5, s84, v3
  v_mfma_f32_16x16x32_bf16 v[48:51], a[40:43], v[200:203], v[48:51]
  v_cvt_pk_bf16_f32 v96, v96, v97
  v_cvt_pk_bf16_f32 v97, v98, v99
  v_cvt_pk_bf16_f32 v98, v100, v101
  v_cvt_pk_bf16_f32 v99, v102, v103
  buffer_store_dwordx4 v[96:99], v21, s[48:51], s81 offen offset:0 sc1
  s_bfe_u32 s84, s2, 0x10002
  s_lshl_b32 s84, s84, 4
  v_mfma_f32_16x16x32_bf16 v[52:55], a[40:43], v[216:219], v[52:55]
  v_xor_b32 v3, s84, v3
  v_mfma_f32_16x16x32_bf16 v[56:59], a[56:59], v[200:203], v[56:59]
  v_mfma_f32_16x16x32_bf16 v[60:63], a[56:59], v[216:219], v[60:63]
  v_mfma_f32_16x16x32_bf16 v[48:51], a[44:47], v[204:207], v[48:51]
  v_mfma_f32_16x16x32_bf16 v[52:55], a[44:47], v[220:223], v[52:55]
  v_mfma_f32_16x16x32_bf16 v[56:59], a[60:63], v[204:207], v[56:59]
  v_mfma_f32_16x16x32_bf16 v[60:63], a[60:63], v[220:223], v[60:63]
  v_mfma_f32_16x16x32_bf16 v[32:35], a[0:3], v[192:195], 0
  s_nop 3
  v_mul_f32 v80, v48, v144
  v_mul_f32 v82, v52, v144
  v_fmac_f32 v80, v52, v148
  v_mfma_f32_16x16x32_bf16 v[36:39], a[0:3], v[208:211], 0
  v_fma_f32 v82, -v48, v148, v82
  v_mul_f32 v81, v49, v145
  v_mul_f32 v83, v53, v145
  v_mfma_f32_16x16x32_bf16 v[40:43], a[16:19], v[192:195], 0
  v_fmac_f32 v81, v53, v149
  v_fma_f32 v83, -v49, v149, v83
  v_cvt_pk_bf16_f32 v248, v80, v82
  v_mfma_f32_16x16x32_bf16 v[44:47], a[16:19], v[208:211], 0
  v_cvt_pk_bf16_f32 v249, v81, v83
  v_mul_f32 v84, v50, v146
  v_mul_f32 v86, v54, v146
  v_cvt_pk_bf16_f32 v100, v104, v105
  v_cvt_pk_bf16_f32 v101, v106, v107
  v_cvt_pk_bf16_f32 v102, v108, v109
  v_cvt_pk_bf16_f32 v103, v110, v111
  buffer_store_dwordx4 v[100:103], v21, s[48:51], s81 offen offset:1024 sc1
  v_mfma_f32_16x16x32_bf16 v[32:35], a[4:7], v[196:199], v[32:35]
  v_fmac_f32 v84, v54, v150
  v_fma_f32 v86, -v50, v150, v86
  v_mul_f32 v85, v51, v147
  v_mfma_f32_16x16x32_bf16 v[36:39], a[4:7], v[212:215], v[36:39]
  v_mul_f32 v87, v55, v147
  v_fmac_f32 v85, v55, v151
  v_fma_f32 v87, -v51, v151, v87
  v_mfma_f32_16x16x32_bf16 v[40:43], a[20:23], v[196:199], v[40:43]
  v_cvt_pk_bf16_f32 v250, v84, v86
  v_cvt_pk_bf16_f32 v251, v85, v87
  v_mul_f32 v80, v56, v152
  v_mfma_f32_16x16x32_bf16 v[44:47], a[20:23], v[212:215], v[44:47]
  v_mul_f32 v82, v60, v152
  v_fmac_f32 v80, v60, v156
  v_fma_f32 v82, -v56, v156, v82
  v_mfma_f32_16x16x32_bf16 v[32:35], a[8:11], v[200:203], v[32:35]
  v_mul_f32 v81, v57, v153
  v_mul_f32 v83, v61, v153
  v_fmac_f32 v81, v61, v157
  v_mfma_f32_16x16x32_bf16 v[36:39], a[8:11], v[216:219], v[36:39]
  v_fma_f32 v83, -v57, v157, v83
k1_pg10:
  s_cbranch_execz k1_wback
  v_cvt_pk_bf16_f32 v252, v80, v82
  v_cvt_pk_bf16_f32 v253, v81, v83
  v_mfma_f32_16x16x32_bf16 v[40:43], a[24:27], v[200:203], v[40:43]
  v_mul_f32 v84, v58, v154
  s_add_u32 s81, s81, 16384
  v_cvt_pk_bf16_f32 v104, v112, v113
  v_cvt_pk_bf16_f32 v105, v114, v115
  v_cvt_pk_bf16_f32 v106, v116, v117
  v_cvt_pk_bf16_f32 v107, v118, v119
  buffer_store_dwordx4 v[104:107], v21, s[48:51], s81 offen offset:0 sc1
  v_mul_f32 v86, v62, v154
  v_fmac_f32 v84, v62, v158
  v_mfma_f32_16x16x32_bf16 v[44:47], a[24:27], v[216:219], v[44:47]
  v_fma_f32 v86, -v58, v158, v86
  v_mul_f32 v85, v59, v155
  v_mul_f32 v87, v63, v155
  v_mfma_f32_16x16x32_bf16 v[32:35], a[12:15], v[204:207], v[32:35]
  v_fmac_f32 v85, v63, v159
  v_fma_f32 v87, -v59, v159, v87
  v_cvt_pk_bf16_f32 v254, v84, v86
  v_mfma_f32_16x16x32_bf16 v[36:39], a[12:15], v[220:223], v[36:39]
  v_cvt_pk_bf16_f32 v255, v85, v87
  v_mfma_f32_16x16x32_bf16 v[40:43], a[28:31], v[204:207], v[40:43]
  v_mfma_f32_16x16x32_bf16 v[44:47], a[28:31], v[220:223], v[44:47]
  v_mfma_f32_16x16x32_bf16 v[48:51], a[80:83], v[248:251], 0
  v_mul_f32 v80, v32, v144
  s_nop 2
  v_mul_f32 v82, v36, v144
  v_fmac_f32 v80, v36, v148
  v_fma_f32 v82, -v32, v148, v82
  v_mul_f32 v81, v33, v145
  v_mfma_f32_16x16x32_bf16 v[52:55], a[96:99], v[248:251], 0
  v_mul_f32 v83, v37, v145
  v_fmac_f32 v81, v37, v149
  v_fma_f32 v83, -v33, v149, v83
  v_cvt_pk_bf16_f32 v240, v80, v82
  v_cvt_pk_bf16_f32 v241, v81, v83
  v_cvt_pk_bf16_f32 v108, v120, v121
  v_cvt_pk_bf16_f32 v109, v122, v123
  v_cvt_pk_bf16_f32 v110, v124, v125
  v_cvt_pk_bf16_f32 v111, v126, v127
  buffer_store_dwordx4 v[108:111], v21, s[48:51], s81 offen offset:1024 sc1
  v_mfma_f32_16x16x32_bf16 v[56:59], a[88:91], v[248:251], 0
  v_mul_f32 v84, v34, v146
  v_mul_f32 v86, v38, v146
  v_fmac_f32 v84, v38, v150
  v_fma_f32 v86, -v34, v150, v86
  v_mul_f32 v85, v35, v147
  v_mfma_f32_16x16x32_bf16 v[60:63], a[104:107], v[248:251], 0
  v_mul_f32 v87, v39, v147
  v_fmac_f32 v85, v39, v151
  v_fma_f32 v87, -v35, v151, v87
  v_cvt_pk_bf16_f32 v242, v84, v86
  v_cvt_pk_bf16_f32 v243, v85, v87
  v_mfma_f32_16x16x32_bf16 v[48:51], a[84:87], v[252:255], v[48:51]
  v_mul_f32 v80, v40, v152
  v_mul_f32 v82, v44, v152
  v_fmac_f32 v80, v44, v156
  v_fma_f32 v82, -v40, v156, v82
  v_mul_f32 v81, v41, v153
  v_mfma_f32_16x16x32_bf16 v[52:55], a[100:103], v[252:255], v[52:55]
  v_mul_f32 v83, v45, v153
  v_fmac_f32 v81, v45, v157
  v_fma_f32 v83, -v41, v157, v83
  v_cvt_pk_bf16_f32 v244, v80, v82
  v_cvt_pk_bf16_f32 v245, v81, v83
  v_mfma_f32_16x16x32_bf16 v[56:59], a[92:95], v[252:255], v[56:59]
  v_mul_f32 v84, v42, v154
  v_cvt_pk_bf16_f32 v128, v128, v129
  v_cvt_pk_bf16_f32 v129, v130, v131
  v_cvt_pk_bf16_f32 v130, v132, v133
  v_cvt_pk_bf16_f32 v131, v134, v135
  s_mov_b32 s81, s28
  buffer_store_dwordx4 v[128:131], v21, s[48:51], s81 offen offset:0 sc1
  v_mul_f32 v86, v46, v154
  v_fmac_f32 v84, v46, v158
  v_fma_f32 v86, -v42, v158, v86
  v_mul_f32 v85, v43, v155
  v_mfma_f32_16x16x32_bf16 v[60:63], a[108:111], v[252:255], v[60:63]
  v_mul_f32 v87, v47, v155
  v_fmac_f32 v85, v47, v159
  v_fma_f32 v87, -v43, v159, v87
  v_cvt_pk_bf16_f32 v246, v84, v86
  v_cvt_pk_bf16_f32 v247, v85, v87
  v_mfma_f32_16x16x32_bf16 v[32:35], a[80:83], v[240:243], 0
  v_mul_f32 v80, v48, v160
  v_mul_f32 v82, v52, v160
  v_fma_f32 v80, -v52, v168, v80
  v_fmac_f32 v82, v48, v168
  v_mul_f32 v81, v49, v161
  v_mfma_f32_16x16x32_bf16 v[36:39], a[96:99], v[240:243], 0
  v_mul_f32 v83, v53, v161
  v_fma_f32 v81, -v53, v169, v81
  v_fmac_f32 v83, v49, v169
  v_cvt_pk_bf16_f32 v248, v80, -v82
  v_cvt_pk_bf16_f32 v249, v81, -v83
  v_mfma_f32_16x16x32_bf16 v[40:43], a[88:91], v[240:243], 0
  v_mul_f32 v84, v50, v162
  v_mul_f32 v86, v54, v162
  v_fma_f32 v84, -v54, v170, v84
  v_cvt_pk_bf16_f32 v132, v136, v137
  v_cvt_pk_bf16_f32 v133, v138, v139
  v_cvt_pk_bf16_f32 v134, v140, v141
  v_cvt_pk_bf16_f32 v135, v142, v143
  buffer_store_dwordx4 v[132:135], v21, s[48:51], s81 offen offset:1024 sc1
  v_fmac_f32 v86, v50, v170
  v_mul_f32 v85, v51, v163
  v_mfma_f32_16x16x32_bf16 v[44:47], a[104:107], v[240:243], 0
  v_mul_f32 v87, v55, v163
  v_fma_f32 v85, -v55, v171, v85
  v_fmac_f32 v87, v51, v171
  v_cvt_pk_bf16_f32 v250, v84, -v86
  v_cvt_pk_bf16_f32 v251, v85, -v87
  v_mfma_f32_16x16x32_bf16 v[32:35], a[84:87], v[244:247], v[32:35]
  v_mul_f32 v80, v56, v164
  v_mul_f32 v82, v60, v164
  v_fma_f32 v80, -v60, v172, v80
  v_fmac_f32 v82, v56, v172
  v_mul_f32 v81, v57, v165
  v_mfma_f32_16x16x32_bf16 v[36:39], a[100:103], v[244:247], v[36:39]
  v_mul_f32 v83, v61, v165
  v_fma_f32 v81, -v61, v173, v81
  v_fmac_f32 v83, v57, v173
  v_cvt_pk_bf16_f32 v252, v80, -v82
  v_cvt_pk_bf16_f32 v253, v81, -v83
  v_mfma_f32_16x16x32_bf16 v[40:43], a[92:95], v[244:247], v[40:43]
  v_mul_f32 v84, v58, v166
  v_mul_f32 v86, v62, v166
  v_fma_f32 v84, -v62, v174, v84
  v_fmac_f32 v86, v58, v174
  v_mul_f32 v85, v59, v167
  v_mfma_f32_16x16x32_bf16 v[44:47], a[108:111], v[244:247], v[44:47]
  v_mul_f32 v87, v63, v167
  v_fma_f32 v85, -v63, v175, v85
  v_fmac_f32 v87, v59, v175
  v_cvt_pk_bf16_f32 v254, v84, -v86
  v_cvt_pk_bf16_f32 v255, v85, -v87
  v_mfma_f32_16x16x32_bf16 v[48:51], v[248:251], a[80:83], 0
  v_mul_f32 v80, v32, v224
  v_mul_f32 v82, v36, v224
  v_fma_f32 v80, -v36, v232, v80
  v_fmac_f32 v82, v32, v232
  v_mul_f32 v81, v33, v225
  v_mfma_f32_16x16x32_bf16 v[52:55], v[248:251], a[96:99], 0
  v_mul_f32 v83, v37, v225
  v_fma_f32 v81, -v37, v233, v81
  v_fmac_f32 v83, v33, v233
  v_cvt_pk_bf16_f32 v240, v80, -v82
  v_cvt_pk_bf16_f32 v241, v81, -v83
  v_mfma_f32_16x16x32_bf16 v[56:59], v[248:251], a[88:91], 0
  v_mul_f32 v84, v34, v226
  v_mul_f32 v86, v38, v226
  v_fma_f32 v84, -v38, v234, v84
  v_fmac_f32 v86, v34, v234
  v_mul_f32 v85, v35, v227
  v_mfma_f32_16x16x32_bf16 v[60:63], v[248:251], a[104:107], 0
  v_mul_f32 v87, v39, v227
  v_fma_f32 v85, -v39, v235, v85
  v_fmac_f32 v87, v35, v235
  v_cvt_pk_bf16_f32 v242, v84, -v86
  v_cvt_pk_bf16_f32 v243, v85, -v87
  v_mfma_f32_16x16x32_bf16 v[48:51], v[252:255], a[84:87], v[48:51]
  v_mul_f32 v80, v40, v228
  v_mul_f32 v82, v44, v228
  v_fma_f32 v80, -v44, v236, v80
  v_fmac_f32 v82, v40, v236
  v_mul_f32 v81, v41, v229
  v_mfma_f32_16x16x32_bf16 v[52:55], v[252:255], a[100:103], v[52:55]
  v_mul_f32 v83, v45, v229
  v_fma_f32 v81, -v45, v237, v81
  v_fmac_f32 v83, v41, v237
  v_cvt_pk_bf16_f32 v244, v80, -v82
  v_cvt_pk_bf16_f32 v245, v81, -v83
  v_mfma_f32_16x16x32_bf16 v[56:59], v[252:255], a[92:95], v[56:59]
  v_mul_f32 v84, v42, v230
  v_mul_f32 v86, v46, v230
  v_fma_f32 v84, -v46, v238, v84
  v_fmac_f32 v86, v42, v238
  v_mul_f32 v85, v43, v231
  v_mfma_f32_16x16x32_bf16 v[60:63], v[252:255], a[108:111], v[60:63]
  v_mul_f32 v87, v47, v231
  v_fma_f32 v85, -v47, v239, v85
  v_fmac_f32 v87, v43, v239
  v_cvt_pk_bf16_f32 v246, v84, -v86
  v_cvt_pk_bf16_f32 v247, v85, -v87
  v_mfma_f32_16x16x32_bf16 v[32:35], v[240:243], a[80:83], 0
  v_mul_f32 v80, v48, v176
  v_mul_f32 v82, v52, v176
  v_fmac_f32 v80, v52, v180
  v_fma_f32 v82, -v48, v180, v82
  v_mul_f32 v81, v49, v177
  v_mfma_f32_16x16x32_bf16 v[36:39], v[240:243], a[96:99], 0
  v_mul_f32 v83, v53, v177
  v_fmac_f32 v81, v53, v181
  v_fma_f32 v83, -v49, v181, v83
  v_cvt_pk_bf16_f32 v248, v80, v82
  v_cvt_pk_bf16_f32 v249, v81, v83
  v_mfma_f32_16x16x32_bf16 v[40:43], v[240:243], a[88:91], 0
  v_mul_f32 v84, v50, v178
  v_mul_f32 v86, v54, v178
  v_fmac_f32 v84, v54, v182
  v_fma_f32 v86, -v50, v182, v86
  v_mul_f32 v85, v51, v179
  v_mfma_f32_16x16x32_bf16 v[44:47], v[240:243], a[104:107], 0
  v_mul_f32 v87, v55, v179
  v_fmac_f32 v85, v55, v183
  v_fma_f32 v87, -v51, v183, v87
  v_cvt_pk_bf16_f32 v250, v84, v86
  v_cvt_pk_bf16_f32 v251, v85, v87
  v_mfma_f32_16x16x32_bf16 v[32:35], v[244:247], a[84:87], v[32:35]
  v_mul_f32 v80, v56, v184
  v_mul_f32 v82, v60, v184
  v_fmac_f32 v80, v60, v188
  v_fma_f32 v82, -v56, v188, v82
  v_mul_f32 v81, v57, v185
  v_mfma_f32_16x16x32_bf16 v[36:39], v[244:247], a[100:103], v[36:39]
  v_mul_f32 v83, v61, v185
  v_fmac_f32 v81, v61, v189
  v_fma_f32 v83, -v57, v189, v83
  v_cvt_pk_bf16_f32 v252, v80, v82
  v_cvt_pk_bf16_f32 v253, v81, v83
  v_mfma_f32_16x16x32_bf16 v[40:43], v[244:247], a[92:95], v[40:43]
  v_mul_f32 v84, v58, v186
  v_mul_f32 v86, v62, v186
  v_fmac_f32 v84, v62, v190
  v_fma_f32 v86, -v58, v190, v86
  v_mul_f32 v85, v59, v187
  v_mfma_f32_16x16x32_bf16 v[44:47], v[244:247], a[108:111], v[44:47]
  v_mul_f32 v87, v63, v187
  v_fmac_f32 v85, v63, v191
  v_fma_f32 v87, -v59, v191, v87
  v_cvt_pk_bf16_f32 v254, v84, v86
  v_cvt_pk_bf16_f32 v255, v85, v87
  ds_write_b128 v1, v[248:251] offset:8192
  ds_write_b128 v1, v[252:255] offset:9216
  v_mul_f32 v80, v32, v176
  v_mul_f32 v82, v36, v176
  v_fmac_f32 v80, v36, v180
  v_fma_f32 v82, -v32, v180, v82
  v_mul_f32 v81, v33, v177
  v_mul_f32 v83, v37, v177
  v_fmac_f32 v81, v37, v181
  v_fma_f32 v83, -v33, v181, v83
  v_cvt_pk_bf16_f32 v240, v80, v82
  v_cvt_pk_bf16_f32 v241, v81, v83
  s_waitcnt lgkmcnt(0)
  s_barrier
  ds_read_b128 a[32:35], v2 offset:8192
  ds_read_b128 a[48:51], v2 offset:9216
  ds_read_b128 a[36:39], v2 offset:10240
  ds_read_b128 a[52:55], v2 offset:11264
  ds_read_b128 a[40:43], v2 offset:12288
  ds_read_b128 a[56:59], v2 offset:13312
  ds_read_b128 a[44:47], v2 offset:14336
  ds_read_b128 a[60:63], v2 offset:15360
  v_mul_f32 v84, v34, v178
  v_mul_f32 v86, v38, v178
  v_fmac_f32 v84, v38, v182
  v_fma_f32 v86, -v34, v182, v86
  v_mul_f32 v85, v35, v179
  v_mul_f32 v87, v39, v179
  v_fmac_f32 v85, v39, v183
  v_fma_f32 v87, -v35, v183, v87
  v_cvt_pk_bf16_f32 v242, v84, v86
  v_cvt_pk_bf16_f32 v243, v85, v87
  v_mul_f32 v80, v40, v184
  v_mul_f32 v82, v44, v184
  s_waitcnt lgkmcnt(0)
  v_mfma_f32_16x16x32_bf16 v[48:51], a[32:35], v[192:195], 0
  v_fmac_f32 v80, v44, v188
  v_fma_f32 v82, -v40, v188, v82
  v_mfma_f32_16x16x32_bf16 v[52:55], a[32:35], v[208:211], 0
  v_mul_f32 v81, v41, v185
  v_mul_f32 v83, v45, v185
  v_mfma_f32_16x16x32_bf16 v[56:59], a[48:51], v[192:195], 0
  v_fmac_f32 v81, v45, v189
  v_fma_f32 v83, -v41, v189, v83
  v_mfma_f32_16x16x32_bf16 v[60:63], a[48:51], v[208:211], 0
  v_cvt_pk_bf16_f32 v244, v80, v82
  v_cvt_pk_bf16_f32 v245, v81, v83
  v_mfma_f32_16x16x32_bf16 v[48:51], a[36:39], v[196:199], v[48:51]
  v_mul_f32 v84, v42, v186
  v_mul_f32 v86, v46, v186
  v_mfma_f32_16x16x32_bf16 v[52:55], a[36:39], v[212:215], v[52:55]
  v_fmac_f32 v84, v46, v190
  v_fma_f32 v86, -v42, v190, v86
  v_mfma_f32_16x16x32_bf16 v[56:59], a[52:55], v[196:199], v[56:59]
  v_mul_f32 v85, v43, v187
  v_mul_f32 v87, v47, v187
  v_mfma_f32_16x16x32_bf16 v[60:63], a[52:55], v[212:215], v[60:63]
  v_fmac_f32 v85, v47, v191
  v_fma_f32 v87, -v43, v191, v87
  v_mfma_f32_16x16x32_bf16 v[48:51], a[40:43], v[200:203], v[48:51]
  v_cvt_pk_bf16_f32 v246, v84, v86
  v_cvt_pk_bf16_f32 v247, v85, v87
  ds_write_b128 v1, v[240:243] offset:0
  ds_write_b128 v1, v[244:247] offset:1024
  v_mfma_f32_16x16x32_bf16 v[52:55], a[40:43], v[216:219], v[52:55]
  v_mfma_f32_16x16x32_bf16 v[56:59], a[56:59], v[200:203], v[56:59]
  v_mfma_f32_16x16x32_bf16 v[60:63], a[56:59], v[216:219], v[60:63]
  v_mfma_f32_16x16x32_bf16 v[48:51], a[44:47], v[204:207], v[48:51]
  s_waitcnt lgkmcnt(0)
  s_barrier
  ds_read_b128 a[0:3], v2 offset:0
  ds_read_b128 a[16:19], v2 offset:1024
  ds_read_b128 a[4:7], v2 offset:2048
  ds_read_b128 a[20:23], v2 offset:3072
  ds_read_b128 a[8:11], v2 offset:4096
  ds_read_b128 a[24:27], v2 offset:5120
  ds_read_b128 a[12:15], v2 offset:6144
  ds_read_b128 a[28:31], v2 offset:7168
  v_mfma_f32_16x16x32_bf16 v[52:55], a[44:47], v[220:223], v[52:55]
  v_mfma_f32_16x16x32_bf16 v[56:59], a[60:63], v[204:207], v[56:59]
  v_mfma_f32_16x16x32_bf16 v[60:63], a[60:63], v[220:223], v[60:63]
  s_waitcnt lgkmcnt(0)
  v_mfma_f32_16x16x32_bf16 v[32:35], a[0:3], v[192:195], 0
  v_mfma_f32_16x16x32_bf16 v[36:39], a[0:3], v[208:211], 0
  v_mfma_f32_16x16x32_bf16 v[40:43], a[16:19], v[192:195], 0
  v_mfma_f32_16x16x32_bf16 v[44:47], a[16:19], v[208:211], 0
  v_cvt_pk_bf16_f32 v248, v48, v49
  v_mfma_f32_16x16x32_bf16 v[32:35], a[4:7], v[196:199], v[32:35]
  v_cvt_pk_bf16_f32 v249, v50, v51
  v_mfma_f32_16x16x32_bf16 v[36:39], a[4:7], v[212:215], v[36:39]
  v_cvt_pk_bf16_f32 v250, v52, v53
  v_mfma_f32_16x16x32_bf16 v[40:43], a[20:23], v[196:199], v[40:43]
  v_cvt_pk_bf16_f32 v251, v54, v55
  v_mfma_f32_16x16x32_bf16 v[44:47], a[20:23], v[212:215], v[44:47]
  buffer_store_dwordx4 v[248:251], v5, s[48:51], s21 offen sc1
  v_mfma_f32_16x16x32_bf16 v[32:35], a[8:11], v[200:203], v[32:35]
  s_add_u32 s21, s21, 73728
  v_mfma_f32_16x16x32_bf16 v[36:39], a[8:11], v[216:219], v[36:39]
  v_cvt_pk_bf16_f32 v252, v56, v57
  v_mfma_f32_16x16x32_bf16 v[40:43], a[24:27], v[200:203], v[40:43]
  v_cvt_pk_bf16_f32 v253, v58, v59
  v_mfma_f32_16x16x32_bf16 v[44:47], a[24:27], v[216:219], v[44:47]
  v_cvt_pk_bf16_f32 v254, v60, v61
  v_mfma_f32_16x16x32_bf16 v[32:35], a[12:15], v[204:207], v[32:35]
  v_cvt_pk_bf16_f32 v255, v62, v63
  v_mfma_f32_16x16x32_bf16 v[36:39], a[12:15], v[220:223], v[36:39]
  buffer_store_dwordx4 v[252:255], v5, s[48:51], s21 offen sc1
  v_mfma_f32_16x16x32_bf16 v[40:43], a[28:31], v[204:207], v[40:43]
  v_mfma_f32_16x16x32_bf16 v[44:47], a[28:31], v[220:223], v[44:47]
  s_cmp_lg_u32 s2, 0
  s_cbranch_scc1 k1_kernel_zst
  s_nop 2
  v_mov_b32 v36, v48
  v_mov_b32 v37, v49
  v_mov_b32 v38, v50
  v_mov_b32 v39, v51
  v_mov_b32 v44, v56
  v_mov_b32 v45, v57
  v_mov_b32 v46, v58
  v_mov_b32 v47, v59
k1_kernel_zst:
  s_nop 7
  v_cvt_pk_bf16_f32 v240, v32, v33
  v_cvt_pk_bf16_f32 v241, v34, v35
  v_cvt_pk_bf16_f32 v242, v36, v37
  v_cvt_pk_bf16_f32 v243, v38, v39
  buffer_store_dwordx4 v[240:243], v3, s[48:51], s20 offen sc1
  s_add_u32 s20, s20, 73728
  v_cvt_pk_bf16_f32 v244, v40, v41
  v_cvt_pk_bf16_f32 v245, v42, v43
  v_cvt_pk_bf16_f32 v246, v44, v45
  v_cvt_pk_bf16_f32 v247, v46, v47
  buffer_store_dwordx4 v[244:247], v3, s[48:51], s20 offen sc1
  s_mov_b64 exec, 0
  s_cmp_eq_u32 s64, 1
  s_cbranch_scc1 k2_pad5
  s_cmp_eq_u32 s64, 2
  s_cbranch_scc1 k2_pad10
  s_cmp_eq_u32 s64, 3
  s_cbranch_scc1 k2_pad15
  s_branch k2_pad0
k1_kernel_end:
  s_endpgm
k1_kernel_dft2:
  s_cmp_eq_u32 s3, 2
  s_cbranch_scc1 k1_kernel_gate
  s_lshl_b32 s84, s3, 1
  s_add_u32 s84, s84, s65
  s_add_u32 s84, s84, 32
  s_lshl_b32 s84, s84, 4
  v_add_u32 v142, s84, v98
  v_lshrrev_b32 v136, 1, v142
  v_and_b32 v137, 1, v142
  v_cvt_f32_u32 v137, v137
  v_mul_f32 v137, 0x3e800000, v137
  v_cvt_f32_u32 v138, v136
  v_mul_f32 v138, s88, v138
  s_lshl_b32 s84, s66, 5
  v_lshl_add_u32 v142, v97, 3, s84
  v_mul_u32_u24 v139, v136, v142
  v_lshlrev_b32 v140, 6, v136
  v_mul_u32_u24 v142, 29128, v139
  v_lshrrev_b32 v142, 24, v142
  v_mul_u32_u24 v142, 576, v142
  v_sub_u32 v139, v139, v142
  v_mul_u32_u24 v142, 29128, v140
  v_lshrrev_b32 v142, 24, v142
  v_mul_u32_u24 v142, 576, v142
  v_sub_u32 v140, v140, v142
  v_cvt_f32_u32 v143, v140
  v_mul_f32 v143, s88, v143
  v_cos_f32 v143, v143
  v_cvt_f32_u32 v141, v139
  v_add_u32 v139, v139, v140
  v_fma_f32 v144, v141, s88, v137
  v_add_f32 v143, v143, v143
  v_add_f32 v145, v144, v138
  v_fma_f32 v146, 2.0, v138, v144
  v_fma_f32 v147, 2.0, v138, v145
  v_fma_f32 v148, 4.0, v138, v144
  v_fma_f32 v149, 4.0, v138, v145
  v_fma_f32 v150, 4.0, v138, v146
  v_fma_f32 v151, 4.0, v138, v147
  v_cos_f32 v144, v144
  v_cos_f32 v145, v145
  v_cos_f32 v146, v146
  v_cos_f32 v147, v147
  v_cos_f32 v148, v148
  v_cos_f32 v149, v149
  v_cos_f32 v150, v150
  v_cos_f32 v151, v151
  v_cvt_pk_bf16_f32 v160, v144, v145
  v_cvt_pk_bf16_f32 v161, v146, v147
  v_cvt_pk_bf16_f32 v162, v148, v149
  v_cvt_pk_bf16_f32 v163, v150, v151
  ds_write_b128 v170, v[160:163] offset:1024
  v_cvt_f32_u32 v141, v139
  v_fma_f32 v152, v141, s88, v137
  v_add_f32 v153, v152, v138
  v_fma_f32 v154, 2.0, v138, v152
  v_fma_f32 v155, 2.0, v138, v153
  v_fma_f32 v156, 4.0, v138, v152
  v_fma_f32 v157, 4.0, v138, v153
  v_fma_f32 v158, 4.0, v138, v154
  v_fma_f32 v159, 4.0, v138, v155
  v_cos_f32 v152, v152
  v_cos_f32 v153, v153
  v_cos_f32 v154, v154
  v_cos_f32 v155, v155
  v_cos_f32 v156, v156
  v_cos_f32 v157, v157
  v_cos_f32 v158, v158
  v_cos_f32 v159, v159
  v_cvt_pk_bf16_f32 v164, v152, v153
  v_cvt_pk_bf16_f32 v165, v154, v155
  v_cvt_pk_bf16_f32 v166, v156, v157
  v_cvt_pk_bf16_f32 v167, v158, v159
  ds_write_b128 v170, v[164:167] offset:9216
  v_fma_f32 v144, v143, v152, -v144
  v_fma_f32 v145, v143, v153, -v145
  v_fma_f32 v146, v143, v154, -v146
  v_fma_f32 v147, v143, v155, -v147
  v_fma_f32 v148, v143, v156, -v148
  v_fma_f32 v149, v143, v157, -v149
  v_fma_f32 v150, v143, v158, -v150
  v_fma_f32 v151, v143, v159, -v151
  v_cvt_pk_bf16_f32 v160, v144, v145
  v_cvt_pk_bf16_f32 v161, v146, v147
  v_cvt_pk_bf16_f32 v162, v148, v149
  v_cvt_pk_bf16_f32 v163, v150, v151
  ds_write_b128 v170, v[160:163] offset:17408
  v_fma_f32 v152, v143, v144, -v152
  v_fma_f32 v153, v143, v145, -v153
  v_fma_f32 v154, v143, v146, -v154
  v_fma_f32 v155, v143, v147, -v155
  v_fma_f32 v156, v143, v148, -v156
  v_fma_f32 v157, v143, v149, -v157
  v_fma_f32 v158, v143, v150, -v158
  v_fma_f32 v159, v143, v151, -v159
  v_cvt_pk_bf16_f32 v164, v152, v153
  v_cvt_pk_bf16_f32 v165, v154, v155
  v_cvt_pk_bf16_f32 v166, v156, v157
  v_cvt_pk_bf16_f32 v167, v158, v159
  ds_write_b128 v170, v[164:167] offset:25600
  v_fma_f32 v144, v143, v152, -v144
  v_fma_f32 v145, v143, v153, -v145
  v_fma_f32 v146, v143, v154, -v146
  v_fma_f32 v147, v143, v155, -v147
  v_fma_f32 v148, v143, v156, -v148
  v_fma_f32 v149, v143, v157, -v149
  v_fma_f32 v150, v143, v158, -v150
  v_fma_f32 v151, v143, v159, -v151
  v_cvt_pk_bf16_f32 v160, v144, v145
  v_cvt_pk_bf16_f32 v161, v146, v147
  v_cvt_pk_bf16_f32 v162, v148, v149
  v_cvt_pk_bf16_f32 v163, v150, v151
  ds_write_b128 v170, v[160:163] offset:33792
  v_fma_f32 v152, v143, v144, -v152
  v_fma_f32 v153, v143, v145, -v153
  v_fma_f32 v154, v143, v146, -v154
  v_fma_f32 v155, v143, v147, -v155
  v_fma_f32 v156, v143, v148, -v156
  v_fma_f32 v157, v143, v149, -v157
  v_fma_f32 v158, v143, v150, -v158
  v_fma_f32 v159, v143, v151, -v159
  v_cvt_pk_bf16_f32 v164, v152, v153
  v_cvt_pk_bf16_f32 v165, v154, v155
  v_cvt_pk_bf16_f32 v166, v156, v157
  v_cvt_pk_bf16_f32 v167, v158, v159
  ds_write_b128 v170, v[164:167] offset:41984
  v_fma_f32 v144, v143, v152, -v144
  v_fma_f32 v145, v143, v153, -v145
  v_fma_f32 v146, v143, v154, -v146
  v_fma_f32 v147, v143, v155, -v147
  v_fma_f32 v148, v143, v156, -v148
  v_fma_f32 v149, v143, v157, -v149
  v_fma_f32 v150, v143, v158, -v150
  v_fma_f32 v151, v143, v159, -v151
  v_cvt_pk_bf16_f32 v160, v144, v145
  v_cvt_pk_bf16_f32 v161, v146, v147
  v_cvt_pk_bf16_f32 v162, v148, v149
  v_cvt_pk_bf16_f32 v163, v150, v151
  ds_write_b128 v170, v[160:163] offset:50176
  v_fma_f32 v152, v143, v144, -v152
  v_fma_f32 v153, v143, v145, -v153
  v_fma_f32 v154, v143, v146, -v154
  v_fma_f32 v155, v143, v147, -v155
  v_fma_f32 v156, v143, v148, -v156
  v_fma_f32 v157, v143, v149, -v157
  v_fma_f32 v158, v143, v150, -v158
  v_fma_f32 v159, v143, v151, -v159
  v_cvt_pk_bf16_f32 v164, v152, v153
  v_cvt_pk_bf16_f32 v165, v154, v155
  v_cvt_pk_bf16_f32 v166, v156, v157
  v_cvt_pk_bf16_f32 v167, v158, v159
  ds_write_b128 v170, v[164:167] offset:58368
  v_fma_f32 v144, v143, v152, -v144
  v_fma_f32 v145, v143, v153, -v145
  v_fma_f32 v146, v143, v154, -v146
  v_fma_f32 v147, v143, v155, -v147
  v_fma_f32 v148, v143, v156, -v148
  v_fma_f32 v149, v143, v157, -v149
  v_fma_f32 v150, v143, v158, -v150
  v_fma_f32 v151, v143, v159, -v151
  v_cvt_pk_bf16_f32 v160, v144, v145
  v_cvt_pk_bf16_f32 v161, v146, v147
  v_cvt_pk_bf16_f32 v162, v148, v149
  v_cvt_pk_bf16_f32 v163, v150, v151
  ds_write_b128 v171, v[160:163] offset:1024
  s_branch k1_kernel_dft2ret
k1_kernel_gate:
  v_mov_b32 v142, 0xbf803f80
  v_cmp_eq_u32 vcc, 2, v98
  s_nop 1
  v_cndmask_b32 v142, 0, v142, vcc
  v_cmp_gt_u32 vcc, 2, v98
  s_add_u32 s84, s74, 82944
  v_add_u32 v170, s84, v21
  v_add_u32 v171, 65536, v170
  s_waitcnt vmcnt(17)
  v_cndmask_b32 v64, v142, v64, vcc
  v_cndmask_b32 v65, v142, v65, vcc
  v_cndmask_b32 v66, v142, v66, vcc
  v_cndmask_b32 v67, v142, v67, vcc
  v_cndmask_b32 v68, v142, v68, vcc
  v_cndmask_b32 v69, v142, v69, vcc
  v_cndmask_b32 v70, v142, v70, vcc
  v_cndmask_b32 v71, v142, v71, vcc
  v_cndmask_b32 v72, v142, v72, vcc
  v_cndmask_b32 v73, v142, v73, vcc
  v_cndmask_b32 v74, v142, v74, vcc
  v_cndmask_b32 v75, v142, v75, vcc
  v_cndmask_b32 v76, v142, v76, vcc
  v_cndmask_b32 v77, v142, v77, vcc
  v_cndmask_b32 v78, v142, v78, vcc
  v_cndmask_b32 v79, v142, v79, vcc
  v_cndmask_b32 v80, v142, v80, vcc
  v_cndmask_b32 v81, v142, v81, vcc
  v_cndmask_b32 v82, v142, v82, vcc
  v_cndmask_b32 v83, v142, v83, vcc
  ds_write_b128 v170, v[64:67] offset:0
  ds_write_b128 v170, v[68:71] offset:16384
  ds_write_b128 v170, v[72:75] offset:32768
  ds_write_b128 v170, v[76:79] offset:49152
  ds_write_b128 v171, v[80:83] offset:0
  s_branch k1_kernel_dft2ret
k1_kernel_spin:
  s_mov_b32 s101, 0
k1_kernel_spin1:
  s_sleep 8
  buffer_load_dword v241, v242, s[60:63], 0 offen sc1
  s_waitcnt vmcnt(0)
  v_cmp_ne_u32 vcc, 0x01010101, v241
  s_add_u32 s101, s101, 1
  s_nop 3
  s_cmp_eq_u64 vcc, 0
  s_cbranch_scc1 k1_kernel_spinret
  s_cmp_lt_u32 s101, 100000
  s_cbranch_scc1 k1_kernel_spin1
  s_branch k1_kernel_spinret
k1_kernel_gs2:
  s_mov_b32 s101, 0
k1_kernel_gt2:
  s_sleep 2
  buffer_load_dword v241, off, s[48:51], s27 sc1
  s_waitcnt vmcnt(0)
  v_readfirstlane_b32 s71, v241
  s_add_u32 s101, s101, 1
  s_nop 2
  s_cmp_ge_u32 s71, 2
  s_cbranch_scc1 k1_kernel_gr2
  s_cmp_lt_u32 s101, 100000
  s_cbranch_scc1 k1_kernel_gt2
  s_branch k1_kernel_gr2
k1_kernel_gs4:
  s_mov_b32 s101, 0
k1_kernel_gt4:
  s_sleep 2
  buffer_load_dword v15, off, s[48:51], s27 sc1
  s_waitcnt vmcnt(0)
  v_readfirstlane_b32 s71, v15
  s_add_u32 s101, s101, 1
  s_nop 2
  s_cmp_ge_u32 s71, 4
  s_cbranch_scc1 k1_kernel_gr4
  s_cmp_lt_u32 s101, 100000
  s_cbranch_scc1 k1_kernel_gt4
  s_branch k1_kernel_gr4
k1_kernel_gs5:
  s_mov_b32 s101, 0
k1_kernel_gt5:
  s_sleep 2
  buffer_load_dword v15, off, s[48:51], s27 sc1
  s_waitcnt vmcnt(0)
  v_readfirstlane_b32 s71, v15
  s_add_u32 s101, s101, 1
  s_nop 2
  s_cmp_ge_u32 s71, 5
  s_cbranch_scc1 k1_kernel_gr5
  s_cmp_lt_u32 s101, 100000
  s_cbranch_scc1 k1_kernel_gt5
  s_branch k1_kernel_gr5
.globl k2_kernel
.p2align 8
.type k2_kernel,@function
k2_kernel:
k2_pad0:
  s_cbranch_execz k2_pad1
  s_cmp_ge_u32 s2, 256
  s_cbranch_scc1 k2_kernel_end
  s_load_dwordx2 s[4:5], s[0:1], 80
  s_load_dwordx2 s[6:7], s[0:1], 64
  v_lshrrev_b32 v1, 6, v0
  v_and_b32 v3, 63, v0
  v_readfirstlane_b32 s16, v1
  v_lshrrev_b32 v1, 4, v3
  v_and_b32 v2, 15, v3
  v_lshlrev_b32 v3, 4, v3
  s_and_b32 s17, s2, 7
  s_lshl_b32 s17, s17, 2
  s_lshr_b32 s19, s2, 6
  s_add_u32 s17, s17, s19
  s_bfe_u32 s18, s2, 0x10005
  s_lshl1_add_u32 s19, s17, s18
  s_mul_i32 s22, s19, 36864
  s_lshl_b32 m0, s16, 12
  s_add_u32 s22, s22, m0
  s_add_u32 s22, s22, 59768832
  s_bfe_u32 s19, s2, 0x20003
  s_mul_i32 s25, s19, 9
  s_add_u32 s25, s25, s16
  s_mul_i32 s21, s17, 36
  s_add_u32 s21, s21, s25
  s_lshl_b32 s21, s21, 14
  s_lshl_b32 s19, s18, 10
  s_add_u32 s21, s21, s19
  s_lshl_b32 s20, s17, 8
  s_lshl3_add_u32 s20, s18, s20
k2_pad1:
  s_cbranch_execz k2_pad2
  s_add_u32 s20, s20, 58982400
  v_lshlrev_b32 v8, 4, v2
  s_waitcnt lgkmcnt(0)
  s_mov_b32 s8, s4
  s_and_b32 s9, s5, 0xffff
  s_mov_b32 s10, 268435456
  s_mov_b32 s11, 0x20000
  buffer_load_dwordx4 v3, s[8:11], s22 offen offset:0 lds
  buffer_load_dwordx4 v3, s[8:11], s22 offen offset:1024 lds
  buffer_load_dwordx4 v3, s[8:11], s22 offen offset:2048 lds
  buffer_load_dwordx4 v3, s[8:11], s22 offen offset:3072 lds
  buffer_load_dwordx2 v[12:13], v8, s[8:11], s20 offen
  buffer_load_dwordx4 a[0:3], v3, s[8:11], s21 offen offset:0
  s_mov_b32 s23, 0x3ae38e39
  s_lshl_b32 s19, s25, 4
  v_add_u32 v9, s19, v2
  v_lshlrev_b32 v8, 2, v1
  v_mul_u32_u24 v5, v9, v8
  v_lshlrev_b32 v6, 4, v9
  v_mul_u32_u24 v8, 29128, v5
  v_lshrrev_b32 v8, 24, v8
  v_mul_u32_u24 v8, 576, v8
  v_sub_u32 v5, v5, v8
  v_mul_u32_u24 v8, 29128, v6
  v_lshrrev_b32 v8, 24, v8
  v_mul_u32_u24 v8, 576, v8
  v_sub_u32 v6, v6, v8
  v_cvt_f32_u32 v7, v9
  v_cvt_f32_u32 v5, v5
  v_cvt_f32_u32 v6, v6
k2_pad2:
  s_cbranch_execz k2_pad3
  v_mul_f32 v7, s23, v7
  v_mul_f32 v5, s23, v5
  v_mul_f32 v6, s23, v6
  v_cos_f32 v10, v6
  v_mov_b32 v44, v5
  v_add_f32 v46, v44, v7
  v_fma_f32 v48, 2.0, v7, v44
  v_fma_f32 v50, 2.0, v7, v46
  v_sin_f32 v45, v44
  v_cos_f32 v44, v44
  v_sin_f32 v47, v46
  v_cos_f32 v46, v46
  v_sin_f32 v49, v48
  v_cos_f32 v48, v48
  v_sin_f32 v51, v50
  v_cos_f32 v50, v50
  v_cvt_pk_bf16_f32 v84, v44, v45
  v_cvt_pk_bf16_f32 v85, v46, v47
  v_cvt_pk_bf16_f32 v86, v48, v49
  v_cvt_pk_bf16_f32 v87, v50, v51
  v_lshlrev_b32 v8, 31, v9
  v_or_b32 v8, 0x3f003f00, v8
  v_cmp_eq_u32 vcc, 0, v1
  s_nop 1
  v_cndmask_b32 v84, v84, v8, vcc
  v_add_f32 v52, v5, v6
  v_add_f32 v10, v10, v10
  v_add_f32 v54, v52, v7
  v_fma_f32 v56, 2.0, v7, v52
  v_fma_f32 v58, 2.0, v7, v54
k2_pad3:
  s_cbranch_execz k2_pad4
  v_sin_f32 v53, v52
  v_cos_f32 v52, v52
  v_sin_f32 v55, v54
  v_cos_f32 v54, v54
  v_sin_f32 v57, v56
  v_cos_f32 v56, v56
  v_sin_f32 v59, v58
  v_cos_f32 v58, v58
  v_cvt_pk_bf16_f32 v88, v52, v53
  v_cvt_pk_bf16_f32 v89, v54, v55
  v_cvt_pk_bf16_f32 v90, v56, v57
  v_cvt_pk_bf16_f32 v91, v58, v59
  v_fma_f32 v44, v10, v52, -v44
  v_fma_f32 v45, v10, v53, -v45
  v_fma_f32 v46, v10, v54, -v46
  v_fma_f32 v47, v10, v55, -v47
  v_fma_f32 v48, v10, v56, -v48
  v_fma_f32 v49, v10, v57, -v49
  v_fma_f32 v50, v10, v58, -v50
  v_fma_f32 v51, v10, v59, -v51
  v_cvt_pk_bf16_f32 v92, v44, v45
  v_cvt_pk_bf16_f32 v93, v46, v47
  v_cvt_pk_bf16_f32 v94, v48, v49
  v_cvt_pk_bf16_f32 v95, v50, v51
  v_fma_f32 v52, v10, v44, -v52
  v_fma_f32 v53, v10, v45, -v53
  v_fma_f32 v54, v10, v46, -v54
  v_fma_f32 v55, v10, v47, -v55
  v_fma_f32 v56, v10, v48, -v56
  v_fma_f32 v57, v10, v49, -v57
k2_pad4:
  s_cbranch_execz k2_kernel_end
  v_fma_f32 v58, v10, v50, -v58
  v_fma_f32 v59, v10, v51, -v59
  v_cvt_pk_bf16_f32 v96, v52, v53
  v_cvt_pk_bf16_f32 v97, v54, v55
  v_cvt_pk_bf16_f32 v98, v56, v57
  v_cvt_pk_bf16_f32 v99, v58, v59
  v_fma_f32 v44, v10, v52, -v44
  v_fma_f32 v45, v10, v53, -v45
  v_fma_f32 v46, v10, v54, -v46
  v_fma_f32 v47, v10, v55, -v47
  v_fma_f32 v48, v10, v56, -v48
  v_fma_f32 v49, v10, v57, -v49
  v_fma_f32 v50, v10, v58, -v50
  v_fma_f32 v51, v10, v59, -v51
  v_cvt_pk_bf16_f32 v100, v44, v45
  v_cvt_pk_bf16_f32 v101, v46, v47
  v_cvt_pk_bf16_f32 v102, v48, v49
  v_cvt_pk_bf16_f32 v103, v50, v51
  s_mov_b32 s12, s6
  s_and_b32 s13, s7, 0xffff
  s_mov_b32 s14, 2359296
  s_mov_b32 s15, 0x20000
  v_bfe_u32 v8, v2, 3, 1
  v_lshl_add_u32 v16, v1, 2, v8
  v_lshlrev_b32 v16, 7, v16
  v_and_b32 v8, 1, v1
  v_lshl_add_u32 v16, v8, 4, v16
  v_and_b32 v8, 3, v2
  v_lshl_add_u32 v16, v8, 5, v16
  v_bfe_u32 v8, v2, 2, 1
k2_pad5:
  s_cbranch_execz k2_pad6
  v_lshl_add_u32 v16, v8, 3, v16
  v_xor_b32 v17, 16, v16
  v_lshlrev_b32 v4, 2, v1
  v_sub_u32 v4, v2, v4
  v_mov_b32 v22, 0
  v_mov_b32 v23, 0
  v_mov_b32 v24, 0
  v_mov_b32 v25, 0
  v_mov_b32 v14, 0x3f80
  v_mov_b32 v15, 1.0
  v_cmp_eq_u32 vcc, 0, v4
  s_nop 1
  v_cndmask_b32 v20, 0, v14, vcc
  v_cmp_eq_u32 vcc, 1, v4
  s_nop 1
  v_cndmask_b32 v20, v20, v15, vcc
  v_mov_b32 v26, v20
  v_cmp_eq_u32 vcc, 2, v4
  s_nop 1
  v_cndmask_b32 v21, 0, v14, vcc
  v_cmp_eq_u32 vcc, 3, v4
  s_nop 1
  v_cndmask_b32 v21, v21, v15, vcc
  v_mov_b32 v27, v21
  v_mul_u32_u24 v4, 304, v2
  v_lshl_add_u32 v4, v1, 3, v4
  v_lshl_add_u32 v4, s16, 5, v4
  v_mul_u32_u24 v8, 3641, v0
  v_lshrrev_b32 v8, 16, v8
  v_add_lshl_u32 v18, v0, v8, 4
k2_pad6:
  s_cbranch_execz k2_pad7
  v_and_b32 v19, 16, v8
  v_mul_u32_u24 v19, 1152, v19
  v_mul_u32_u24 v8, 864, v8
  v_lshl_add_u32 v8, v0, 4, v8
  v_add_u32 v19, v19, v8
  s_sub_u32 s25, s25, s16
  s_lshr_b32 s19, s17, 1
  s_lshl1_add_u32 s19, s19, s18
  s_mul_i32 s24, s19, 73728
  s_and_b32 s19, s17, 1
  s_mul_i32 s19, s19, 18432
  s_add_u32 s24, s24, s19
  s_lshl_b32 s19, s25, 5
  s_add_u32 s24, s24, s19
  s_waitcnt vmcnt(1)
  s_barrier
  ds_read_b64_tr_b16 v[60:61], v16 offset:0
  ds_read_b64_tr_b16 v[62:63], v16 offset:256
  ds_read_b64_tr_b16 v[64:65], v17 offset:0
  ds_read_b64_tr_b16 v[66:67], v17 offset:256
  ds_read_b64_tr_b16 v[68:69], v16 offset:2048
  ds_read_b64_tr_b16 v[70:71], v16 offset:2304
  ds_read_b64_tr_b16 v[72:73], v17 offset:2048
  ds_read_b64_tr_b16 v[74:75], v17 offset:2304
  ds_read_b64_tr_b16 v[76:77], v16 offset:4096
  ds_read_b64_tr_b16 v[78:79], v16 offset:4352
  ds_read_b64_tr_b16 v[80:81], v17 offset:4096
  ds_read_b64_tr_b16 v[82:83], v17 offset:4352
  s_waitcnt lgkmcnt(8)
  v_mfma_f32_16x16x32_bf16 v[28:31], v[84:87], v[60:63], 0
k2_pad7:
  s_cbranch_execz k2_pad8
  v_mfma_f32_16x16x32_bf16 v[32:35], v[84:87], v[64:67], 0
  buffer_load_dwordx4 a[4:7], v3, s[8:11], s21 offen offset:2048
  s_add_u32 s21, s21, 4096
  v_fma_f32 v52, v10, v44, -v52
  v_fma_f32 v53, v10, v45, -v53
  v_fma_f32 v54, v10, v46, -v54
  v_fma_f32 v55, v10, v47, -v55
  v_fma_f32 v56, v10, v48, -v56
  v_fma_f32 v57, v10, v49, -v57
  v_fma_f32 v58, v10, v50, -v58
  v_fma_f32 v59, v10, v51, -v59
  v_cvt_pk_bf16_f32 v104, v52, v53
  v_cvt_pk_bf16_f32 v105, v54, v55
  v_cvt_pk_bf16_f32 v106, v56, v57
  v_cvt_pk_bf16_f32 v107, v58, v59
  ds_read_b64_tr_b16 v[60:61], v16 offset:6144
  ds_read_b64_tr_b16 v[62:63], v16 offset:6400
  ds_read_b64_tr_b16 v[64:65], v17 offset:6144
  ds_read_b64_tr_b16 v[66:67], v17 offset:6400
  s_waitcnt lgkmcnt(8)
  v_mfma_f32_16x16x32_bf16 v[28:31], v[88:91], v[68:71], v[28:31]
  v_mfma_f32_16x16x32_bf16 v[32:35], v[88:91], v[72:75], v[32:35]
  v_fma_f32 v44, v10, v52, -v44
  v_fma_f32 v45, v10, v53, -v45
  v_fma_f32 v46, v10, v54, -v46
  v_fma_f32 v47, v10, v55, -v47
  v_fma_f32 v48, v10, v56, -v48
  v_fma_f32 v49, v10, v57, -v49
  v_fma_f32 v50, v10, v58, -v50
  v_fma_f32 v51, v10, v59, -v51
k2_pad8:
  s_cbranch_execz k2_pad9
  v_cvt_pk_bf16_f32 v84, v44, v45
  v_cvt_pk_bf16_f32 v85, v46, v47
  v_cvt_pk_bf16_f32 v86, v48, v49
  v_cvt_pk_bf16_f32 v87, v50, v51
  ds_read_b64_tr_b16 v[68:69], v16 offset:8192
  ds_read_b64_tr_b16 v[70:71], v16 offset:8448
  ds_read_b64_tr_b16 v[72:73], v17 offset:8192
  ds_read_b64_tr_b16 v[74:75], v17 offset:8448
  s_waitcnt lgkmcnt(8)
  v_mfma_f32_16x16x32_bf16 v[28:31], v[92:95], v[76:79], v[28:31]
  v_mfma_f32_16x16x32_bf16 v[32:35], v[92:95], v[80:83], v[32:35]
  buffer_load_dwordx4 a[8:11], v3, s[8:11], s21 offen offset:0
  v_fma_f32 v52, v10, v44, -v52
  v_fma_f32 v53, v10, v45, -v53
  v_fma_f32 v54, v10, v46, -v54
  v_fma_f32 v55, v10, v47, -v55
  v_fma_f32 v56, v10, v48, -v56
  v_fma_f32 v57, v10, v49, -v57
  v_fma_f32 v58, v10, v50, -v58
  v_fma_f32 v59, v10, v51, -v59
  v_cvt_pk_bf16_f32 v88, v52, v53
  v_cvt_pk_bf16_f32 v89, v54, v55
  v_cvt_pk_bf16_f32 v90, v56, v57
  v_cvt_pk_bf16_f32 v91, v58, v59
  ds_read_b64_tr_b16 v[76:77], v16 offset:10240
  ds_read_b64_tr_b16 v[78:79], v16 offset:10496
  ds_read_b64_tr_b16 v[80:81], v17 offset:10240
  ds_read_b64_tr_b16 v[82:83], v17 offset:10496
  s_waitcnt lgkmcnt(8)
  v_mfma_f32_16x16x32_bf16 v[28:31], v[96:99], v[60:63], v[28:31]
k2_pad9:
  s_cbranch_execz k2_kernel_end
  v_mfma_f32_16x16x32_bf16 v[32:35], v[96:99], v[64:67], v[32:35]
  v_fma_f32 v44, v10, v52, -v44
  v_fma_f32 v45, v10, v53, -v45
  v_fma_f32 v46, v10, v54, -v46
  v_fma_f32 v47, v10, v55, -v47
  v_fma_f32 v48, v10, v56, -v48
  v_fma_f32 v49, v10, v57, -v49
  v_fma_f32 v50, v10, v58, -v50
  v_fma_f32 v51, v10, v59, -v51
  v_cvt_pk_bf16_f32 v92, v44, v45
  v_cvt_pk_bf16_f32 v93, v46, v47
  v_cvt_pk_bf16_f32 v94, v48, v49
  v_cvt_pk_bf16_f32 v95, v50, v51
  ds_read_b64_tr_b16 v[60:61], v16 offset:12288
  ds_read_b64_tr_b16 v[62:63], v16 offset:12544
  ds_read_b64_tr_b16 v[64:65], v17 offset:12288
  ds_read_b64_tr_b16 v[66:67], v17 offset:12544
  s_waitcnt lgkmcnt(8)
  v_mfma_f32_16x16x32_bf16 v[28:31], v[100:103], v[68:71], v[28:31]
  v_mfma_f32_16x16x32_bf16 v[32:35], v[100:103], v[72:75], v[32:35]
  buffer_load_dwordx4 a[12:15], v3, s[8:11], s21 offen offset:2048
  s_add_u32 s21, s21, 4096
  v_mov_b32 v52, 0x41100000
  v_fma_f32 v52, v52, v6, v5
  v_add_f32 v54, v52, v7
  v_fma_f32 v56, 2.0, v7, v52
  v_fma_f32 v58, 2.0, v7, v54
  v_sin_f32 v53, v52
  v_cos_f32 v52, v52
  v_sin_f32 v55, v54
k2_pad10:
  s_cbranch_execz k2_pad11
  v_cos_f32 v54, v54
  v_sin_f32 v57, v56
  v_cos_f32 v56, v56
  v_sin_f32 v59, v58
  v_cos_f32 v58, v58
  v_cvt_pk_bf16_f32 v96, v52, v53
  v_cvt_pk_bf16_f32 v97, v54, v55
  v_cvt_pk_bf16_f32 v98, v56, v57
  v_cvt_pk_bf16_f32 v99, v58, v59
  ds_read_b64_tr_b16 v[68:69], v16 offset:14336
  ds_read_b64_tr_b16 v[70:71], v16 offset:14592
  ds_read_b64_tr_b16 v[72:73], v17 offset:14336
  ds_read_b64_tr_b16 v[74:75], v17 offset:14592
  s_waitcnt lgkmcnt(8)
  v_mfma_f32_16x16x32_bf16 v[28:31], v[104:107], v[76:79], v[28:31]
  v_mfma_f32_16x16x32_bf16 v[32:35], v[104:107], v[80:83], v[32:35]
  v_mov_b32 v44, 0x41200000
  v_fma_f32 v44, v44, v6, v5
  v_add_f32 v46, v44, v7
  v_fma_f32 v48, 2.0, v7, v44
  v_fma_f32 v50, 2.0, v7, v46
  v_sin_f32 v45, v44
  v_cos_f32 v44, v44
  v_sin_f32 v47, v46
  v_cos_f32 v46, v46
  v_sin_f32 v49, v48
  v_cos_f32 v48, v48
  v_sin_f32 v51, v50
  v_cos_f32 v50, v50
  v_cvt_pk_bf16_f32 v100, v44, v45
k2_pad11:
  s_cbranch_execz k2_pad12
  v_cvt_pk_bf16_f32 v101, v46, v47
  v_cvt_pk_bf16_f32 v102, v48, v49
  v_cvt_pk_bf16_f32 v103, v50, v51
  ds_read_b64_tr_b16 v[76:77], v16 offset:16384
  ds_read_b64_tr_b16 v[78:79], v16 offset:16640
  ds_read_b64_tr_b16 v[80:81], v17 offset:16384
  ds_read_b64_tr_b16 v[82:83], v17 offset:16640
  s_waitcnt lgkmcnt(8)
  v_mfma_f32_16x16x32_bf16 v[28:31], v[84:87], v[60:63], v[28:31]
  v_mfma_f32_16x16x32_bf16 v[32:35], v[84:87], v[64:67], v[32:35]
  buffer_load_dwordx4 a[16:19], v3, s[8:11], s21 offen offset:0
  v_fma_f32 v52, v10, v44, -v52
  v_fma_f32 v53, v10, v45, -v53
  v_fma_f32 v54, v10, v46, -v54
  v_fma_f32 v55, v10, v47, -v55
  v_fma_f32 v56, v10, v48, -v56
  v_fma_f32 v57, v10, v49, -v57
  v_fma_f32 v58, v10, v50, -v58
  v_fma_f32 v59, v10, v51, -v59
  v_cvt_pk_bf16_f32 v104, v52, v53
  v_cvt_pk_bf16_f32 v105, v54, v55
  v_cvt_pk_bf16_f32 v106, v56, v57
  v_cvt_pk_bf16_f32 v107, v58, v59
  ds_read_b64_tr_b16 v[60:61], v16 offset:18432
  ds_read_b64_tr_b16 v[62:63], v16 offset:18688
  ds_read_b64_tr_b16 v[64:65], v17 offset:18432
  ds_read_b64_tr_b16 v[66:67], v17 offset:18688
  s_waitcnt lgkmcnt(8)
  v_mfma_f32_16x16x32_bf16 v[28:31], v[88:91], v[68:71], v[28:31]
  v_mfma_f32_16x16x32_bf16 v[32:35], v[88:91], v[72:75], v[32:35]
k2_pad12:
  s_cbranch_execz k2_pad13
  v_fma_f32 v44, v10, v52, -v44
  v_fma_f32 v45, v10, v53, -v45
  v_fma_f32 v46, v10, v54, -v46
  v_fma_f32 v47, v10, v55, -v47
  v_fma_f32 v48, v10, v56, -v48
  v_fma_f32 v49, v10, v57, -v49
  v_fma_f32 v50, v10, v58, -v50
  v_fma_f32 v51, v10, v59, -v51
  v_cvt_pk_bf16_f32 v84, v44, v45
  v_cvt_pk_bf16_f32 v85, v46, v47
  v_cvt_pk_bf16_f32 v86, v48, v49
  v_cvt_pk_bf16_f32 v87, v50, v51
  ds_read_b64_tr_b16 v[68:69], v16 offset:20480
  ds_read_b64_tr_b16 v[70:71], v16 offset:20736
  ds_read_b64_tr_b16 v[72:73], v17 offset:20480
  ds_read_b64_tr_b16 v[74:75], v17 offset:20736
  s_waitcnt lgkmcnt(8)
  v_mfma_f32_16x16x32_bf16 v[28:31], v[92:95], v[76:79], v[28:31]
  v_mfma_f32_16x16x32_bf16 v[32:35], v[92:95], v[80:83], v[32:35]
  buffer_load_dwordx4 a[20:23], v3, s[8:11], s21 offen offset:2048
  s_add_u32 s21, s21, 4096
  v_fma_f32 v52, v10, v44, -v52
  v_fma_f32 v53, v10, v45, -v53
  v_fma_f32 v54, v10, v46, -v54
  v_fma_f32 v55, v10, v47, -v55
  v_fma_f32 v56, v10, v48, -v56
  v_fma_f32 v57, v10, v49, -v57
  v_fma_f32 v58, v10, v50, -v58
  v_fma_f32 v59, v10, v51, -v59
  v_cvt_pk_bf16_f32 v88, v52, v53
k2_pad13:
  s_cbranch_execz k2_pad14
  v_cvt_pk_bf16_f32 v89, v54, v55
  v_cvt_pk_bf16_f32 v90, v56, v57
  v_cvt_pk_bf16_f32 v91, v58, v59
  ds_read_b64_tr_b16 v[76:77], v16 offset:22528
  ds_read_b64_tr_b16 v[78:79], v16 offset:22784
  ds_read_b64_tr_b16 v[80:81], v17 offset:22528
  ds_read_b64_tr_b16 v[82:83], v17 offset:22784
  s_waitcnt lgkmcnt(8)
  v_mfma_f32_16x16x32_bf16 v[28:31], v[96:99], v[60:63], v[28:31]
  v_mfma_f32_16x16x32_bf16 v[32:35], v[96:99], v[64:67], v[32:35]
  v_fma_f32 v44, v10, v52, -v44
  v_fma_f32 v45, v10, v53, -v45
  v_fma_f32 v46, v10, v54, -v46
  v_fma_f32 v47, v10, v55, -v47
  v_fma_f32 v48, v10, v56, -v48
  v_fma_f32 v49, v10, v57, -v49
  v_fma_f32 v50, v10, v58, -v50
  v_fma_f32 v51, v10, v59, -v51
  v_cvt_pk_bf16_f32 v92, v44, v45
  v_cvt_pk_bf16_f32 v93, v46, v47
  v_cvt_pk_bf16_f32 v94, v48, v49
  v_cvt_pk_bf16_f32 v95, v50, v51
  ds_read_b64_tr_b16 v[60:61], v16 offset:24576
  ds_read_b64_tr_b16 v[62:63], v16 offset:24832
  ds_read_b64_tr_b16 v[64:65], v17 offset:24576
  ds_read_b64_tr_b16 v[66:67], v17 offset:24832
  s_waitcnt lgkmcnt(8)
  v_mfma_f32_16x16x32_bf16 v[28:31], v[100:103], v[68:71], v[28:31]
  v_mfma_f32_16x16x32_bf16 v[32:35], v[100:103], v[72:75], v[32:35]
  buffer_load_dwordx4 a[24:27], v3, s[8:11], s21 offen offset:0
k2_pad14:
  s_cbranch_execz k2_kernel_end
  v_fma_f32 v52, v10, v44, -v52
  v_fma_f32 v53, v10, v45, -v53
  v_fma_f32 v54, v10, v46, -v54
  v_fma_f32 v55, v10, v47, -v55
  v_fma_f32 v56, v10, v48, -v56
  v_fma_f32 v57, v10, v49, -v57
  v_fma_f32 v58, v10, v50, -v58
  v_fma_f32 v59, v10, v51, -v59
  v_cvt_pk_bf16_f32 v96, v52, v53
  v_cvt_pk_bf16_f32 v97, v54, v55
  v_cvt_pk_bf16_f32 v98, v56, v57
  v_cvt_pk_bf16_f32 v99, v58, v59
  ds_read_b64_tr_b16 v[68:69], v16 offset:26624
  ds_read_b64_tr_b16 v[70:71], v16 offset:26880
  ds_read_b64_tr_b16 v[72:73], v17 offset:26624
  ds_read_b64_tr_b16 v[74:75], v17 offset:26880
  s_waitcnt lgkmcnt(8)
  v_mfma_f32_16x16x32_bf16 v[28:31], v[104:107], v[76:79], v[28:31]
  v_mfma_f32_16x16x32_bf16 v[32:35], v[104:107], v[80:83], v[32:35]
  v_fma_f32 v44, v10, v52, -v44
  v_fma_f32 v45, v10, v53, -v45
  v_fma_f32 v46, v10, v54, -v46
  v_fma_f32 v47, v10, v55, -v47
  v_fma_f32 v48, v10, v56, -v48
  v_fma_f32 v49, v10, v57, -v49
  v_fma_f32 v50, v10, v58, -v50
  v_fma_f32 v51, v10, v59, -v51
  v_cvt_pk_bf16_f32 v100, v44, v45
  v_cvt_pk_bf16_f32 v101, v46, v47
  v_cvt_pk_bf16_f32 v102, v48, v49
k2_pad15:
  s_cbranch_execz k2_pad16
  v_cvt_pk_bf16_f32 v103, v50, v51
  ds_read_b64_tr_b16 v[76:77], v16 offset:28672
  ds_read_b64_tr_b16 v[78:79], v16 offset:28928
  ds_read_b64_tr_b16 v[80:81], v17 offset:28672
  ds_read_b64_tr_b16 v[82:83], v17 offset:28928
  s_waitcnt lgkmcnt(8)
  v_mfma_f32_16x16x32_bf16 v[28:31], v[84:87], v[60:63], v[28:31]
  v_mfma_f32_16x16x32_bf16 v[32:35], v[84:87], v[64:67], v[32:35]
  buffer_load_dwordx4 a[28:31], v3, s[8:11], s21 offen offset:2048
  s_add_u32 s21, s21, 4096
  v_fma_f32 v52, v10, v44, -v52
  v_fma_f32 v53, v10, v45, -v53
  v_fma_f32 v54, v10, v46, -v54
  v_fma_f32 v55, v10, v47, -v55
  v_fma_f32 v56, v10, v48, -v56
  v_fma_f32 v57, v10, v49, -v57
  v_fma_f32 v58, v10, v50, -v58
  v_fma_f32 v59, v10, v51, -v59
  v_cvt_pk_bf16_f32 v104, v52, v53
  v_cvt_pk_bf16_f32 v105, v54, v55
  v_cvt_pk_bf16_f32 v106, v56, v57
  v_cvt_pk_bf16_f32 v107, v58, v59
  ds_read_b64_tr_b16 v[60:61], v16 offset:30720
  ds_read_b64_tr_b16 v[62:63], v16 offset:30976
  ds_read_b64_tr_b16 v[64:65], v17 offset:30720
  ds_read_b64_tr_b16 v[66:67], v17 offset:30976
  s_waitcnt lgkmcnt(8)
  v_mfma_f32_16x16x32_bf16 v[28:31], v[88:91], v[68:71], v[28:31]
  v_mfma_f32_16x16x32_bf16 v[32:35], v[88:91], v[72:75], v[32:35]
  v_lshlrev_b32 v12, 16, v12
k2_pad16:
  s_cbranch_execz k2_pad17
  v_lshlrev_b32 v13, 16, v13
  v_mul_f32 v12, 0xbfb8aa3b, v12
  v_mul_f32 v13, 0xbfb8aa3b, v13
  ds_read_b64_tr_b16 v[68:69], v16 offset:32768
  ds_read_b64_tr_b16 v[70:71], v16 offset:33024
  ds_read_b64_tr_b16 v[72:73], v17 offset:32768
  ds_read_b64_tr_b16 v[74:75], v17 offset:33024
  s_waitcnt lgkmcnt(8)
  v_mfma_f32_16x16x32_bf16 v[28:31], v[92:95], v[76:79], v[28:31]
  v_mfma_f32_16x16x32_bf16 v[32:35], v[92:95], v[80:83], v[32:35]
  v_exp_f32 v12, v12
  v_exp_f32 v13, v13
  v_add_f32 v12, 1.0, v12
  v_add_f32 v13, 1.0, v13
  ds_read_b64_tr_b16 v[76:77], v16 offset:34816
  ds_read_b64_tr_b16 v[78:79], v16 offset:35072
  ds_read_b64_tr_b16 v[80:81], v17 offset:34816
  ds_read_b64_tr_b16 v[82:83], v17 offset:35072
  s_waitcnt lgkmcnt(8)
  v_mfma_f32_16x16x32_bf16 v[28:31], v[96:99], v[60:63], v[28:31]
  v_mfma_f32_16x16x32_bf16 v[32:35], v[96:99], v[64:67], v[32:35]
  v_rcp_f32 v12, v12
  v_rcp_f32 v13, v13
  v_cvt_pk_bf16_f32 v12, v12, v12
  v_cvt_pk_bf16_f32 v13, v13, v13
  s_waitcnt lgkmcnt(4)
  v_mfma_f32_16x16x32_bf16 v[28:31], v[100:103], v[68:71], v[28:31]
  v_mfma_f32_16x16x32_bf16 v[32:35], v[100:103], v[72:75], v[32:35]
  v_and_b32 v12, 0xffff0000, v12
  v_and_b32 v13, 0xffff0000, v13
k2_pad17:
  s_cbranch_execz k2_pad18
  v_sub_f32 v14, 1.0, v12
  v_sub_f32 v15, 1.0, v13
  s_waitcnt lgkmcnt(0)
  v_mfma_f32_16x16x32_bf16 v[28:31], v[104:107], v[76:79], v[28:31]
  v_mfma_f32_16x16x32_bf16 v[32:35], v[104:107], v[80:83], v[32:35]
  v_cvt_pk_bf16_f32 v14, v14, v14
  v_cvt_pk_bf16_f32 v15, v15, v15
  v_and_b32 v14, 0xffff0000, v14
  v_and_b32 v15, 0xffff0000, v15
  v_mul_f32 v12, 0x35e38e39, v12
  v_mul_f32 v13, 0x35e38e39, v13
  s_waitcnt vmcnt(7)
  v_mfma_f32_16x16x32_bf16 v[36:39], v[20:23], a[0:3], 0
  v_mfma_f32_16x16x32_bf16 v[40:43], v[24:27], a[0:3], 0
  s_waitcnt vmcnt(6)
  v_mfma_f32_16x16x32_bf16 v[36:39], v[20:23], a[4:7], v[36:39]
  v_mfma_f32_16x16x32_bf16 v[40:43], v[24:27], a[4:7], v[40:43]
  s_waitcnt vmcnt(5)
  v_mfma_f32_16x16x32_bf16 v[36:39], v[20:23], a[8:11], v[36:39]
  v_mfma_f32_16x16x32_bf16 v[40:43], v[24:27], a[8:11], v[40:43]
  s_waitcnt vmcnt(4)
  v_mfma_f32_16x16x32_bf16 v[36:39], v[20:23], a[12:15], v[36:39]
  v_mfma_f32_16x16x32_bf16 v[40:43], v[24:27], a[12:15], v[40:43]
  v_mul_f32 v28, v12, v28
  v_mul_f32 v29, v12, v29
  v_mul_f32 v30, v12, v30
  v_mul_f32 v31, v12, v31
  v_mul_f32 v32, v13, v32
  v_mul_f32 v33, v13, v33
  v_mul_f32 v34, v13, v34
k2_pad18:
  s_cbranch_execz k2_pad19
  v_mul_f32 v35, v13, v35
  s_waitcnt vmcnt(3)
  v_mfma_f32_16x16x32_bf16 v[36:39], v[20:23], a[16:19], v[36:39]
  v_mfma_f32_16x16x32_bf16 v[40:43], v[24:27], a[16:19], v[40:43]
  s_waitcnt vmcnt(2)
  v_mfma_f32_16x16x32_bf16 v[36:39], v[20:23], a[20:23], v[36:39]
  v_mfma_f32_16x16x32_bf16 v[40:43], v[24:27], a[20:23], v[40:43]
  s_waitcnt vmcnt(1)
  v_mfma_f32_16x16x32_bf16 v[36:39], v[20:23], a[24:27], v[36:39]
  v_mfma_f32_16x16x32_bf16 v[40:43], v[24:27], a[24:27], v[40:43]
  s_waitcnt vmcnt(0)
  v_mfma_f32_16x16x32_bf16 v[36:39], v[20:23], a[28:31], v[36:39]
  v_mfma_f32_16x16x32_bf16 v[40:43], v[24:27], a[28:31], v[40:43]
  s_nop 6
  v_fmac_f32 v28, v14, v36
  v_fmac_f32 v29, v14, v37
  v_fmac_f32 v30, v14, v38
  v_fmac_f32 v31, v14, v39
  v_cvt_pk_bf16_f32 v28, v28, v29
  v_cvt_pk_bf16_f32 v29, v30, v31
  ds_write_b64 v4, v[28:29] offset:36864
  v_fmac_f32 v32, v15, v40
  v_fmac_f32 v33, v15, v41
  v_fmac_f32 v34, v15, v42
  v_fmac_f32 v35, v15, v43
  v_cvt_pk_bf16_f32 v32, v32, v33
  v_cvt_pk_bf16_f32 v33, v34, v35
  ds_write_b64 v4, v[32:33] offset:41728
  s_waitcnt lgkmcnt(0)
  s_barrier
k2_pad19:
  s_cbranch_execz k2_kernel_end
  ds_read_b128 v[28:31], v18 offset:36864
  s_waitcnt lgkmcnt(0)
  buffer_store_dwordx4 v[28:31], v19, s[12:15], s24 offen
k2_kernel_end:
  s_endpgm
.section .rodata,"a"
.p2align 6
.amdhsa_kernel k1_kernel
  .amdhsa_next_free_vgpr 512
  .amdhsa_next_free_sgpr 102
  .amdhsa_accum_offset 256
  .amdhsa_group_segment_fixed_size 0
  .amdhsa_kernarg_size 88
  .amdhsa_user_sgpr_count 2
  .amdhsa_user_sgpr_kernarg_segment_ptr 1
  .amdhsa_system_sgpr_workgroup_id_x 1
.end_amdhsa_kernel
.p2align 6
.amdhsa_kernel k2_kernel
  .amdhsa_next_free_vgpr 140
  .amdhsa_next_free_sgpr 102
  .amdhsa_accum_offset 108
  .amdhsa_group_segment_fixed_size 0
  .amdhsa_kernarg_size 88
  .amdhsa_user_sgpr_count 2
  .amdhsa_user_sgpr_kernarg_segment_ptr 1
  .amdhsa_system_sgpr_workgroup_id_x 1
.end_amdhsa_kernel
```
